```python
import torch

def _softmax(x, axis=-1):
    return torch.softmax(x, dim=axis)
def _gelu(x):
    return torch.nn.functional.gelu(x, approximate="tanh")
def _silu(x):
    return torch.nn.functional.silu(x)
def _sigmoid(x):
    return torch.sigmoid(x)
def _layernorm(x, axis=-1, eps=1e-5):
    m = x.mean(dim=axis, keepdim=True)
    v = x.var(dim=axis, keepdim=True, unbiased=False)
    return (x - m) / torch.sqrt(v + eps)
def _scatter_add(tgt, idx, src, axis=0):
    return tgt.clone().index_add_(axis, idx, src)
def _segment_sum(src, seg, n):
    out = torch.zeros((n,) + src.shape[1:], dtype=src.dtype)
    return out.index_add_(0, seg, src)
def _pad(x, pw):
    flat = tuple(v for pair in reversed(pw) for v in pair)
    return torch.nn.functional.pad(x, flat)

kernel_name = 'recurrent_scan__sliding_block_cached__dense_activation_relu__prompt'

def setup_inputs():

    _w = (lambda a: (lambda t: t.to(torch.bfloat16) if t.is_floating_point() else t)(torch.as_tensor(a)))
    def _A_setup():
        B, Sq, D = 1, 2048, 448
        Hq, Hkv, Sk, Dh = 16, 8, 2048, 256
        assert Hq % Hkv == 0, (Hq, Hkv)
        return {
            "x": _w((lambda *s: torch.randn(*s, dtype=torch.bfloat16) * 0.05)(B, Sq, D)),
            "k_cache": _w((lambda *s: torch.randn(*s, dtype=torch.bfloat16) * 0.8)(B, Hkv, Sk, Dh)),
            "v_cache": _w((lambda *s: torch.randn(*s, dtype=torch.bfloat16) * 0.2)(B, Hkv, Sk, Dh)),
            "wq": _w((lambda *s: torch.randn(*s, dtype=torch.bfloat16) * 0.8)(D, Hq * Dh) * (D ** -0.5)),
            "wo": _w((lambda *s: torch.randn(*s, dtype=torch.bfloat16) * 0.2)(Hq * Dh, D) * ((Hq * Dh) ** -0.5)),
        }
    _A_in = _A_setup()

    def _B_setup():
        B, S, D, Dff = 1, 2048, 448, 1792
        return {
            "x": _w((lambda *s: torch.randn(*s, dtype=torch.bfloat16) * 0.05)(B, S, D)),
            "w1": _w((lambda *s: torch.randn(*s, dtype=torch.bfloat16) * 0.1)(D, Dff)),
            "w2": _w((lambda *s: torch.randn(*s, dtype=torch.bfloat16) * 0.1)(Dff, D)),
        }
    _B_in = _B_setup()

    return {
        "A_x": _A_in["x"],
        "A_k_cache": _A_in["k_cache"],
        "A_v_cache": _A_in["v_cache"],
        "A_wq": _A_in["wq"],
        "A_wo": _A_in["wo"],
        "B_x": _B_in["x"],
        "B_w1": _B_in["w1"],
        "B_w2": _B_in["w2"],
    }

def reference(A_x, A_k_cache, A_v_cache, A_wq, A_wo, B_x, B_w1, B_w2):
    def _A_ref(x, k_cache, v_cache, wq, wo):
        B, Sq, D = x.shape
        Hq, Dh = 16, 256
        Hkv, Sk = k_cache.shape[1], k_cache.shape[2]
        W = min(4096, max(256, Sk // 4))
        rep = Hq // Hkv
        q = (lambda x, *d: x.permute(*d))((x @ wq).reshape(B, Sq, Hq, Dh), 0, 2, 1, 3)
        k = (lambda x, n, axis: torch.repeat_interleave(x, n, dim=axis))(k_cache[:, :, Sk - W:, :], rep, axis=1)
        v = (lambda x, n, axis: torch.repeat_interleave(x, n, dim=axis))(v_cache[:, :, Sk - W:, :], rep, axis=1)
        scores = torch.einsum("bhqd,bhkd->bhqk", q, k) * (Dh ** -0.5)
        p = _softmax(scores, axis=-1)
        o = torch.einsum("bhqk,bhkd->bhqd", p, v)
        return (lambda x, *d: x.permute(*d))(o, 0, 2, 1, 3).reshape(B, Sq, Hq * Dh) @ wo

    def _B_ref(x, w1, w2):
        h = torch.einsum("bsd,df->bsf", x, w1)
        zero = torch.zeros_like(h)
        h = torch.maximum(h, zero)
        return torch.einsum("bsf,fd->bsd", h, w2)

    x = A_x
    xn = _layernorm(x, axis=-1)
    s = _A_ref(xn, A_k_cache, A_v_cache, A_wq, A_wo)
    g = _silu(_B_ref(xn, B_w1, B_w2))
    return x + s * g
```

```asm
; @launch grid=(256,1,1) block=(256,1,1) lds=163840
.amdgcn_target "amdgcn-amd-amdhsa--gfx950"
.text
.globl recurrent_scan__sliding_block_cached__dense_activation_relu__prompt_kernel
.p2align 8
.type recurrent_scan__sliding_block_cached__dense_activation_relu__prompt_kernel,@function
recurrent_scan__sliding_block_cached__dense_activation_relu__prompt_kernel:
    s_cmp_ge_u32 s2, 256
    s_cbranch_scc1 L_END
    s_load_dwordx16 s[48:63], s[0:1], 0
    s_load_dwordx4 s[64:67], s[0:1], 64
    s_load_dwordx2 s[40:41], s[0:1], 80
    s_getpc_b64 s[92:93]
L_PC:
    s_lshr_b32 s95, s2, 3
    s_lshl_b32 s3, s95, 11
    v_lshrrev_b32 v11, 4, v0
    v_lshl_add_u32 v11, v11, 7, s3
    v_min_u32 v11, L_CODE_END-L_PC-4, v11
    global_load_dword a87, v11, s[92:93]
    s_and_b32 s94, s2, 7
    s_and_b32 s45, s94, 3
    s_lshl_b32 s45, s45, 2
    s_and_b32 s3, s95, 3
    s_add_u32 s45, s45, s3
    s_lshr_b32 s44, s94, 2
    s_lshl_b32 s44, s44, 3
    s_lshr_b32 s68, s95, 2
    s_add_u32 s44, s44, s68
    v_lshrrev_b32 v11, 6, v0
    v_and_b32 v12, 63, v0
    v_readfirstlane_b32 s46, v11
    v_and_b32 v13, 15, v12
    v_lshrrev_b32 v14, 4, v12
    s_lshl_b32 s3, s46, 5
    v_add_u32 v15, s3, v13
    v_mul_u32_u24 v15, 896, v15
    s_mul_i32 s94, s44, 114688
    v_lshrrev_b32 v152, 3, v12
    v_add_u32 v152, s3, v152
    v_mul_u32_u24 v152, 896, v152
    v_xor_b32 v153, v14, v12
    v_and_b32 v153, 7, v153
    v_lshl_add_u32 v152, v153, 4, v152
    v_xor_b32 v153, 64, v152
    s_lshl_b32 s47, s46, 12
    s_mul_i32 s101, s45, 1
    s_mul_i32 s3, s101, 9363
    s_lshr_b32 s3, s3, 16
    s_mul_i32 s3, s3, 7
    s_sub_u32 s101, s101, s3
    s_mov_b32 s81, 6144
    s_mov_b32 s82, 12288
    s_mov_b32 s83, 18432
    s_waitcnt lgkmcnt(0)
    s_add_u32 s4, s48, s94
    s_addc_u32 s5, s49, 0
    s_sub_u32 s6, 1835008, s94
    s_mov_b32 s7, 0x20000
    s_mov_b32 s0, s101
    s_mov_b32 s1, s101
    s_lshl_b32 s98, s0, 14
    s_add_u32 s98, s98, s47
    s_add_u32 m0, s98, 49152
    v_lshl_add_u32 v154, s0, 7, v152
    v_lshl_add_u32 v155, s0, 7, v153
    s_add_u32 s0, s0, 1
    s_cmp_eq_u32 s0, 7
    s_cselect_b32 s0, 0, s0
    buffer_load_dwordx4 v154, s[4:7], 0 offen offset:0 lds
    v_mov_b32 v9, 0x3f803f80
    v_accvgpr_write_b32 a60, v9
    v_accvgpr_write_b32 a61, v9
    v_accvgpr_write_b32 a62, v9
    v_accvgpr_write_b32 a63, v9
    v_lshrrev_b32 v0, 1, v13
    v_xor_b32 v0, v0, v14
    v_lshlrev_b32 v0, 4, v0
    v_lshl_add_u32 v0, v13, 7, v0
    v_add_u32 v0, s47, v0
    buffer_load_dwordx4 v155, s[4:7], s81 offen offset:1024 lds
    v_add_u32 v0, 49152, v0
    v_lshrrev_b32 v11, 5, v12
    v_lshlrev_b32 v1, 1, v11
    v_xor_b32 v1, v1, v12
    v_and_b32 v1, 3, v1
    v_lshlrev_b32 v1, 4, v1
    v_and_b32 v2, 1, v14
    v_lshl_add_u32 v1, v2, 6, v1
    v_bfe_u32 v2, v12, 2, 2
    v_lshl_add_u32 v3, v11, 3, v2
    buffer_load_dwordx4 v154, s[4:7], s82 offen offset:2048 lds
    v_lshl_add_u32 v4, v11, 2, v2
    s_add_u32 s32, s64, s94
    s_addc_u32 s33, s65, 0
    s_sub_u32 s34, 1835008, s94
    s_mov_b32 s35, 0x20000
    s_mul_i32 s94, s45, 224
    s_add_u32 s24, s60, s94
    s_addc_u32 s25, s61, 0
    s_sub_u32 s26, 1605632, s94
    s_mov_b32 s27, 0x20000
    buffer_load_dwordx4 v155, s[4:7], s83 offen offset:3072 lds
    s_mov_b32 s77, 13312
    s_mov_b32 s78, 112640
    s_mov_b32 s79, 125952
    s_and_b32 s94, s46, 1
    s_lshr_b32 s95, s46, 1
    s_lshl_b32 s3, s94, 1
    v_xor_b32 v10, s3, v12
    v_and_b32 v10, 3, v10
    v_lshlrev_b32 v10, 4, v10
    v_lshl_add_u32 v10, v14, 6, v10
    s_lshl_b32 s98, s0, 14
    s_add_u32 s98, s98, s47
    s_add_u32 m0, s98, 49152
    v_lshl_add_u32 v154, s0, 7, v152
    v_lshl_add_u32 v155, s0, 7, v153
    s_add_u32 s0, s0, 1
    s_cmp_eq_u32 s0, 7
    s_cselect_b32 s0, 0, s0
    buffer_load_dwordx4 v154, s[4:7], 0 offen offset:0 lds
    v_mov_b32 v139, 2147418112
    v_cmp_gt_u32 vcc, 0xe0, v10
    s_nop 1
    v_cndmask_b32 v10, v139, v10, vcc
    v_lshl_add_u32 v6, s46, 3, v2
    v_mul_u32_u24 v6, 3584, v6
    v_add_u32 v6, v6, v10
    v_lshl_add_u32 v9, s46, 2, v2
    v_mul_u32_u24 v9, 896, v9
    v_add_u32 v9, v9, v10
    v_accvgpr_write_b32 a79, v9
    buffer_load_dwordx4 v155, s[4:7], s81 offen offset:1024 lds
    s_mov_b32 s97, s68
    s_lshl2_add_u32 s68, s68, s46
    s_lshl_b32 s3, s45, 9
    s_add_u32 s16, s54, s3
    s_addc_u32 s17, s55, 0
    s_sub_u32 s18, 3670016, s3
    s_mov_b32 s19, 0x20000
    v_lshlrev_b32 v7, 7, v12
    v_lshrrev_b32 v8, 2, v12
    v_and_b32 v9, 3, v12
    buffer_load_dwordx4 v154, s[4:7], s82 offen offset:2048 lds
    v_mul_u32_u24 v138, 3584, v8
    v_lshl_add_u32 v138, v9, 6, v138
    s_mul_i32 s3, s68, 50176
    v_add_u32 v138, s3, v138
    v_cmp_gt_u32 vcc, 56, v12
    v_mov_b32 v139, 2147418112
    s_nop 0
    v_cndmask_b32 v138, v139, v138, vcc
    s_lshl_b32 s3, s94, 2
    s_add_u32 s3, s3, s95
    s_lshl_b32 s3, s3, 15
    buffer_load_dwordx4 v155, s[4:7], s83 offen offset:3072 lds
    s_and_b32 s101, s97, 3
    s_lshl_b32 s69, s101, 7
    s_add_u32 s3, s3, s69
    s_add_u32 s88, s69, 0
    s_and_b32 s88, s88, 0x180
    s_add_u32 s88, s88, 3072
    s_add_u32 s89, s69, 128
    s_and_b32 s89, s89, 0x180
    s_add_u32 s89, s89, 2048
    s_add_u32 s90, s69, 256
    s_lshl_b32 s98, s0, 14
    s_add_u32 s98, s98, s47
    s_add_u32 m0, s98, 49152
    v_lshl_add_u32 v154, s0, 7, v152
    v_lshl_add_u32 v155, s0, 7, v153
    s_add_u32 s0, s0, 1
    s_cmp_eq_u32 s0, 7
    s_cselect_b32 s0, 0, s0
    buffer_load_dwordx4 v154, s[4:7], 0 offen offset:0 lds
    s_and_b32 s90, s90, 0x180
    s_add_u32 s90, s90, 1024
    s_add_u32 s91, s69, 384
    s_and_b32 s91, s91, 0x180
    s_add_u32 s91, s91, 0
    v_lshl_add_u32 v5, v3, 13, v1
    v_add_u32 v5, s3, v5
    s_and_b32 s69, s45, 1
    s_lshl1_add_u32 s69, s97, s69
    s_and_b32 s69, s69, 15
    buffer_load_dwordx4 v155, s[4:7], s81 offen offset:1024 lds
    s_sub_u32 s95, s69, s95
    s_and_b32 s95, s95, 15
    s_lshl_b32 s95, s95, 14
    s_lshl_b32 s69, s69, 14
    s_add_u32 s69, s69, s47
    s_lshl_b32 s3, s46, 7
    s_add_u32 s3, s3, s95
    v_lshl_add_u32 v10, v4, 9, v1
    v_add_u32 v10, s3, v10
    v_accvgpr_write_b32 a81, v10
    buffer_load_dwordx4 v154, s[4:7], s82 offen offset:2048 lds
    s_mov_b64 exec, 0
    s_cmp_eq_u32 s46, 0
    s_cbranch_scc1 L_PAD0
    s_cmp_eq_u32 s46, 1
    s_cbranch_scc1 L_PAD1
    s_cmp_eq_u32 s46, 2
    s_cbranch_scc1 L_PAD2
    s_branch L_PAD3
L_PADBACK:
    s_mov_b64 exec, -1
    s_mul_i32 s3, s46, 28672
    v_mul_u32_u24 v10, 896, v4
    v_add3_u32 v10, v10, v1, s3
    v_accvgpr_write_b32 a82, v10
    s_lshl1_add_u32 s71, s97, s45
    s_and_b32 s71, s71, 15
    s_lshr_b32 s84, s71, 1
    s_cmp_eq_u32 s84, 7
    s_cselect_b32 s84, 0, s84
    s_lshl_b32 s84, s84, 2
    buffer_load_dwordx4 v155, s[4:7], s83 offen offset:3072 lds
    s_mov_b32 s58, 0x06543210
    s_mov_b32 s59, 0x00654321
    s_add_u32 s3, s84, 4
    s_lshr_b64 s[58:59], s[58:59], s3
    s_mov_b32 s99, s58
    s_mov_b32 s58, 0x60123456
    s_mov_b32 s59, 0x00012345
    s_sub_u32 s3, 28, s84
    s_lshr_b64 s[58:59], s[58:59], s3
    s_mov_b32 s80, s58
    s_lshl_b32 s98, s0, 14
    s_add_u32 s98, s98, s47
    s_add_u32 m0, s98, 49152
    v_lshl_add_u32 v154, s0, 7, v152
    v_lshl_add_u32 v155, s0, 7, v153
    s_add_u32 s0, s0, 1
    s_cmp_eq_u32 s0, 7
    s_cselect_b32 s0, 0, s0
    buffer_load_dwordx4 v154, s[4:7], 0 offen offset:0 lds
    s_and_b32 s101, s101, 1
    s_mul_i32 s101, s101, 200704
    v_and_b32 v3, 1, v14
    v_lshl_add_u32 v4, v3, 1, v11
    v_lshl_add_u32 v15, v4, 4, v15
    v_accvgpr_write_b32 a85, v15
    s_lshl_b32 s3, s94, 2
    v_add_u32 v10, s3, v4
    v_xor_b32 v10, v10, v12
    v_and_b32 v10, 7, v10
    buffer_load_dwordx4 v155, s[4:7], s81 offen offset:1024 lds
    v_lshlrev_b32 v10, 4, v10
    v_lshrrev_b32 v8, 3, v12
    v_lshl_add_u32 v10, v8, 9, v10
    v_add_u32 v10, s69, v10
    v_accvgpr_write_b32 a80, v10
    v_bfe_u32 v10, v13, 1, 1
    v_bfe_u32 v8, v13, 2, 1
    v_lshl_add_u32 v10, v10, 1, v8
    v_lshrrev_b32 v8, 3, v13
    v_lshl_add_u32 v10, v8, 2, v10
    buffer_load_dwordx4 v154, s[4:7], s82 offen offset:2048 lds
    v_xor_b32 v10, v10, v4
    v_lshlrev_b32 v10, 4, v10
    v_lshl_add_u32 v10, v8, 12, v10
    v_and_b32 v8, 7, v13
    v_lshl_add_u32 v10, v8, 7, v10
    v_accvgpr_write_b32 a83, v10
    v_lshlrev_b32 v10, 6, v2
    v_lshl_add_u32 v10, v3, 5, v10
    v_lshl_add_u32 v10, v9, 3, v10
    v_lshl_add_u32 v8, v14, 12, v10
    buffer_load_dwordx4 v155, s[4:7], s83 offen offset:3072 lds
    v_accvgpr_write_b32 a86, v8
    v_lshl_add_u32 v1, v14, 9, v10
    v_xor_b32 v2, 32, v1
    v_lshl_add_u32 v10, v3, 9, v10
    v_lshl_add_u32 v3, v11, 13, v10
    v_xor_b32 v4, 32, v3
    s_lshr_b32 s94, s45, 2
    s_mul_i32 s94, s94, 401408
    s_and_b32 s3, s45, 3
    s_mul_i32 s3, s3, 224
    s_lshl_b32 s98, s0, 14
    s_add_u32 s98, s98, s47
    s_add_u32 m0, s98, 49152
    v_lshl_add_u32 v154, s0, 7, v152
    v_lshl_add_u32 v155, s0, 7, v153
    s_add_u32 s0, s0, 1
    s_cmp_eq_u32 s0, 7
    s_cselect_b32 s0, 0, s0
    buffer_load_dwordx4 v154, s[4:7], 0 offen offset:0 lds
    s_add_u32 s94, s94, s3
    s_add_u32 s28, s62, s94
    s_addc_u32 s29, s63, 0
    s_sub_u32 s30, 1605632, s94
    s_mov_b32 s31, 0x20000
    s_mul_i32 s94, s45, 229376
    s_add_u32 s20, s56, s94
    s_addc_u32 s21, s57, 0
    s_sub_u32 s22, 3670016, s94
    s_mov_b32 s23, 0x20000
    v_lshl_add_u32 v156, s1, 14, v0
    v_xor_b32 v157, 64, v156
    s_waitcnt vmcnt(13)
    ds_read_b128 v[192:195], v156 offset:0
    ds_read_b128 v[196:199], v156 offset:2048
    ds_read_b128 v[200:203], v157 offset:0
    ds_read_b128 v[204:207], v157 offset:2048
    s_add_u32 s1, s1, 1
    s_cmp_eq_u32 s1, 7
    s_cselect_b32 s1, 0, s1
    buffer_load_dwordx4 v155, s[4:7], s81 offen offset:1024 lds
    s_lshr_b32 s94, s45, 1
    s_lshl_b32 s94, s94, 20
    s_add_u32 s95, s94, 783360
    s_add_u32 s8, s50, s95
    s_addc_u32 s9, s51, 0
    s_sub_u32 s10, 8388608, s95
    s_mov_b32 s11, 0x20000
    s_add_u32 s95, s94, 786432
    s_add_u32 s12, s52, s95
    s_addc_u32 s13, s53, 0
    buffer_load_dwordx4 v154, s[4:7], s82 offen offset:2048 lds
    s_sub_u32 s14, 8388608, s95
    s_mov_b32 s15, 0x20000
    s_mov_b32 s36, s66
    s_mov_b32 s37, s67
    s_mov_b32 s38, 256
    s_mov_b32 s39, 0x20000
    s_mov_b32 s42, 268435456
    s_mov_b32 s43, 0x20000
    s_mov_b32 s73, 261120
    s_mov_b32 s85, 3072
    s_waitcnt lgkmcnt(3)
    v_mfma_f32_16x16x32_bf16 v[128:131], a[60:63], v[192:195], 0
    s_waitcnt lgkmcnt(2)
    v_mfma_f32_16x16x32_bf16 v[132:135], a[60:63], v[196:199], 0
    s_waitcnt lgkmcnt(1)
    v_mfma_f32_16x16x32_bf16 v[128:131], a[60:63], v[200:203], v[128:131]
    s_waitcnt lgkmcnt(0)
    v_mfma_f32_16x16x32_bf16 v[132:135], a[60:63], v[204:207], v[132:135]
    v_mfma_f32_16x16x32_bf16 v[144:147], v[192:195], v[192:195], 0
    v_mfma_f32_16x16x32_bf16 v[148:151], v[196:199], v[196:199], 0
    v_mfma_f32_16x16x32_bf16 v[144:147], v[200:203], v[200:203], v[144:147]
    v_mfma_f32_16x16x32_bf16 v[148:151], v[204:207], v[204:207], v[148:151]
    buffer_load_dwordx4 v155, s[4:7], s83 offen offset:3072 lds
    s_mov_b32 s74, 522240
    s_mov_b32 s86, 6144
    s_mov_b32 s75, 783360
    s_mov_b32 s87, 9216
    s_mov_b32 s70, 0xffff0000
    s_lshl_b32 s94, s44, 13
    s_add_u32 s94, s94, 50331648
    s_or_b32 s3, s45, s46
    s_cmp_eq_u32 s3, 0
    s_cselect_b32 s95, s94, 2147418112
    s_lshl_b32 s98, s0, 14
    s_add_u32 s98, s98, s47
    s_add_u32 m0, s98, 49152
    v_lshl_add_u32 v154, s0, 7, v152
    v_lshl_add_u32 v155, s0, 7, v153
    s_add_u32 s0, s0, 1
    s_cmp_eq_u32 s0, 7
    s_cselect_b32 s0, 0, s0
    buffer_load_dwordx4 v154, s[4:7], 0 offen offset:0 lds
    v_mov_b32 v140, 0
    v_lshlrev_b32 v141, 7, v13
    v_lshl_add_u32 v141, v14, 11, v141
    v_add_u32 v141, s95, v141
    s_lshl_b32 s3, s46, 11
    s_add_u32 s76, s94, s3
    s_lshl_b32 s3, s71, 7
    s_add_u32 s3, s76, s3
    v_mov_b32 v9, 2147418112
    v_mov_b32 v10, s3
    v_lshl_add_u32 v156, s1, 14, v0
    v_xor_b32 v157, 64, v156
    s_waitcnt vmcnt(13)
    ds_read_b128 v[208:211], v156 offset:0
    ds_read_b128 v[212:215], v156 offset:2048
    ds_read_b128 v[216:219], v157 offset:0
    ds_read_b128 v[220:223], v157 offset:2048
    s_add_u32 s1, s1, 1
    s_cmp_eq_u32 s1, 7
    s_cselect_b32 s1, 0, s1
    buffer_load_dwordx4 v155, s[4:7], s81 offen offset:1024 lds
    v_cmp_eq_u32 vcc, 0, v12
    s_nop 1
    v_cndmask_b32 v10, v9, v10, vcc
    v_accvgpr_write_b32 a84, v10
    s_mul_i32 s94, s44, 1835008
    s_lshl_b32 s3, s46, 15
    s_add_u32 s94, s94, s3
    s_lshl_b32 s3, s71, 11
    s_add_u32 s93, s94, s3
    s_lshl_b32 s3, s71, 17
    s_add_u32 s100, s94, s3
    buffer_load_dwordx4 v154, s[4:7], s82 offen offset:2048 lds
    s_lshl2_add_u32 s3, s44, s46
    s_mul_i32 s72, s3, 114688
    s_add_u32 s72, s72, 33554432
    s_mul_i32 s3, s45, 7168
    s_add_u32 s92, s72, s3
    s_lshr_b32 s3, s45, 2
    s_mul_i32 s3, s3, 28672
    s_add_u32 s72, s72, s3
    s_cmp_ge_u32 s71, 14
    s_cselect_b32 s100, 2147418112, s100
    s_waitcnt lgkmcnt(3)
    v_mfma_f32_16x16x32_bf16 v[128:131], a[60:63], v[208:211], v[128:131]
    s_waitcnt lgkmcnt(2)
    v_mfma_f32_16x16x32_bf16 v[132:135], a[60:63], v[212:215], v[132:135]
    s_waitcnt lgkmcnt(1)
    v_mfma_f32_16x16x32_bf16 v[128:131], a[60:63], v[216:219], v[128:131]
    s_waitcnt lgkmcnt(0)
    v_mfma_f32_16x16x32_bf16 v[132:135], a[60:63], v[220:223], v[132:135]
    v_mfma_f32_16x16x32_bf16 v[144:147], v[208:211], v[208:211], v[144:147]
    v_mfma_f32_16x16x32_bf16 v[148:151], v[212:215], v[212:215], v[148:151]
    v_mfma_f32_16x16x32_bf16 v[144:147], v[216:219], v[216:219], v[144:147]
    v_mfma_f32_16x16x32_bf16 v[148:151], v[220:223], v[220:223], v[148:151]
    buffer_load_dwordx4 v155, s[4:7], s83 offen offset:3072 lds
    v_lshlrev_b32 v9, 2, v14
    v_sub_u32 v9, v13, v9
    v_mov_b32 v10, 0x3f80
    v_lshlrev_b32 v8, 4, v9
    v_and_b32 v8, 16, v8
    v_lshlrev_b32 v10, v8, v10
    v_lshrrev_b32 v9, 1, v9
    v_cmp_eq_u32 vcc, 0, v9
    s_nop 1
    v_cndmask_b32 v8, 0, v10, vcc
    v_accvgpr_write_b32 a74, v8
    s_lshl_b32 s98, s0, 14
    s_add_u32 s98, s98, s47
    s_add_u32 m0, s98, 49152
    v_lshl_add_u32 v154, s0, 7, v152
    v_lshl_add_u32 v155, s0, 7, v153
    buffer_load_dwordx4 v154, s[4:7], 0 offen offset:0 lds
    v_cmp_eq_u32 vcc, 1, v9
    s_nop 1
    v_cndmask_b32 v8, 0, v10, vcc
    v_accvgpr_write_b32 a75, v8
    v_accvgpr_write_b32 a72, 0
    v_accvgpr_write_b32 a73, 0
    v_accvgpr_write_b32 a76, 0
    v_accvgpr_write_b32 a77, 0
    s_lshl_b32 s94, s44, 4
    s_or_b32 s3, s45, s46
    s_cmp_eq_u32 s3, 0
    s_cselect_b32 s94, s94, 2147418112
    v_lshl_add_u32 v156, s1, 14, v0
    v_xor_b32 v157, 64, v156
    s_waitcnt vmcnt(13)
    ds_read_b128 v[192:195], v156 offset:0
    ds_read_b128 v[196:199], v156 offset:2048
    ds_read_b128 v[200:203], v157 offset:0
    ds_read_b128 v[204:207], v157 offset:2048
    s_add_u32 s1, s1, 1
    s_cmp_eq_u32 s1, 7
    s_cselect_b32 s1, 0, s1
    buffer_load_dwordx4 v155, s[4:7], s81 offen offset:1024 lds
    v_lshlrev_b32 v15, 12, v12
    buffer_load_dwordx4 v154, s[4:7], s82 offen offset:2048 lds
    s_waitcnt lgkmcnt(3)
    v_mfma_f32_16x16x32_bf16 v[128:131], a[60:63], v[192:195], v[128:131]
    s_waitcnt lgkmcnt(2)
    v_mfma_f32_16x16x32_bf16 v[132:135], a[60:63], v[196:199], v[132:135]
    s_waitcnt lgkmcnt(1)
    v_mfma_f32_16x16x32_bf16 v[128:131], a[60:63], v[200:203], v[128:131]
    s_waitcnt lgkmcnt(0)
    v_mfma_f32_16x16x32_bf16 v[132:135], a[60:63], v[204:207], v[132:135]
    v_mfma_f32_16x16x32_bf16 v[144:147], v[192:195], v[192:195], v[144:147]
    v_mfma_f32_16x16x32_bf16 v[148:151], v[196:199], v[196:199], v[148:151]
    v_mfma_f32_16x16x32_bf16 v[144:147], v[200:203], v[200:203], v[144:147]
    v_mfma_f32_16x16x32_bf16 v[148:151], v[204:207], v[204:207], v[148:151]
    buffer_load_dwordx4 v155, s[4:7], s83 offen offset:3072 lds
    s_add_u32 m0, s47, 0
    s_nop 0
    buffer_load_dwordx4 v6, s[24:27], 0 offen offset:0 lds
    v_lshl_add_u32 v156, s1, 14, v0
    v_xor_b32 v157, 64, v156
    s_waitcnt vmcnt(13)
    ds_read_b128 v[208:211], v156 offset:0
    ds_read_b128 v[212:215], v156 offset:2048
    ds_read_b128 v[216:219], v157 offset:0
    ds_read_b128 v[220:223], v157 offset:2048
    s_add_u32 s1, s1, 1
    s_cmp_eq_u32 s1, 7
    s_cselect_b32 s1, 0, s1
    buffer_load_dwordx4 v6, s[24:27], s77 offen offset:1024 lds
    buffer_load_dwordx4 v6, s[24:27], s78 offen offset:2048 lds
    s_waitcnt lgkmcnt(3)
    v_mfma_f32_16x16x32_bf16 v[128:131], a[60:63], v[208:211], v[128:131]
    s_waitcnt lgkmcnt(2)
    v_mfma_f32_16x16x32_bf16 v[132:135], a[60:63], v[212:215], v[132:135]
    s_waitcnt lgkmcnt(1)
    v_mfma_f32_16x16x32_bf16 v[128:131], a[60:63], v[216:219], v[128:131]
    s_waitcnt lgkmcnt(0)
    v_mfma_f32_16x16x32_bf16 v[132:135], a[60:63], v[220:223], v[132:135]
    v_mfma_f32_16x16x32_bf16 v[144:147], v[208:211], v[208:211], v[144:147]
    v_mfma_f32_16x16x32_bf16 v[148:151], v[212:215], v[212:215], v[148:151]
    v_mfma_f32_16x16x32_bf16 v[144:147], v[216:219], v[216:219], v[144:147]
    v_mfma_f32_16x16x32_bf16 v[148:151], v[220:223], v[220:223], v[148:151]
    buffer_load_dwordx4 v6, s[24:27], s79 offen offset:3072 lds
    v_add_u32 v6, 229376, v6
    s_add_u32 m0, s47, 16384
    s_nop 0
    buffer_load_dwordx4 v6, s[24:27], 0 offen offset:0 lds
    v_lshl_add_u32 v156, s1, 14, v0
    v_xor_b32 v157, 64, v156
    s_waitcnt vmcnt(13)
    ds_read_b128 v[192:195], v156 offset:0
    ds_read_b128 v[196:199], v156 offset:2048
    ds_read_b128 v[200:203], v157 offset:0
    ds_read_b128 v[204:207], v157 offset:2048
    s_add_u32 s1, s1, 1
    s_cmp_eq_u32 s1, 7
    s_cselect_b32 s1, 0, s1
    buffer_load_dwordx4 v6, s[24:27], s77 offen offset:1024 lds
    buffer_load_dwordx4 v6, s[24:27], s78 offen offset:2048 lds
    s_waitcnt lgkmcnt(3)
    v_mfma_f32_16x16x32_bf16 v[128:131], a[60:63], v[192:195], v[128:131]
    s_waitcnt lgkmcnt(2)
    v_mfma_f32_16x16x32_bf16 v[132:135], a[60:63], v[196:199], v[132:135]
    s_waitcnt lgkmcnt(1)
    v_mfma_f32_16x16x32_bf16 v[128:131], a[60:63], v[200:203], v[128:131]
    s_waitcnt lgkmcnt(0)
    v_mfma_f32_16x16x32_bf16 v[132:135], a[60:63], v[204:207], v[132:135]
    v_mfma_f32_16x16x32_bf16 v[144:147], v[192:195], v[192:195], v[144:147]
    v_mfma_f32_16x16x32_bf16 v[148:151], v[196:199], v[196:199], v[148:151]
    v_mfma_f32_16x16x32_bf16 v[144:147], v[200:203], v[200:203], v[144:147]
    v_mfma_f32_16x16x32_bf16 v[148:151], v[204:207], v[204:207], v[148:151]
    buffer_load_dwordx4 v6, s[24:27], s79 offen offset:3072 lds
    v_add_u32 v6, 229376, v6
    v_lshl_add_u32 v156, s1, 14, v0
    v_xor_b32 v157, 64, v156
    s_waitcnt vmcnt(12)
    ds_read_b128 v[208:211], v156 offset:0
    ds_read_b128 v[212:215], v156 offset:2048
    ds_read_b128 v[216:219], v157 offset:0
    ds_read_b128 v[220:223], v157 offset:2048
    s_add_u32 s1, s1, 1
    s_cmp_eq_u32 s1, 7
    s_cselect_b32 s1, 0, s1
    s_waitcnt lgkmcnt(3)
    v_mfma_f32_16x16x32_bf16 v[128:131], a[60:63], v[208:211], v[128:131]
    s_waitcnt lgkmcnt(2)
    v_mfma_f32_16x16x32_bf16 v[132:135], a[60:63], v[212:215], v[132:135]
    s_waitcnt lgkmcnt(1)
    v_mfma_f32_16x16x32_bf16 v[128:131], a[60:63], v[216:219], v[128:131]
    s_waitcnt lgkmcnt(0)
    v_mfma_f32_16x16x32_bf16 v[132:135], a[60:63], v[220:223], v[132:135]
    v_mfma_f32_16x16x32_bf16 v[144:147], v[208:211], v[208:211], v[144:147]
    v_mfma_f32_16x16x32_bf16 v[148:151], v[212:215], v[212:215], v[148:151]
    v_mfma_f32_16x16x32_bf16 v[144:147], v[216:219], v[216:219], v[144:147]
    v_mfma_f32_16x16x32_bf16 v[148:151], v[220:223], v[220:223], v[148:151]
    v_lshl_add_u32 v156, s1, 14, v0
    v_xor_b32 v157, 64, v156
    v_mov_b32 v13, v0
    v_xor_b32 v14, 64, v0
    v_mov_b32 v0, 1
    v_accvgpr_read_b32 v8, a84
    v_accvgpr_read_b32 v11, a86
    v_xor_b32 v12, 32, v11
    s_branch L_BODY
.p2align 12
L_BODY:
L_PAD0:
    s_cbranch_execz L_PAD4
    s_waitcnt vmcnt(8)
    ds_read_b128 v[192:195], v156 offset:0
    ds_read_b128 v[196:199], v156 offset:2048
    ds_read_b128 v[200:203], v157 offset:0
    ds_read_b128 v[204:207], v157 offset:2048
    ds_read_b128 v[16:19], v13 offset:0
    ds_read_b128 v[20:23], v13 offset:2048
    ds_read_b128 v[24:27], v14 offset:0
    ds_read_b128 v[28:31], v14 offset:2048
    ds_read_b128 v[32:35], v13 offset:16384
    s_waitcnt lgkmcnt(8)
    v_mfma_f32_16x16x32_bf16 v[128:131], a[60:63], v[192:195], v[128:131]
    ds_read_b128 v[36:39], v13 offset:18432
    ds_read_b128 v[40:43], v14 offset:16384
    s_waitcnt lgkmcnt(9)
    v_mfma_f32_16x16x32_bf16 v[132:135], a[60:63], v[196:199], v[132:135]
    ds_read_b128 v[44:47], v14 offset:18432
    ds_read_b128 v[48:51], v13 offset:32768
    s_waitcnt lgkmcnt(10)
    v_mfma_f32_16x16x32_bf16 v[128:131], a[60:63], v[200:203], v[128:131]
    ds_read_b128 v[52:55], v13 offset:34816
    ds_read_b128 v[56:59], v14 offset:32768
    s_waitcnt lgkmcnt(11)
    v_mfma_f32_16x16x32_bf16 v[132:135], a[60:63], v[204:207], v[132:135]
    ds_read_b128 v[60:63], v14 offset:34816
    ds_read_b128 v[64:67], v13 offset:49152
    v_mfma_f32_16x16x32_bf16 v[144:147], v[192:195], v[192:195], v[144:147]
    ds_read_b128 v[68:71], v13 offset:51200
    ds_read_b128 v[72:75], v14 offset:49152
    v_mfma_f32_16x16x32_bf16 v[148:151], v[196:199], v[196:199], v[148:151]
    ds_read_b128 v[76:79], v14 offset:51200
    v_add_u32 v13, 65536, v13
    v_add_u32 v14, 65536, v14
    ds_read_b128 v[80:83], v13 offset:0
    v_mfma_f32_16x16x32_bf16 v[144:147], v[200:203], v[200:203], v[144:147]
    ds_read_b128 v[84:87], v13 offset:2048
    ds_read_b128 v[88:91], v14 offset:0
    v_mfma_f32_16x16x32_bf16 v[148:151], v[204:207], v[204:207], v[148:151]
    ds_read_b128 v[92:95], v14 offset:2048
    ds_read_b128 v[96:99], v13 offset:16384
    ds_read_b128 v[100:103], v13 offset:18432
    ds_read_b128 v[104:107], v14 offset:16384
    ds_read_b128 v[108:111], v14 offset:18432
    ds_read_b128 v[112:115], v13 offset:32768
    ds_read_b128 v[116:119], v13 offset:34816
    ds_read_b128 v[120:123], v14 offset:32768
    ds_read_b128 v[124:127], v14 offset:34816
    s_add_u32 m0, s47, 32768
    s_nop 0
    buffer_load_dwordx4 v6, s[24:27], 0 offen offset:0 lds
    buffer_load_dwordx4 v6, s[24:27], s77 offen offset:1024 lds
    buffer_load_dwordx4 v6, s[24:27], s78 offen offset:2048 lds
    buffer_load_dwordx4 v6, s[24:27], s79 offen offset:3072 lds
    v_add_u32 v6, 229376, v6
    buffer_load_dword a87, v138, s[24:27], 0 offen
    buffer_store_dword v140, v141, s[40:43], 0 offen sc1
    v_mul_f32 v142, 0xbb124925, v128
    v_mul_f32 v143, 0xbb124925, v132
    v_cvt_pk_bf16_f32 v128, v142, v142
    v_cvt_pk_bf16_f32 v132, v143, v143
    v_and_b32 v160, s70, v128
    v_and_b32 v161, s70, v128
    v_and_b32 v162, s70, v128
    v_and_b32 v163, s70, v128
    v_and_b32 v164, s70, v132
    v_and_b32 v165, s70, v132
    v_and_b32 v166, s70, v132
    v_and_b32 v167, s70, v132
    s_waitcnt lgkmcnt(15)
    v_mfma_f32_16x16x32_bf16 v[208:211], a[74:77], v[16:19], v[160:163]
    s_add_u32 m0, s47, 49152
    v_mfma_f32_16x16x32_bf16 v[212:215], a[72:75], v[16:19], v[160:163]
    v_mfma_f32_16x16x32_bf16 v[216:219], a[74:77], v[20:23], v[164:167]
    v_mfma_f32_16x16x32_bf16 v[220:223], a[72:75], v[20:23], v[164:167]
    v_mfma_f32_16x16x32_bf16 v[192:195], a[74:77], v[24:27], v[160:163]
    s_nop 2
    v_cvt_pk_bf16_f32 v16, v208, v209
    v_cvt_pk_bf16_f32 v17, v210, v211
    v_mfma_f32_16x16x32_bf16 v[196:199], a[72:75], v[24:27], v[160:163]
    v_cvt_pk_bf16_f32 v18, v212, v213
    v_cvt_pk_bf16_f32 v19, v214, v215
    v_mfma_f32_16x16x32_bf16 v[200:203], a[74:77], v[28:31], v[164:167]
    v_cvt_pk_bf16_f32 v20, v216, v217
    v_cvt_pk_bf16_f32 v21, v218, v219
    v_mfma_f32_16x16x32_bf16 v[204:207], a[72:75], v[28:31], v[164:167]
    v_cvt_pk_bf16_f32 v22, v220, v221
    v_cvt_pk_bf16_f32 v23, v222, v223
    v_mfma_f32_16x16x32_bf16 v[208:211], a[74:77], v[32:35], v[160:163]
    v_cvt_pk_bf16_f32 v24, v192, v193
    v_cvt_pk_bf16_f32 v25, v194, v195
    v_mfma_f32_16x16x32_bf16 v[212:215], a[72:75], v[32:35], v[160:163]
    v_cvt_pk_bf16_f32 v26, v196, v197
    v_cvt_pk_bf16_f32 v27, v198, v199
    v_mfma_f32_16x16x32_bf16 v[216:219], a[74:77], v[36:39], v[164:167]
    v_cvt_pk_bf16_f32 v28, v200, v201
    v_cvt_pk_bf16_f32 v29, v202, v203
    v_mfma_f32_16x16x32_bf16 v[220:223], a[72:75], v[36:39], v[164:167]
    v_cvt_pk_bf16_f32 v30, v204, v205
    v_cvt_pk_bf16_f32 v31, v206, v207
    v_mfma_f32_16x16x32_bf16 v[192:195], a[74:77], v[40:43], v[160:163]
    v_cvt_pk_bf16_f32 v32, v208, v209
    v_cvt_pk_bf16_f32 v33, v210, v211
    v_mfma_f32_16x16x32_bf16 v[196:199], a[72:75], v[40:43], v[160:163]
    v_cvt_pk_bf16_f32 v34, v212, v213
    v_cvt_pk_bf16_f32 v35, v214, v215
    v_mfma_f32_16x16x32_bf16 v[200:203], a[74:77], v[44:47], v[164:167]
    v_cvt_pk_bf16_f32 v36, v216, v217
    v_cvt_pk_bf16_f32 v37, v218, v219
    v_mfma_f32_16x16x32_bf16 v[204:207], a[72:75], v[44:47], v[164:167]
    v_cvt_pk_bf16_f32 v38, v220, v221
    v_cvt_pk_bf16_f32 v39, v222, v223
    v_mfma_f32_16x16x32_bf16 v[208:211], a[74:77], v[48:51], v[160:163]
    v_cvt_pk_bf16_f32 v40, v192, v193
    v_cvt_pk_bf16_f32 v41, v194, v195
    v_mfma_f32_16x16x32_bf16 v[212:215], a[72:75], v[48:51], v[160:163]
    v_cvt_pk_bf16_f32 v42, v196, v197
    v_cvt_pk_bf16_f32 v43, v198, v199
    v_mfma_f32_16x16x32_bf16 v[216:219], a[74:77], v[52:55], v[164:167]
    v_cvt_pk_bf16_f32 v44, v200, v201
    v_cvt_pk_bf16_f32 v45, v202, v203
    v_mfma_f32_16x16x32_bf16 v[220:223], a[72:75], v[52:55], v[164:167]
    v_cvt_pk_bf16_f32 v46, v204, v205
    v_cvt_pk_bf16_f32 v47, v206, v207
    v_mfma_f32_16x16x32_bf16 v[192:195], a[74:77], v[56:59], v[160:163]
    v_cvt_pk_bf16_f32 v48, v208, v209
    v_cvt_pk_bf16_f32 v49, v210, v211
    v_mfma_f32_16x16x32_bf16 v[196:199], a[72:75], v[56:59], v[160:163]
    v_cvt_pk_bf16_f32 v50, v212, v213
    v_cvt_pk_bf16_f32 v51, v214, v215
    v_mfma_f32_16x16x32_bf16 v[200:203], a[74:77], v[60:63], v[164:167]
    v_cvt_pk_bf16_f32 v52, v216, v217
    v_cvt_pk_bf16_f32 v53, v218, v219
    v_mfma_f32_16x16x32_bf16 v[204:207], a[72:75], v[60:63], v[164:167]
    v_cvt_pk_bf16_f32 v54, v220, v221
    s_waitcnt lgkmcnt(0)
    v_mfma_f32_16x16x32_bf16 v[208:211], a[74:77], v[64:67], v[160:163]
    s_waitcnt vmcnt(6)
    s_barrier
    ds_read_b64_tr_b16 a[0:1], v11 offset:0
    ds_read_b64_tr_b16 a[2:3], v11 offset:1024
    ds_read_b64_tr_b16 a[4:5], v12 offset:0
    ds_read_b64_tr_b16 a[6:7], v12 offset:1024
    ds_read_b64_tr_b16 a[8:9], v11 offset:256
    ds_read_b64_tr_b16 a[10:11], v11 offset:1280
    ds_read_b64_tr_b16 a[12:13], v12 offset:256
    ds_read_b64_tr_b16 a[14:15], v12 offset:1280
    v_mfma_f32_16x16x32_bf16 v[212:215], a[72:75], v[64:67], v[160:163]
    v_cvt_pk_bf16_f32 v55, v222, v223
    v_cvt_pk_bf16_f32 v56, v192, v193
    v_mfma_f32_16x16x32_bf16 v[216:219], a[74:77], v[68:71], v[164:167]
    ds_read_b64_tr_b16 a[16:17], v11 offset:512
    v_cvt_pk_bf16_f32 v57, v194, v195
    v_mfma_f32_16x16x32_bf16 v[220:223], a[72:75], v[68:71], v[164:167]
    ds_read_b64_tr_b16 a[18:19], v11 offset:1536
    v_cvt_pk_bf16_f32 v58, v196, v197
    v_mfma_f32_16x16x32_bf16 v[192:195], a[74:77], v[72:75], v[160:163]
    ds_read_b64_tr_b16 a[20:21], v12 offset:512
    v_cvt_pk_bf16_f32 v59, v198, v199
    v_mfma_f32_16x16x32_bf16 v[196:199], a[72:75], v[72:75], v[160:163]
    buffer_load_dwordx4 v6, s[24:27], 0 offen offset:0 lds
    ds_read_b64_tr_b16 a[22:23], v12 offset:1536
    v_cvt_pk_bf16_f32 v60, v200, v201
    v_cvt_pk_bf16_f32 v61, v202, v203
    v_mfma_f32_16x16x32_bf16 v[200:203], a[74:77], v[76:79], v[164:167]
    ds_read_b64_tr_b16 a[24:25], v11 offset:768
    v_cvt_pk_bf16_f32 v62, v204, v205
    v_cvt_pk_bf16_f32 v63, v206, v207
    v_mfma_f32_16x16x32_bf16 v[204:207], a[72:75], v[76:79], v[164:167]
    ds_read_b64_tr_b16 a[26:27], v11 offset:1792
    v_cvt_pk_bf16_f32 v64, v208, v209
    v_cvt_pk_bf16_f32 v65, v210, v211
    v_mfma_f32_16x16x32_bf16 v[208:211], a[74:77], v[80:83], v[160:163]
    buffer_load_dwordx4 v6, s[24:27], s77 offen offset:1024 lds
    ds_read_b64_tr_b16 a[28:29], v11 offset:2048
    v_cvt_pk_bf16_f32 v66, v212, v213
    v_cvt_pk_bf16_f32 v67, v214, v215
    v_mfma_f32_16x16x32_bf16 v[212:215], a[72:75], v[80:83], v[160:163]
    ds_read_b64_tr_b16 a[30:31], v11 offset:3072
    v_cvt_pk_bf16_f32 v68, v216, v217
    v_cvt_pk_bf16_f32 v69, v218, v219
    v_mfma_f32_16x16x32_bf16 v[216:219], a[74:77], v[84:87], v[164:167]
    buffer_load_dwordx4 v6, s[24:27], s78 offen offset:2048 lds
    v_cvt_pk_bf16_f32 v70, v220, v221
    v_cvt_pk_bf16_f32 v71, v222, v223
    v_mfma_f32_16x16x32_bf16 v[220:223], a[72:75], v[84:87], v[164:167]
    ds_read_b64_tr_b16 a[32:33], v12 offset:2048
    s_waitcnt lgkmcnt(5)
    v_mfma_f32_16x16x32_bf16 v[224:227], a[0:3], v[16:19], 0
    ds_read_b64_tr_b16 a[34:35], v12 offset:3072
    buffer_load_dwordx4 v6, s[24:27], s79 offen offset:3072 lds
    v_mfma_f32_16x16x32_bf16 v[228:231], a[0:3], v[20:23], 0
    ds_read_b64_tr_b16 a[36:37], v11 offset:2304
    v_add_u32 v6, 229376, v6
    v_mfma_f32_16x16x32_bf16 v[232:235], a[4:7], v[16:19], 0
    ds_read_b64_tr_b16 a[38:39], v11 offset:3328
    v_cvt_pk_bf16_f32 v72, v192, v193
    v_mfma_f32_16x16x32_bf16 v[236:239], a[4:7], v[20:23], 0
    ds_read_b64_tr_b16 a[40:41], v12 offset:2304
    s_add_u32 m0, s47, 65536
    v_mfma_f32_16x16x32_bf16 v[240:243], a[8:11], v[16:19], 0
    ds_read_b64_tr_b16 a[42:43], v12 offset:3328
    v_cvt_pk_bf16_f32 v73, v194, v195
    v_mfma_f32_16x16x32_bf16 v[244:247], a[8:11], v[20:23], 0
    ds_read_b64_tr_b16 a[44:45], v11 offset:2560
    buffer_load_dwordx4 v6, s[24:27], 0 offen offset:0 lds
    v_mfma_f32_16x16x32_bf16 v[248:251], a[12:15], v[16:19], 0
    ds_read_b64_tr_b16 a[46:47], v11 offset:3584
    buffer_load_dwordx4 v6, s[24:27], s77 offen offset:1024 lds
    v_mfma_f32_16x16x32_bf16 v[252:255], a[12:15], v[20:23], 0
    ds_read_b64_tr_b16 a[48:49], v12 offset:2560
    v_cvt_pk_bf16_f32 v74, v196, v197
    v_mfma_f32_16x16x32_bf16 v[192:195], a[74:77], v[88:91], v[160:163]
    ds_read_b64_tr_b16 a[50:51], v12 offset:3584
    v_cvt_pk_bf16_f32 v75, v198, v199
    v_mfma_f32_16x16x32_bf16 v[168:171], a[16:19], v[16:19], 0
    ds_read_b64_tr_b16 a[52:53], v11 offset:2816
    v_cvt_pk_bf16_f32 v76, v200, v201
    v_mfma_f32_16x16x32_bf16 v[172:175], a[16:19], v[20:23], 0
    ds_read_b64_tr_b16 a[54:55], v11 offset:3840
    buffer_load_dwordx4 v6, s[24:27], s78 offen offset:2048 lds
    v_mfma_f32_16x16x32_bf16 v[176:179], a[20:23], v[16:19], 0
    ds_read_b64_tr_b16 a[56:57], v11 offset:16384
    v_cvt_pk_bf16_f32 v77, v202, v203
    v_mfma_f32_16x16x32_bf16 v[180:183], a[20:23], v[20:23], 0
    ds_read_b64_tr_b16 a[58:59], v11 offset:17408
    s_waitcnt lgkmcnt(6)
    v_mfma_f32_16x16x32_bf16 v[184:187], a[24:27], v[16:19], 0
    ds_read_b64_tr_b16 a[0:1], v12 offset:16384
    v_cvt_pk_bf16_f32 v78, v204, v205
    v_mfma_f32_16x16x32_bf16 v[188:191], a[24:27], v[20:23], 0
    ds_read_b64_tr_b16 a[2:3], v12 offset:17408
    buffer_load_dwordx4 v6, s[24:27], s79 offen offset:3072 lds
    v_mfma_f32_16x16x32_bf16 v[224:227], a[28:31], v[24:27], v[224:227]
    ds_read_b64_tr_b16 a[4:5], v11 offset:16640
    v_add_u32 v6, 229376, v6
    v_mfma_f32_16x16x32_bf16 v[228:231], a[28:31], v[28:31], v[228:231]
    ds_read_b64_tr_b16 a[6:7], v11 offset:17664
    s_add_u32 m0, s47, 81920
    v_mfma_f32_16x16x32_bf16 v[196:199], a[72:75], v[88:91], v[160:163]
    ds_read_b64_tr_b16 a[8:9], v12 offset:16640
    v_cvt_pk_bf16_f32 v79, v206, v207
    v_mfma_f32_16x16x32_bf16 v[232:235], a[32:35], v[24:27], v[232:235]
    ds_read_b64_tr_b16 a[10:11], v12 offset:17664
    v_cvt_pk_bf16_f32 v80, v208, v209
    v_mfma_f32_16x16x32_bf16 v[236:239], a[32:35], v[28:31], v[236:239]
    ds_read_b64_tr_b16 a[12:13], v11 offset:16896
    buffer_load_dwordx4 v6, s[24:27], 0 offen offset:0 lds
    v_mfma_f32_16x16x32_bf16 v[240:243], a[36:39], v[24:27], v[240:243]
    ds_read_b64_tr_b16 a[14:15], v11 offset:17920
    v_cvt_pk_bf16_f32 v81, v210, v211
    v_mfma_f32_16x16x32_bf16 v[244:247], a[36:39], v[28:31], v[244:247]
    ds_read_b64_tr_b16 a[16:17], v12 offset:16896
    v_cvt_pk_bf16_f32 v82, v212, v213
    v_mfma_f32_16x16x32_bf16 v[248:251], a[40:43], v[24:27], v[248:251]
    ds_read_b64_tr_b16 a[18:19], v12 offset:17920
    v_cvt_pk_bf16_f32 v83, v214, v215
    v_mfma_f32_16x16x32_bf16 v[252:255], a[40:43], v[28:31], v[252:255]
    ds_read_b64_tr_b16 a[20:21], v11 offset:17152
    buffer_load_dwordx4 v6, s[24:27], s77 offen offset:1024 lds
    v_mfma_f32_16x16x32_bf16 v[168:171], a[44:47], v[24:27], v[168:171]
    ds_read_b64_tr_b16 a[22:23], v11 offset:18176
    v_cvt_pk_bf16_f32 v84, v216, v217
    v_mfma_f32_16x16x32_bf16 v[172:175], a[44:47], v[28:31], v[172:175]
    ds_read_b64_tr_b16 a[24:25], v11 offset:18432
    v_cvt_pk_bf16_f32 v85, v218, v219
    v_mfma_f32_16x16x32_bf16 v[200:203], a[74:77], v[92:95], v[164:167]
    ds_read_b64_tr_b16 a[26:27], v11 offset:19456
    s_waitcnt lgkmcnt(6)
    v_mfma_f32_16x16x32_bf16 v[176:179], a[48:51], v[24:27], v[176:179]
    ds_read_b64_tr_b16 a[28:29], v12 offset:18432
    buffer_load_dwordx4 v6, s[24:27], s78 offen offset:2048 lds
    v_mfma_f32_16x16x32_bf16 v[180:183], a[48:51], v[28:31], v[180:183]
    ds_read_b64_tr_b16 a[30:31], v12 offset:19456
    v_cvt_pk_bf16_f32 v86, v220, v221
    v_mfma_f32_16x16x32_bf16 v[184:187], a[52:55], v[24:27], v[184:187]
    ds_read_b64_tr_b16 a[32:33], v11 offset:18688
    v_cvt_pk_bf16_f32 v87, v222, v223
    v_mfma_f32_16x16x32_bf16 v[188:191], a[52:55], v[28:31], v[188:191]
    ds_read_b64_tr_b16 a[34:35], v11 offset:19712
    v_cvt_pk_bf16_f32 v88, v192, v193
    v_mfma_f32_16x16x32_bf16 v[224:227], a[56:59], v[32:35], v[224:227]
    ds_read_b64_tr_b16 a[36:37], v12 offset:18688
    s_waitcnt vmcnt(7)
    v_mfma_f32_16x16x32_bf16 v[228:231], a[56:59], v[36:39], v[228:231]
    ds_read_b64_tr_b16 a[38:39], v12 offset:19712
    s_barrier
    v_mfma_f32_16x16x32_bf16 v[232:235], a[0:3], v[32:35], v[232:235]
    ds_read_b64_tr_b16 a[40:41], v11 offset:18944
    buffer_load_dwordx4 v6, s[24:27], s79 offen offset:3072 lds
    v_mfma_f32_16x16x32_bf16 v[236:239], a[0:3], v[36:39], v[236:239]
    ds_read_b64_tr_b16 a[42:43], v11 offset:19968
    v_add_u32 v6, 229376, v6
    v_mfma_f32_16x16x32_bf16 v[204:207], a[72:75], v[92:95], v[164:167]
    ds_read_b64_tr_b16 a[44:45], v12 offset:18944
    s_add_u32 m0, s47, 98304
    v_mfma_f32_16x16x32_bf16 v[240:243], a[4:7], v[32:35], v[240:243]
    ds_read_b64_tr_b16 a[46:47], v12 offset:19968
    v_cvt_pk_bf16_f32 v89, v194, v195
    v_mfma_f32_16x16x32_bf16 v[244:247], a[4:7], v[36:39], v[244:247]
    ds_read_b64_tr_b16 a[48:49], v11 offset:19200
    v_cvt_pk_bf16_f32 v90, v196, v197
    v_mfma_f32_16x16x32_bf16 v[248:251], a[8:11], v[32:35], v[248:251]
    ds_read_b64_tr_b16 a[50:51], v11 offset:20224
    v_cvt_pk_bf16_f32 v91, v198, v199
    v_mfma_f32_16x16x32_bf16 v[252:255], a[8:11], v[36:39], v[252:255]
    ds_read_b64_tr_b16 a[52:53], v11 offset:32768
    buffer_load_dwordx4 v6, s[24:27], 0 offen offset:0 lds
    v_mfma_f32_16x16x32_bf16 v[168:171], a[12:15], v[32:35], v[168:171]
    ds_read_b64_tr_b16 a[54:55], v11 offset:33792
    v_accvgpr_read_b32 v140, a74
    v_mfma_f32_16x16x32_bf16 v[172:175], a[12:15], v[36:39], v[172:175]
    ds_read_b64_tr_b16 a[56:57], v12 offset:32768
    s_waitcnt lgkmcnt(6)
    v_mfma_f32_16x16x32_bf16 v[176:179], a[16:19], v[32:35], v[176:179]
    ds_read_b64_tr_b16 a[58:59], v12 offset:33792
    v_accvgpr_read_b32 v141, a75
    v_mfma_f32_16x16x32_bf16 v[180:183], a[16:19], v[36:39], v[180:183]
    ds_read_b64_tr_b16 a[0:1], v11 offset:33024
    v_lshlrev_b32 v136, 16, v140
    v_mfma_f32_16x16x32_bf16 v[208:211], a[74:77], v[96:99], v[160:163]
    ds_read_b64_tr_b16 a[2:3], v11 offset:34048
    buffer_load_dwordx4 v6, s[24:27], s77 offen offset:1024 lds
    v_mfma_f32_16x16x32_bf16 v[184:187], a[20:23], v[32:35], v[184:187]
    ds_read_b64_tr_b16 a[4:5], v12 offset:33024
    v_and_b32 v137, s70, v140
    v_mfma_f32_16x16x32_bf16 v[188:191], a[20:23], v[36:39], v[188:191]
    ds_read_b64_tr_b16 a[6:7], v12 offset:34048
    v_lshlrev_b32 v138, 16, v141
    v_mfma_f32_16x16x32_bf16 v[224:227], a[24:27], v[40:43], v[224:227]
    ds_read_b64_tr_b16 a[8:9], v11 offset:33280
    v_and_b32 v139, s70, v141
    v_mfma_f32_16x16x32_bf16 v[228:231], a[24:27], v[44:47], v[228:231]
    ds_read_b64_tr_b16 a[10:11], v11 offset:34304
    v_cvt_pk_bf16_f32 v92, v200, v201
    v_mfma_f32_16x16x32_bf16 v[232:235], a[28:31], v[40:43], v[232:235]
    ds_read_b64_tr_b16 a[12:13], v12 offset:33280
    buffer_load_dwordx4 v6, s[24:27], s78 offen offset:2048 lds
    v_mfma_f32_16x16x32_bf16 v[236:239], a[28:31], v[44:47], v[236:239]
    ds_read_b64_tr_b16 a[14:15], v12 offset:34304
    v_mul_f32 v144, v136, v144
    v_mfma_f32_16x16x32_bf16 v[240:243], a[32:35], v[40:43], v[240:243]
    ds_read_b64_tr_b16 a[16:17], v11 offset:33536
    v_cvt_pk_bf16_f32 v93, v202, v203
    v_mfma_f32_16x16x32_bf16 v[244:247], a[32:35], v[44:47], v[244:247]
    ds_read_b64_tr_b16 a[18:19], v11 offset:34560
    v_mul_f32 v148, v136, v148
    v_mfma_f32_16x16x32_bf16 v[212:215], a[72:75], v[96:99], v[160:163]
    ds_read_b64_tr_b16 a[20:21], v11 offset:34816
    v_fmac_f32 v144, v137, v145
    v_mfma_f32_16x16x32_bf16 v[248:251], a[36:39], v[40:43], v[248:251]
    ds_read_b64_tr_b16 a[22:23], v11 offset:35840
    buffer_load_dwordx4 v6, s[24:27], s79 offen offset:3072 lds
    v_mfma_f32_16x16x32_bf16 v[252:255], a[36:39], v[44:47], v[252:255]
    ds_read_b64_tr_b16 a[24:25], v12 offset:34816
    v_add_u32 v6, 229376, v6
    v_mfma_f32_16x16x32_bf16 v[168:171], a[40:43], v[40:43], v[168:171]
    ds_read_b64_tr_b16 a[26:27], v12 offset:35840
    s_lshl_b32 s0, s46, 13
    v_mfma_f32_16x16x32_bf16 v[172:175], a[40:43], v[44:47], v[172:175]
    ds_read_b64_tr_b16 a[28:29], v11 offset:35072
    s_waitcnt lgkmcnt(6)
    v_mfma_f32_16x16x32_bf16 v[176:179], a[44:47], v[40:43], v[176:179]
    ds_read_b64_tr_b16 a[30:31], v11 offset:36096
    s_add_u32 m0, s0, 131072
    v_mfma_f32_16x16x32_bf16 v[180:183], a[44:47], v[44:47], v[180:183]
    ds_read_b64_tr_b16 a[32:33], v12 offset:35072
    v_mfma_f32_16x16x32_bf16 v[216:219], a[74:77], v[100:103], v[164:167]
    ds_read_b64_tr_b16 a[34:35], v12 offset:36096
    buffer_store_dword v0, v15, s[36:39], s94 offen sc1
    v_mfma_f32_16x16x32_bf16 v[184:187], a[48:51], v[40:43], v[184:187]
    ds_read_b64_tr_b16 a[36:37], v11 offset:35328
    v_fmac_f32 v148, v137, v149
    v_mfma_f32_16x16x32_bf16 v[188:191], a[48:51], v[44:47], v[188:191]
    ds_read_b64_tr_b16 a[38:39], v11 offset:36352
    buffer_load_dwordx4 v5, s[16:19], 0 offen offset:0 lds
    v_mfma_f32_16x16x32_bf16 v[224:227], a[52:55], v[48:51], v[224:227]
    ds_read_b64_tr_b16 a[40:41], v12 offset:35328
    v_fmac_f32 v144, v138, v146
    v_mfma_f32_16x16x32_bf16 v[228:231], a[52:55], v[52:55], v[228:231]
    ds_read_b64_tr_b16 a[42:43], v12 offset:36352
    v_fmac_f32 v148, v138, v150
    v_mfma_f32_16x16x32_bf16 v[232:235], a[56:59], v[48:51], v[232:235]
    ds_read_b64_tr_b16 a[44:45], v11 offset:35584
    v_fmac_f32 v144, v139, v147
    v_mfma_f32_16x16x32_bf16 v[236:239], a[56:59], v[52:55], v[236:239]
    ds_read_b64_tr_b16 a[46:47], v11 offset:36608
    v_fmac_f32 v148, v139, v151
    v_mfma_f32_16x16x32_bf16 v[240:243], a[0:3], v[48:51], v[240:243]
    ds_read_b64_tr_b16 a[48:49], v11 offset:49152
    v_mov_b32 v145, v144
    v_mfma_f32_16x16x32_bf16 v[244:247], a[0:3], v[52:55], v[244:247]
    ds_read_b64_tr_b16 a[50:51], v11 offset:50176
    v_cvt_pk_bf16_f32 v94, v204, v205
    v_mfma_f32_16x16x32_bf16 v[220:223], a[72:75], v[100:103], v[164:167]
    ds_read_b64_tr_b16 a[52:53], v12 offset:49152
    v_mov_b32 v149, v148
    v_mfma_f32_16x16x32_bf16 v[248:251], a[4:7], v[48:51], v[248:251]
    ds_read_b64_tr_b16 a[54:55], v12 offset:50176
    v_cvt_pk_bf16_f32 v95, v206, v207
    v_mfma_f32_16x16x32_bf16 v[252:255], a[4:7], v[52:55], v[252:255]
    ds_read_b64_tr_b16 a[56:57], v11 offset:49408
    buffer_load_dwordx4 v5, s[16:19], s73 offen offset:1024 lds
    v_mfma_f32_16x16x32_bf16 v[168:171], a[8:11], v[48:51], v[168:171]
    v_permlane16_swap_b32 v144, v145
    v_mfma_f32_16x16x32_bf16 v[172:175], a[8:11], v[52:55], v[172:175]
    v_permlane16_swap_b32 v148, v149
    v_mfma_f32_16x16x32_bf16 v[176:179], a[12:15], v[48:51], v[176:179]
    ds_read_b64_tr_b16 a[58:59], v11 offset:50432
    v_add_f32 v144, v144, v145
    v_mfma_f32_16x16x32_bf16 v[180:183], a[12:15], v[52:55], v[180:183]
    ds_read_b64_tr_b16 a[0:1], v12 offset:49408
    s_waitcnt lgkmcnt(4)
    v_mfma_f32_16x16x32_bf16 v[184:187], a[16:19], v[48:51], v[184:187]
    ds_read_b64_tr_b16 a[2:3], v12 offset:50432
    v_add_f32 v148, v148, v149
    v_mfma_f32_16x16x32_bf16 v[188:191], a[16:19], v[52:55], v[188:191]
    ds_read_b64_tr_b16 a[4:5], v11 offset:49664
    v_mov_b32 v145, v144
    v_mfma_f32_16x16x32_bf16 v[192:195], a[74:77], v[104:107], v[160:163]
    ds_read_b64_tr_b16 a[6:7], v11 offset:50688
    v_mov_b32 v149, v148
    v_mfma_f32_16x16x32_bf16 v[224:227], a[20:23], v[56:59], v[224:227]
    ds_read_b64_tr_b16 a[8:9], v12 offset:49664
    v_cvt_pk_bf16_f32 v96, v208, v209
    v_mfma_f32_16x16x32_bf16 v[228:231], a[20:23], v[60:63], v[228:231]
    ds_read_b64_tr_b16 a[10:11], v12 offset:50688
    buffer_load_dwordx4 v5, s[16:19], s74 offen offset:2048 lds
    v_mfma_f32_16x16x32_bf16 v[232:235], a[24:27], v[56:59], v[232:235]
    ds_read_b64_tr_b16 a[12:13], v11 offset:49920
    ds_read_b64_tr_b16 a[14:15], v11 offset:50944
    v_mfma_f32_16x16x32_bf16 v[236:239], a[24:27], v[60:63], v[236:239]
    v_permlane32_swap_b32 v144, v145
    v_mfma_f32_16x16x32_bf16 v[240:243], a[28:31], v[56:59], v[240:243]
    ds_read_b64_tr_b16 a[16:17], v11 offset:51200
    v_cvt_pk_bf16_f32 v97, v210, v211
    v_mfma_f32_16x16x32_bf16 v[244:247], a[28:31], v[60:63], v[244:247]
    v_permlane32_swap_b32 v148, v149
    v_mfma_f32_16x16x32_bf16 v[248:251], a[32:35], v[56:59], v[248:251]
    ds_read_b64_tr_b16 a[18:19], v11 offset:52224
    v_add_f32 v144, v144, v145
    v_mfma_f32_16x16x32_bf16 v[252:255], a[32:35], v[60:63], v[252:255]
    ds_read_b64_tr_b16 a[20:21], v12 offset:51200
    v_add_f32 v148, v148, v149
    v_mfma_f32_16x16x32_bf16 v[196:199], a[72:75], v[104:107], v[160:163]
    ds_read_b64_tr_b16 a[22:23], v12 offset:52224
    v_mul_f32 v144, 0x3b124925, v144
    v_mfma_f32_16x16x32_bf16 v[168:171], a[36:39], v[56:59], v[168:171]
    ds_read_b64_tr_b16 a[24:25], v11 offset:51456
    v_cvt_pk_bf16_f32 v98, v212, v213
    v_mfma_f32_16x16x32_bf16 v[172:175], a[36:39], v[60:63], v[172:175]
    ds_read_b64_tr_b16 a[26:27], v11 offset:52480
    buffer_load_dwordx4 v5, s[16:19], s75 offen offset:3072 lds
    v_mfma_f32_16x16x32_bf16 v[176:179], a[40:43], v[56:59], v[176:179]
    ds_read_b64_tr_b16 a[28:29], v12 offset:51456
    v_add_u32 v5, 1048576, v5
    v_mfma_f32_16x16x32_bf16 v[180:183], a[40:43], v[60:63], v[180:183]
    ds_read_b64_tr_b16 a[30:31], v12 offset:52480
    s_add_u32 m0, s0, 135168
    v_mfma_f32_16x16x32_bf16 v[184:187], a[44:47], v[56:59], v[184:187]
    ds_read_b64_tr_b16 a[32:33], v11 offset:51712
    v_mul_f32 v148, 0x3b124925, v148
    v_mfma_f32_16x16x32_bf16 v[188:191], a[44:47], v[60:63], v[188:191]
    ds_read_b64_tr_b16 a[34:35], v11 offset:52736
    v_cvt_pk_bf16_f32 v99, v214, v215
    v_mfma_f32_16x16x32_bf16 v[224:227], a[48:51], v[64:67], v[224:227]
    ds_read_b64_tr_b16 a[36:37], v12 offset:51712
    s_waitcnt vmcnt(9)
    v_mfma_f32_16x16x32_bf16 v[228:231], a[48:51], v[68:71], v[228:231]
    ds_read_b64_tr_b16 a[38:39], v12 offset:52736
    v_add_u32 v12, 65536, v12
    v_mfma_f32_16x16x32_bf16 v[200:203], a[74:77], v[108:111], v[164:167]
    ds_read_b64_tr_b16 a[40:41], v11 offset:51968
    s_waitcnt lgkmcnt(6)
    v_mfma_f32_16x16x32_bf16 v[232:235], a[52:55], v[64:67], v[232:235]
    ds_read_b64_tr_b16 a[42:43], v11 offset:52992
    v_add_u32 v11, 65536, v11
    v_mfma_f32_16x16x32_bf16 v[236:239], a[52:55], v[68:71], v[236:239]
    s_barrier
    ds_read_b64_tr_b16 a[44:45], v11 offset:0
    v_mfma_f32_16x16x32_bf16 v[240:243], a[56:59], v[64:67], v[240:243]
    ds_read_b64_tr_b16 a[46:47], v11 offset:1024
    buffer_load_dwordx4 v5, s[16:19], 0 offen offset:0 lds
    v_mfma_f32_16x16x32_bf16 v[244:247], a[56:59], v[68:71], v[244:247]
    ds_read_b64_tr_b16 a[48:49], v12 offset:0
    v_fma_f32 v144, -v142, v142, v144
    v_mfma_f32_16x16x32_bf16 v[248:251], a[0:3], v[64:67], v[248:251]
    ds_read_b64_tr_b16 a[50:51], v12 offset:1024
    v_fma_f32 v148, -v143, v143, v148
    v_mfma_f32_16x16x32_bf16 v[252:255], a[0:3], v[68:71], v[252:255]
    v_max_f32 v144, 0, v144
    v_max_f32 v148, 0, v148
    v_mfma_f32_16x16x32_bf16 v[168:171], a[4:7], v[64:67], v[168:171]
    ds_read_b64_tr_b16 a[52:53], v11 offset:256
    v_mul_f32 v145, v142, v142
    v_mfma_f32_16x16x32_bf16 v[172:175], a[4:7], v[68:71], v[172:175]
    ds_read_b64_tr_b16 a[54:55], v11 offset:1280
    v_mul_f32 v149, v143, v143
    v_mfma_f32_16x16x32_bf16 v[204:207], a[72:75], v[108:111], v[164:167]
    ds_read_b64_tr_b16 a[56:57], v12 offset:256
    v_mul_f32 v146, 0x43800000, v144
    v_mfma_f32_16x16x32_bf16 v[176:179], a[8:11], v[64:67], v[176:179]
    ds_read_b64_tr_b16 a[58:59], v12 offset:1280
    v_mbcnt_lo_u32_b32 v0, -1, 0
    v_mfma_f32_16x16x32_bf16 v[180:183], a[8:11], v[68:71], v[180:183]
    ds_read_b64_tr_b16 a[0:1], v11 offset:512
    v_mul_f32 v150, 0x43800000, v148
    v_mfma_f32_16x16x32_bf16 v[184:187], a[12:15], v[64:67], v[184:187]
    ds_read_b64_tr_b16 a[2:3], v11 offset:1536
    buffer_load_dwordx4 v5, s[16:19], s73 offen offset:1024 lds
    v_mfma_f32_16x16x32_bf16 v[188:191], a[12:15], v[68:71], v[188:191]
    ds_read_b64_tr_b16 a[4:5], v12 offset:512
    v_mbcnt_hi_u32_b32 v0, -1, v0
    v_mfma_f32_16x16x32_bf16 v[224:227], a[16:19], v[72:75], v[224:227]
    ds_read_b64_tr_b16 a[6:7], v12 offset:1536
    v_cvt_pk_bf16_f32 v100, v216, v217
    v_mfma_f32_16x16x32_bf16 v[228:231], a[16:19], v[76:79], v[228:231]
    v_cmp_gt_f32 s[64:65], v145, v146
    v_cmp_gt_u32 s[96:97], 56, v0
    v_mfma_f32_16x16x32_bf16 v[232:235], a[20:23], v[72:75], v[232:235]
    ds_read_b64_tr_b16 a[8:9], v11 offset:768
    v_cvt_pk_bf16_f32 v101, v218, v219
    v_mfma_f32_16x16x32_bf16 v[236:239], a[20:23], v[76:79], v[236:239]
    ds_read_b64_tr_b16 a[10:11], v11 offset:1792
    v_cmp_gt_f32 vcc, v149, v150
    v_mfma_f32_16x16x32_bf16 v[208:211], a[74:77], v[112:115], v[160:163]
    ds_read_b64_tr_b16 a[12:13], v11 offset:2048
    v_mov_b32 v15, 2147418112
    v_mfma_f32_16x16x32_bf16 v[240:243], a[24:27], v[72:75], v[240:243]
    ds_read_b64_tr_b16 a[14:15], v11 offset:3072
    v_cvt_pk_bf16_f32 v144, v144, v144
    v_mfma_f32_16x16x32_bf16 v[244:247], a[24:27], v[76:79], v[244:247]
    ds_read_b64_tr_b16 a[16:17], v12 offset:2048
    s_waitcnt lgkmcnt(5)
    v_mfma_f32_16x16x32_bf16 v[248:251], a[28:31], v[72:75], v[248:251]
    ds_read_b64_tr_b16 a[18:19], v12 offset:3072
    buffer_load_dwordx4 v5, s[16:19], s74 offen offset:2048 lds
    v_mfma_f32_16x16x32_bf16 v[252:255], a[28:31], v[76:79], v[252:255]
    ds_read_b64_tr_b16 a[20:21], v11 offset:2304
    v_lshrrev_b32 v156, 2, v0
    v_mfma_f32_16x16x32_bf16 v[168:171], a[32:35], v[72:75], v[168:171]
    ds_read_b64_tr_b16 a[22:23], v11 offset:3328
    v_cvt_pk_bf16_f32 v148, v148, v148
    v_mfma_f32_16x16x32_bf16 v[172:175], a[32:35], v[76:79], v[172:175]
L_PAD1:
    s_cbranch_execz L_PAD5
    v_and_b32 v0, 3, v0
    s_or_b64 s[64:65], s[64:65], vcc
    v_mfma_f32_16x16x32_bf16 v[212:215], a[72:75], v[112:115], v[160:163]
    ds_read_b64_tr_b16 a[24:25], v12 offset:2304
    v_mul_u32_u24 v156, 896, v156
    v_mfma_f32_16x16x32_bf16 v[176:179], a[36:39], v[72:75], v[176:179]
    ds_read_b64_tr_b16 a[26:27], v12 offset:3328
    v_and_b32 v144, s70, v144
    v_mfma_f32_16x16x32_bf16 v[180:183], a[36:39], v[76:79], v[180:183]
    ds_read_b64_tr_b16 a[28:29], v11 offset:2560
    v_lshl_add_u32 v0, v0, 6, v156
    v_mfma_f32_16x16x32_bf16 v[184:187], a[40:43], v[72:75], v[184:187]
    ds_read_b64_tr_b16 a[30:31], v11 offset:3584
    v_add_u32 v5, 786432, v5
    v_mfma_f32_16x16x32_bf16 v[188:191], a[40:43], v[76:79], v[188:191]
    ds_read_b64_tr_b16 a[32:33], v12 offset:2560
    v_and_b32 v148, s70, v148
    v_mfma_f32_16x16x32_bf16 v[224:227], a[44:47], v[80:83], v[224:227]
    ds_read_b64_tr_b16 a[34:35], v12 offset:3584
    v_cndmask_b32 v0, v15, v0, s[96:97]
    v_mfma_f32_16x16x32_bf16 v[228:231], a[44:47], v[84:87], v[228:231]
    ds_read_b64_tr_b16 a[36:37], v11 offset:2816
    s_add_u32 m0, s0, 0
    v_mfma_f32_16x16x32_bf16 v[232:235], a[48:51], v[80:83], v[232:235]
    ds_read_b64_tr_b16 a[38:39], v11 offset:3840
    v_add_f32 v144, 0x3727c5ac, v144
    v_mfma_f32_16x16x32_bf16 v[236:239], a[48:51], v[84:87], v[236:239]
    v_add_f32 v148, 0x3727c5ac, v148
    v_cvt_pk_bf16_f32 v102, v220, v221
    v_mfma_f32_16x16x32_bf16 v[216:219], a[74:77], v[116:119], v[164:167]
    ds_read_b64_tr_b16 a[40:41], v11 offset:16384
    buffer_load_dwordx4 v5, s[16:19], 0 offen offset:0 lds
    v_mfma_f32_16x16x32_bf16 v[240:243], a[52:55], v[80:83], v[240:243]
    ds_read_b64_tr_b16 a[42:43], v11 offset:17408
    v_cvt_pk_bf16_f32 v144, v144, v144
    v_mfma_f32_16x16x32_bf16 v[244:247], a[52:55], v[84:87], v[244:247]
    ds_read_b64_tr_b16 a[44:45], v12 offset:16384
    v_cvt_pk_bf16_f32 v103, v222, v223
    v_mfma_f32_16x16x32_bf16 v[248:251], a[56:59], v[80:83], v[248:251]
    ds_read_b64_tr_b16 a[46:47], v12 offset:17408
    v_cvt_pk_bf16_f32 v148, v148, v148
    v_mfma_f32_16x16x32_bf16 v[252:255], a[56:59], v[84:87], v[252:255]
    ds_read_b64_tr_b16 a[48:49], v11 offset:16640
    v_and_b32 v144, s70, v144
    v_mfma_f32_16x16x32_bf16 v[168:171], a[0:3], v[80:83], v[168:171]
    ds_read_b64_tr_b16 a[50:51], v11 offset:17664
    v_and_b32 v148, s70, v148
    v_mfma_f32_16x16x32_bf16 v[172:175], a[0:3], v[84:87], v[172:175]
    v_sqrt_f32 v144, v144
    v_mfma_f32_16x16x32_bf16 v[176:179], a[4:7], v[80:83], v[176:179]
    ds_read_b64_tr_b16 a[52:53], v12 offset:16640
    buffer_load_dwordx4 v5, s[16:19], s73 offen offset:1024 lds
    v_mfma_f32_16x16x32_bf16 v[180:183], a[4:7], v[84:87], v[180:183]
    v_sqrt_f32 v148, v148
    v_mfma_f32_16x16x32_bf16 v[220:223], a[72:75], v[116:119], v[164:167]
    ds_read_b64_tr_b16 a[54:55], v12 offset:17664
    s_waitcnt lgkmcnt(4)
    v_mfma_f32_16x16x32_bf16 v[184:187], a[8:11], v[80:83], v[184:187]
    ds_read_b64_tr_b16 a[56:57], v11 offset:16896
    v_cvt_pk_bf16_f32 v144, v144, v144
    v_mfma_f32_16x16x32_bf16 v[188:191], a[8:11], v[84:87], v[188:191]
    ds_read_b64_tr_b16 a[58:59], v11 offset:17920
    v_cvt_pk_bf16_f32 v104, v192, v193
    v_mfma_f32_16x16x32_bf16 v[224:227], a[12:15], v[88:91], v[224:227]
    ds_read_b64_tr_b16 a[0:1], v12 offset:16896
    v_cvt_pk_bf16_f32 v148, v148, v148
    v_mfma_f32_16x16x32_bf16 v[228:231], a[12:15], v[92:95], v[228:231]
    ds_read_b64_tr_b16 a[2:3], v12 offset:17920
    v_cvt_pk_bf16_f32 v105, v194, v195
    v_mfma_f32_16x16x32_bf16 v[232:235], a[16:19], v[88:91], v[232:235]
    ds_read_b64_tr_b16 a[4:5], v11 offset:17152
    v_and_b32 v144, s70, v144
    v_mfma_f32_16x16x32_bf16 v[236:239], a[16:19], v[92:95], v[236:239]
    ds_read_b64_tr_b16 a[6:7], v11 offset:18176
    buffer_load_dwordx4 v5, s[16:19], s74 offen offset:2048 lds
    v_mfma_f32_16x16x32_bf16 v[240:243], a[20:23], v[88:91], v[240:243]
    ds_read_b64_tr_b16 a[8:9], v11 offset:18432
    v_and_b32 v148, s70, v148
    v_mfma_f32_16x16x32_bf16 v[244:247], a[20:23], v[92:95], v[244:247]
    v_rcp_f32 v144, v144
    v_mfma_f32_16x16x32_bf16 v[192:195], a[74:77], v[120:123], v[160:163]
    v_rcp_f32 v148, v148
    v_mfma_f32_16x16x32_bf16 v[248:251], a[24:27], v[88:91], v[248:251]
    ds_read_b64_tr_b16 a[10:11], v11 offset:19456
    v_mul_f32 v144, 0x3db8aa3b, v144
    v_mfma_f32_16x16x32_bf16 v[252:255], a[24:27], v[92:95], v[252:255]
    ds_read_b64_tr_b16 a[12:13], v12 offset:18432
    buffer_load_dwordx4 v5, s[16:19], s75 offen offset:3072 lds
    v_mfma_f32_16x16x32_bf16 v[168:171], a[28:31], v[88:91], v[168:171]
    ds_read_b64_tr_b16 a[14:15], v12 offset:19456
    v_mul_f32 v148, 0x3db8aa3b, v148
    v_mfma_f32_16x16x32_bf16 v[172:175], a[28:31], v[92:95], v[172:175]
    ds_read_b64_tr_b16 a[16:17], v11 offset:18688
    v_cvt_pk_bf16_f32 v106, v196, v197
    v_mfma_f32_16x16x32_bf16 v[176:179], a[32:35], v[88:91], v[176:179]
    ds_read_b64_tr_b16 a[18:19], v11 offset:19712
    v_accvgpr_write_b32 a78, v144
    v_mfma_f32_16x16x32_bf16 v[180:183], a[32:35], v[92:95], v[180:183]
    ds_read_b64_tr_b16 a[20:21], v12 offset:18688
    v_cvt_pk_bf16_f32 v107, v198, v199
    v_mfma_f32_16x16x32_bf16 v[184:187], a[36:39], v[88:91], v[184:187]
    ds_read_b64_tr_b16 a[22:23], v12 offset:19712
    v_add_u32 v5, 1048576, v5
    v_mfma_f32_16x16x32_bf16 v[188:191], a[36:39], v[92:95], v[188:191]
    ds_read_b64_tr_b16 a[24:25], v11 offset:18944
    v_accvgpr_write_b32 a84, v148
    v_mfma_f32_16x16x32_bf16 v[196:199], a[72:75], v[120:123], v[160:163]
    s_add_u32 m0, s0, 4096
    ds_read_b64_tr_b16 a[26:27], v11 offset:19968
    v_mfma_f32_16x16x32_bf16 v[224:227], a[40:43], v[96:99], v[224:227]
    ds_read_b64_tr_b16 a[28:29], v12 offset:18944
    buffer_load_dwordx4 v5, s[16:19], 0 offen offset:0 lds
    v_mfma_f32_16x16x32_bf16 v[228:231], a[40:43], v[100:103], v[228:231]
    ds_read_b64_tr_b16 a[30:31], v12 offset:19968
    s_waitcnt vmcnt(13)
    v_mfma_f32_16x16x32_bf16 v[232:235], a[44:47], v[96:99], v[232:235]
    ds_read_b64_tr_b16 a[32:33], v11 offset:19200
    s_barrier
    v_mfma_f32_16x16x32_bf16 v[236:239], a[44:47], v[100:103], v[236:239]
    ds_read_b64_tr_b16 a[34:35], v11 offset:20224
    s_waitcnt lgkmcnt(6)
    v_mfma_f32_16x16x32_bf16 v[240:243], a[48:51], v[96:99], v[240:243]
    ds_read_b64_tr_b16 a[36:37], v11 offset:32768
    v_cvt_pk_bf16_f32 v108, v200, v201
    v_mfma_f32_16x16x32_bf16 v[244:247], a[48:51], v[100:103], v[244:247]
    ds_read_b64_tr_b16 a[38:39], v11 offset:33792
    v_cvt_pk_bf16_f32 v109, v202, v203
    v_mfma_f32_16x16x32_bf16 v[248:251], a[52:55], v[96:99], v[248:251]
    ds_read_b64_tr_b16 a[40:41], v11 offset:34816
    buffer_load_dwordx4 v5, s[16:19], s73 offen offset:1024 lds
    v_mfma_f32_16x16x32_bf16 v[252:255], a[52:55], v[100:103], v[252:255]
    ds_read_b64_tr_b16 a[42:43], v11 offset:35840
    v_cvt_pk_bf16_f32 v110, v204, v205
    v_mfma_f32_16x16x32_bf16 v[200:203], a[74:77], v[124:127], v[164:167]
    ds_read_b64_tr_b16 a[44:45], v12 offset:32768
    buffer_load_dwordx4 v5, s[16:19], s74 offen offset:2048 lds
    v_mfma_f32_16x16x32_bf16 v[168:171], a[56:59], v[96:99], v[168:171]
    ds_read_b64_tr_b16 a[46:47], v12 offset:33792
    v_cvt_pk_bf16_f32 v111, v206, v207
    v_mfma_f32_16x16x32_bf16 v[172:175], a[56:59], v[100:103], v[172:175]
    ds_read_b64_tr_b16 a[48:49], v12 offset:34816
    v_subrev_u32 v5, 2883456, v5
    v_mfma_f32_16x16x32_bf16 v[176:179], a[0:3], v[96:99], v[176:179]
    ds_read_b64_tr_b16 a[50:51], v12 offset:35840
    v_cvt_pk_bf16_f32 v112, v208, v209
    v_mfma_f32_16x16x32_bf16 v[180:183], a[0:3], v[100:103], v[180:183]
    ds_read_b64_tr_b16 a[52:53], v11 offset:33024
    v_and_b32 v5, 0xfffffdff, v5
    v_mfma_f32_16x16x32_bf16 v[184:187], a[4:7], v[96:99], v[184:187]
    ds_read_b64_tr_b16 a[54:55], v11 offset:34048
    v_cvt_pk_bf16_f32 v113, v210, v211
    v_mfma_f32_16x16x32_bf16 v[188:191], a[4:7], v[100:103], v[188:191]
    ds_read_b64_tr_b16 a[56:57], v11 offset:35072
    s_add_u32 m0, s0, 32768
    v_mfma_f32_16x16x32_bf16 v[204:207], a[72:75], v[124:127], v[164:167]
    ds_read_b64_tr_b16 a[58:59], v11 offset:36096
    v_cvt_pk_bf16_f32 v114, v212, v213
    v_mfma_f32_16x16x32_bf16 v[224:227], a[8:11], v[104:107], v[224:227]
    ds_read_b64_tr_b16 a[0:1], v12 offset:33024
    v_cvt_pk_bf16_f32 v115, v214, v215
    v_mfma_f32_16x16x32_bf16 v[228:231], a[8:11], v[108:111], v[228:231]
    ds_read_b64_tr_b16 a[2:3], v12 offset:34048
    buffer_load_dwordx4 v5, s[16:19], 0 offen offset:0 lds
    v_mfma_f32_16x16x32_bf16 v[232:235], a[12:15], v[104:107], v[232:235]
    ds_read_b64_tr_b16 a[4:5], v12 offset:35072
    v_cvt_pk_bf16_f32 v116, v216, v217
    v_mfma_f32_16x16x32_bf16 v[236:239], a[12:15], v[108:111], v[236:239]
    ds_read_b64_tr_b16 a[6:7], v12 offset:36096
    v_cvt_pk_bf16_f32 v117, v218, v219
    v_mfma_f32_16x16x32_bf16 v[240:243], a[16:19], v[104:107], v[240:243]
    ds_read_b64_tr_b16 a[8:9], v11 offset:33280
    v_cvt_pk_bf16_f32 v118, v220, v221
    v_mfma_f32_16x16x32_bf16 v[244:247], a[16:19], v[108:111], v[244:247]
    ds_read_b64_tr_b16 a[10:11], v11 offset:34304
    v_cvt_pk_bf16_f32 v119, v222, v223
    v_mfma_f32_16x16x32_bf16 v[248:251], a[20:23], v[104:107], v[248:251]
    ds_read_b64_tr_b16 a[12:13], v11 offset:35328
    buffer_load_dwordx4 v5, s[16:19], s73 offen offset:1024 lds
    v_mfma_f32_16x16x32_bf16 v[252:255], a[20:23], v[108:111], v[252:255]
    ds_read_b64_tr_b16 a[14:15], v11 offset:36352
    s_waitcnt lgkmcnt(6)
    v_mfma_f32_16x16x32_bf16 v[168:171], a[24:27], v[104:107], v[168:171]
    ds_read_b64_tr_b16 a[16:17], v12 offset:33280
    v_cvt_pk_bf16_f32 v120, v192, v193
    v_mfma_f32_16x16x32_bf16 v[172:175], a[24:27], v[108:111], v[172:175]
    ds_read_b64_tr_b16 a[18:19], v12 offset:34304
    v_cvt_pk_bf16_f32 v121, v194, v195
    v_mfma_f32_16x16x32_bf16 v[176:179], a[28:31], v[104:107], v[176:179]
    buffer_load_dwordx4 v5, s[16:19], s74 offen offset:2048 lds
    ds_read_b64_tr_b16 a[20:21], v12 offset:35328
    v_mfma_f32_16x16x32_bf16 v[180:183], a[28:31], v[108:111], v[180:183]
    ds_read_b64_tr_b16 a[22:23], v12 offset:36352
    v_cvt_pk_bf16_f32 v122, v196, v197
    v_mfma_f32_16x16x32_bf16 v[184:187], a[32:35], v[104:107], v[184:187]
    ds_read_b64_tr_b16 a[24:25], v11 offset:33536
    v_cvt_pk_bf16_f32 v123, v198, v199
    v_mfma_f32_16x16x32_bf16 v[188:191], a[32:35], v[108:111], v[188:191]
    ds_read_b64_tr_b16 a[26:27], v11 offset:34560
    v_cvt_pk_bf16_f32 v124, v200, v201
    v_mfma_f32_16x16x32_bf16 v[224:227], a[36:39], v[112:115], v[224:227]
    buffer_load_dwordx4 v5, s[16:19], s75 offen offset:3072 lds
    v_add_u32 v5, 1048576, v5
    v_mfma_f32_16x16x32_bf16 v[228:231], a[36:39], v[116:119], v[228:231]
    v_cvt_pk_bf16_f32 v125, v202, v203
    v_cvt_pk_bf16_f32 v126, v204, v205
    v_cvt_pk_bf16_f32 v127, v206, v207
    s_add_u32 m0, s0, 36864
    v_mfma_f32_16x16x32_bf16 v[224:227], a[40:43], v[120:123], v[224:227]
    s_waitcnt vmcnt(11)
    s_barrier
    v_mfma_f32_16x16x32_bf16 v[228:231], a[40:43], v[124:127], v[228:231]
    buffer_load_dwordx4 v5, s[16:19], 0 offen offset:0 lds
    ds_read_b64_tr_b16 a[28:29], v11 offset:35584
    v_mfma_f32_16x16x32_bf16 v[232:235], a[44:47], v[112:115], v[232:235]
    ds_read_b64_tr_b16 a[30:31], v11 offset:36608
    buffer_load_dwordx4 v5, s[16:19], s73 offen offset:1024 lds
    v_mfma_f32_16x16x32_bf16 v[236:239], a[44:47], v[116:119], v[236:239]
    buffer_load_dwordx4 v5, s[16:19], s74 offen offset:2048 lds
    v_add_u32 v3, 131072, v3
    v_mfma_f32_16x16x32_bf16 v[232:235], a[48:51], v[120:123], v[232:235]
    ds_read_b64_tr_b16 a[32:33], v3 offset:0
    v_add_u32 v4, 131072, v4
    v_mfma_f32_16x16x32_bf16 v[236:239], a[48:51], v[124:127], v[236:239]
    ds_read_b64_tr_b16 a[34:35], v3 offset:16384
    v_add_u32 v5, 786432, v5
    v_mfma_f32_16x16x32_bf16 v[240:243], a[52:55], v[112:115], v[240:243]
    ds_read_b64_tr_b16 a[36:37], v4 offset:0
    s_add_u32 m0, s0, 65536
    v_mfma_f32_16x16x32_bf16 v[244:247], a[52:55], v[116:119], v[244:247]
    ds_read_b64_tr_b16 a[38:39], v4 offset:16384
    s_lshr_b32 s1, s68, 2
    v_mfma_f32_16x16x32_bf16 v[240:243], a[56:59], v[120:123], v[240:243]
    ds_read_b64_tr_b16 a[40:41], v3 offset:256
    s_and_b32 s1, s1, 1
    v_mfma_f32_16x16x32_bf16 v[244:247], a[56:59], v[124:127], v[244:247]
    ds_read_b64_tr_b16 a[42:43], v3 offset:16640
    s_mul_i32 s1, s1, 14336
    v_mfma_f32_16x16x32_bf16 v[248:251], a[0:3], v[112:115], v[248:251]
    ds_read_b64_tr_b16 a[44:45], v4 offset:256
    buffer_load_dwordx4 v5, s[16:19], 0 offen offset:0 lds
    v_mfma_f32_16x16x32_bf16 v[252:255], a[0:3], v[116:119], v[252:255]
    ds_read_b64_tr_b16 a[46:47], v4 offset:16640
    s_waitcnt lgkmcnt(6)
    v_mfma_f32_16x16x32_bf16 v[248:251], a[4:7], v[120:123], v[248:251]
    ds_read_b64_tr_b16 a[48:49], v3 offset:1024
    s_add_u32 s1, s1, s72
    v_mfma_f32_16x16x32_bf16 v[252:255], a[4:7], v[124:127], v[252:255]
    ds_read_b64_tr_b16 a[50:51], v3 offset:17408
    s_cmp_lg_u64 s[64:65], 0
    s_cbranch_scc1 L_REVAR
L_VAROK:
    v_mfma_f32_16x16x32_bf16 v[168:171], a[8:11], v[112:115], v[168:171]
    ds_read_b64_tr_b16 a[52:53], v4 offset:1024
    s_mov_b32 s98, 0x41800000
    v_mfma_f32_16x16x32_bf16 v[172:175], a[8:11], v[116:119], v[172:175]
    ds_read_b64_tr_b16 a[54:55], v4 offset:17408
    v_mbcnt_lo_u32_b32 v7, -1, 0
    v_mfma_f32_16x16x32_bf16 v[168:171], a[12:15], v[120:123], v[168:171]
    ds_read_b64_tr_b16 a[56:57], v3 offset:1280
    v_mbcnt_hi_u32_b32 v7, -1, v7
    v_mfma_f32_16x16x32_bf16 v[172:175], a[12:15], v[124:127], v[172:175]
    ds_read_b64_tr_b16 a[58:59], v3 offset:17664
    buffer_load_dwordx4 v5, s[16:19], s73 offen offset:1024 lds
    v_mfma_f32_16x16x32_bf16 v[176:179], a[16:19], v[112:115], v[176:179]
    ds_read_b64_tr_b16 a[0:1], v4 offset:1280
    v_lshlrev_b32 v7, 4, v7
    v_mfma_f32_16x16x32_bf16 v[180:183], a[16:19], v[116:119], v[180:183]
    ds_read_b64_tr_b16 a[2:3], v4 offset:17664
    s_lshl_b32 s94, s44, 4
    v_mfma_f32_16x16x32_bf16 v[176:179], a[20:23], v[120:123], v[176:179]
    ds_read_b64_tr_b16 a[4:5], v3 offset:2048
    v_mov_b32 v14, s94
    v_mfma_f32_16x16x32_bf16 v[180:183], a[20:23], v[124:127], v[180:183]
    ds_read_b64_tr_b16 a[6:7], v3 offset:18432
    v_and_b32 v13, 0xf0, v7
    v_mfma_f32_16x16x32_bf16 v[184:187], a[24:27], v[112:115], v[184:187]
    ds_read_b64_tr_b16 a[8:9], v4 offset:2048
    v_lshlrev_b32 v13, 3, v13
    v_mfma_f32_16x16x32_bf16 v[188:191], a[24:27], v[116:119], v[188:191]
    ds_read_b64_tr_b16 a[10:11], v4 offset:18432
    s_add_u32 s94, s92, 4096
    v_mfma_f32_16x16x32_bf16 v[184:187], a[28:31], v[120:123], v[184:187]
    ds_read_b64_tr_b16 a[12:13], v3 offset:2304
    v_cvt_pk_bf16_f32 v128, v224, v225
    v_mfma_f32_16x16x32_bf16 v[188:191], a[28:31], v[124:127], v[188:191]
    ds_read_b64_tr_b16 a[14:15], v3 offset:18688
    buffer_load_dwordx4 v5, s[16:19], s74 offen offset:2048 lds
    v_mfma_f32_16x16x32_bf16 v[192:195], a[32:35], v[16:19], 0
    ds_read_b64_tr_b16 a[16:17], v4 offset:2304
    v_cvt_pk_bf16_f32 v129, v226, v227
    v_mfma_f32_16x16x32_bf16 v[196:199], a[32:35], v[20:23], 0
    ds_read_b64_tr_b16 a[18:19], v4 offset:18688
    s_waitcnt lgkmcnt(6)
    v_mfma_f32_16x16x32_bf16 v[200:203], a[36:39], v[16:19], 0
    ds_read_b64_tr_b16 a[20:21], v3 offset:3072
    v_cvt_pk_bf16_f32 v130, v232, v233
    v_mfma_f32_16x16x32_bf16 v[204:207], a[36:39], v[20:23], 0
    ds_read_b64_tr_b16 a[22:23], v3 offset:19456
    v_cvt_pk_bf16_f32 v131, v234, v235
    v_mfma_f32_16x16x32_bf16 v[208:211], a[40:43], v[16:19], 0
    ds_read_b64_tr_b16 a[24:25], v4 offset:3072
    v_pk_max_i16 v128, v128, 0
    v_mfma_f32_16x16x32_bf16 v[212:215], a[40:43], v[20:23], 0
    ds_read_b64_tr_b16 a[26:27], v4 offset:19456
    v_pk_max_i16 v129, v129, 0
    v_mfma_f32_16x16x32_bf16 v[216:219], a[44:47], v[16:19], 0
    ds_read_b64_tr_b16 a[28:29], v3 offset:3328
    buffer_load_dwordx4 v5, s[16:19], s75 offen offset:3072 lds
    v_mfma_f32_16x16x32_bf16 v[220:223], a[44:47], v[20:23], 0
    ds_read_b64_tr_b16 a[30:31], v3 offset:19712
    v_add_u32 v5, 1048576, v5
    v_mfma_f32_16x16x32_bf16 v[192:195], a[48:51], v[24:27], v[192:195]
    ds_read_b64_tr_b16 a[32:33], v4 offset:3328
    s_add_u32 m0, s0, 69632
    v_mfma_f32_16x16x32_bf16 v[196:199], a[48:51], v[28:31], v[196:199]
    ds_read_b64_tr_b16 a[34:35], v4 offset:19712
    v_pk_max_i16 v130, v130, 0
    v_mfma_f32_16x16x32_bf16 v[200:203], a[52:55], v[24:27], v[200:203]
    ds_read_b64_tr_b16 a[36:37], v3 offset:4096
    v_pk_max_i16 v131, v131, 0
    v_mfma_f32_16x16x32_bf16 v[204:207], a[52:55], v[28:31], v[204:207]
    ds_read_b64_tr_b16 a[38:39], v3 offset:20480
    v_cvt_pk_bf16_f32 v132, v228, v229
    v_mfma_f32_16x16x32_bf16 v[208:211], a[56:59], v[24:27], v[208:211]
    ds_read_b64_tr_b16 a[40:41], v4 offset:4096
    v_cvt_pk_bf16_f32 v133, v230, v231
    v_mfma_f32_16x16x32_bf16 v[212:215], a[56:59], v[28:31], v[212:215]
    ds_read_b64_tr_b16 a[42:43], v4 offset:20480
    v_cvt_pk_bf16_f32 v134, v236, v237
    v_mfma_f32_16x16x32_bf16 v[216:219], a[0:3], v[24:27], v[216:219]
    ds_read_b64_tr_b16 a[44:45], v3 offset:4352
    buffer_load_dwordx4 v5, s[16:19], 0 offen offset:0 lds
    v_mfma_f32_16x16x32_bf16 v[220:223], a[0:3], v[28:31], v[220:223]
    ds_read_b64_tr_b16 a[46:47], v3 offset:20736
    v_cvt_pk_bf16_f32 v135, v238, v239
    v_mfma_f32_16x16x32_bf16 v[192:195], a[4:7], v[32:35], v[192:195]
    ds_read_b64_tr_b16 a[48:49], v4 offset:4352
    v_pk_max_i16 v132, v132, 0
    v_mfma_f32_16x16x32_bf16 v[196:199], a[4:7], v[36:39], v[196:199]
    ds_read_b64_tr_b16 a[50:51], v4 offset:20736
    s_waitcnt lgkmcnt(6)
    v_mfma_f32_16x16x32_bf16 v[200:203], a[8:11], v[32:35], v[200:203]
    ds_read_b64_tr_b16 a[52:53], v3 offset:5120
    v_pk_max_i16 v133, v133, 0
    v_mfma_f32_16x16x32_bf16 v[204:207], a[8:11], v[36:39], v[204:207]
    ds_read_b64_tr_b16 a[54:55], v3 offset:21504
    v_pk_max_i16 v134, v134, 0
    v_mfma_f32_16x16x32_bf16 v[208:211], a[12:15], v[32:35], v[208:211]
    ds_read_b64_tr_b16 a[56:57], v4 offset:5120
    v_pk_max_i16 v135, v135, 0
    v_mfma_f32_16x16x32_bf16 v[212:215], a[12:15], v[36:39], v[212:215]
    ds_read_b64_tr_b16 a[58:59], v4 offset:21504
    buffer_load_dwordx4 v5, s[16:19], s73 offen offset:1024 lds
    v_mfma_f32_16x16x32_bf16 v[216:219], a[16:19], v[32:35], v[216:219]
    ds_read_b64_tr_b16 a[0:1], v3 offset:5376
    v_cvt_pk_bf16_f32 v136, v240, v241
    v_mfma_f32_16x16x32_bf16 v[220:223], a[16:19], v[36:39], v[220:223]
    ds_read_b64_tr_b16 a[2:3], v3 offset:21760
    v_cvt_pk_bf16_f32 v137, v242, v243
    v_mfma_f32_16x16x32_bf16 v[192:195], a[20:23], v[40:43], v[192:195]
    ds_read_b64_tr_b16 a[4:5], v4 offset:5376
    s_waitcnt vmcnt(13)
    v_mfma_f32_16x16x32_bf16 v[196:199], a[20:23], v[44:47], v[196:199]
    ds_read_b64_tr_b16 a[6:7], v4 offset:21760
    s_barrier
    v_mfma_f32_16x16x32_bf16 v[200:203], a[24:27], v[40:43], v[200:203]
    ds_read_b64_tr_b16 a[8:9], v3 offset:6144
    v_cvt_pk_bf16_f32 v138, v248, v249
    v_mfma_f32_16x16x32_bf16 v[204:207], a[24:27], v[44:47], v[204:207]
    ds_read_b64_tr_b16 a[10:11], v3 offset:22528
    v_cvt_pk_bf16_f32 v139, v250, v251
    v_mfma_f32_16x16x32_bf16 v[208:211], a[28:31], v[40:43], v[208:211]
    ds_read_b64_tr_b16 a[12:13], v4 offset:6144
    v_pk_max_i16 v136, v136, 0
    v_mfma_f32_16x16x32_bf16 v[212:215], a[28:31], v[44:47], v[212:215]
    ds_read_b64_tr_b16 a[14:15], v4 offset:22528
    buffer_load_dwordx4 v5, s[16:19], s74 offen offset:2048 lds
    v_mfma_f32_16x16x32_bf16 v[216:219], a[32:35], v[40:43], v[216:219]
    ds_read_b64_tr_b16 a[16:17], v3 offset:6400
    v_subrev_u32 v5, 2883456, v5
    v_mfma_f32_16x16x32_bf16 v[220:223], a[32:35], v[44:47], v[220:223]
    ds_read_b64_tr_b16 a[18:19], v3 offset:22784
    v_subrev_u32 v3, 131072, v3
    v_mfma_f32_16x16x32_bf16 v[192:195], a[36:39], v[48:51], v[192:195]
    ds_read_b64_tr_b16 a[20:21], v4 offset:6400
    v_and_b32 v5, 0xfffffdff, v5
    v_mfma_f32_16x16x32_bf16 v[196:199], a[36:39], v[52:55], v[196:199]
    ds_read_b64_tr_b16 a[22:23], v4 offset:22784
    s_waitcnt lgkmcnt(6)
    v_mfma_f32_16x16x32_bf16 v[200:203], a[40:43], v[48:51], v[200:203]
    ds_read_b64_tr_b16 a[24:25], v3 offset:0
    v_subrev_u32 v4, 131072, v4
    v_mfma_f32_16x16x32_bf16 v[204:207], a[40:43], v[52:55], v[204:207]
    ds_read_b64_tr_b16 a[26:27], v3 offset:16384
    s_add_u32 m0, s0, 98304
    v_mfma_f32_16x16x32_bf16 v[208:211], a[44:47], v[48:51], v[208:211]
    ds_read_b64_tr_b16 a[28:29], v4 offset:0
    v_pk_max_i16 v137, v137, 0
    v_mfma_f32_16x16x32_bf16 v[212:215], a[44:47], v[52:55], v[212:215]
    ds_read_b64_tr_b16 a[30:31], v4 offset:16384
    v_pk_max_i16 v138, v138, 0
    v_mfma_f32_16x16x32_bf16 v[216:219], a[48:51], v[48:51], v[216:219]
    ds_read_b64_tr_b16 a[32:33], v3 offset:256
    v_pk_max_i16 v139, v139, 0
    v_mfma_f32_16x16x32_bf16 v[220:223], a[48:51], v[52:55], v[220:223]
    ds_read_b64_tr_b16 a[34:35], v3 offset:16640
    v_cvt_pk_bf16_f32 v140, v244, v245
    v_mfma_f32_16x16x32_bf16 v[192:195], a[52:55], v[56:59], v[192:195]
    ds_read_b64_tr_b16 a[36:37], v4 offset:256
    buffer_load_dwordx4 v5, s[16:19], 0 offen offset:0 lds
    v_mfma_f32_16x16x32_bf16 v[196:199], a[52:55], v[60:63], v[196:199]
    ds_read_b64_tr_b16 a[38:39], v4 offset:16640
    v_cvt_pk_bf16_f32 v141, v246, v247
    v_mfma_f32_16x16x32_bf16 v[200:203], a[56:59], v[56:59], v[200:203]
    ds_read_b64_tr_b16 a[40:41], v3 offset:1024
    v_cvt_pk_bf16_f32 v142, v252, v253
    v_mfma_f32_16x16x32_bf16 v[204:207], a[56:59], v[60:63], v[204:207]
    ds_read_b64_tr_b16 a[42:43], v3 offset:17408
    v_cvt_pk_bf16_f32 v143, v254, v255
    v_mfma_f32_16x16x32_bf16 v[208:211], a[0:3], v[56:59], v[208:211]
    ds_read_b64_tr_b16 a[44:45], v4 offset:1024
    v_pk_max_i16 v140, v140, 0
    v_mfma_f32_16x16x32_bf16 v[212:215], a[0:3], v[60:63], v[212:215]
    ds_read_b64_tr_b16 a[46:47], v4 offset:17408
    v_pk_max_i16 v141, v141, 0
    v_mfma_f32_16x16x32_bf16 v[216:219], a[4:7], v[56:59], v[216:219]
    ds_read_b64_tr_b16 a[48:49], v3 offset:1280
    v_pk_max_i16 v142, v142, 0
    v_mfma_f32_16x16x32_bf16 v[220:223], a[4:7], v[60:63], v[220:223]
    ds_read_b64_tr_b16 a[50:51], v3 offset:17664
    buffer_load_dwordx4 v5, s[16:19], s73 offen offset:1024 lds
    v_mfma_f32_16x16x32_bf16 v[192:195], a[8:11], v[64:67], v[192:195]
    ds_read_b64_tr_b16 a[52:53], v4 offset:1280
    v_pk_max_i16 v143, v143, 0
    v_mfma_f32_16x16x32_bf16 v[196:199], a[8:11], v[68:71], v[196:199]
    ds_read_b64_tr_b16 a[54:55], v4 offset:17664
    s_waitcnt lgkmcnt(6)
    v_mfma_f32_16x16x32_bf16 v[200:203], a[12:15], v[64:67], v[200:203]
    ds_read_b64_tr_b16 a[56:57], v3 offset:2048
    v_cvt_pk_bf16_f32 v144, v168, v169
    v_mfma_f32_16x16x32_bf16 v[204:207], a[12:15], v[68:71], v[204:207]
    ds_read_b64_tr_b16 a[58:59], v3 offset:18432
    v_cvt_pk_bf16_f32 v145, v170, v171
    v_mfma_f32_16x16x32_bf16 v[208:211], a[16:19], v[64:67], v[208:211]
    ds_read_b64_tr_b16 a[0:1], v4 offset:2048
    v_cvt_pk_bf16_f32 v146, v176, v177
    v_mfma_f32_16x16x32_bf16 v[212:215], a[16:19], v[68:71], v[212:215]
    ds_read_b64_tr_b16 a[2:3], v4 offset:18432
    v_cvt_pk_bf16_f32 v147, v178, v179
    v_mfma_f32_16x16x32_bf16 v[216:219], a[20:23], v[64:67], v[216:219]
    ds_read_b64_tr_b16 a[4:5], v3 offset:2304
    v_pk_max_i16 v144, v144, 0
    v_mfma_f32_16x16x32_bf16 v[220:223], a[20:23], v[68:71], v[220:223]
    ds_read_b64_tr_b16 a[6:7], v3 offset:18688
    buffer_load_dwordx4 v5, s[16:19], s74 offen offset:2048 lds
    v_mfma_f32_16x16x32_bf16 v[192:195], a[24:27], v[72:75], v[192:195]
    ds_read_b64_tr_b16 a[8:9], v4 offset:2304
    v_pk_max_i16 v145, v145, 0
    v_mfma_f32_16x16x32_bf16 v[196:199], a[24:27], v[76:79], v[196:199]
    ds_read_b64_tr_b16 a[10:11], v4 offset:18688
    v_pk_max_i16 v146, v146, 0
    v_mfma_f32_16x16x32_bf16 v[200:203], a[28:31], v[72:75], v[200:203]
    ds_read_b64_tr_b16 a[12:13], v3 offset:3072
    v_pk_max_i16 v147, v147, 0
    v_mfma_f32_16x16x32_bf16 v[204:207], a[28:31], v[76:79], v[204:207]
    ds_read_b64_tr_b16 a[14:15], v3 offset:19456
    v_cvt_pk_bf16_f32 v148, v172, v173
    v_mfma_f32_16x16x32_bf16 v[208:211], a[32:35], v[72:75], v[208:211]
    ds_read_b64_tr_b16 a[16:17], v4 offset:3072
    v_cvt_pk_bf16_f32 v149, v174, v175
    v_mfma_f32_16x16x32_bf16 v[212:215], a[32:35], v[76:79], v[212:215]
    ds_read_b64_tr_b16 a[18:19], v4 offset:19456
    v_cvt_pk_bf16_f32 v150, v180, v181
    v_mfma_f32_16x16x32_bf16 v[216:219], a[36:39], v[72:75], v[216:219]
    ds_read_b64_tr_b16 a[20:21], v3 offset:3328
    buffer_load_dwordx4 v5, s[16:19], s75 offen offset:3072 lds
    v_mfma_f32_16x16x32_bf16 v[220:223], a[36:39], v[76:79], v[220:223]
    ds_read_b64_tr_b16 a[22:23], v3 offset:19712
    v_add_u32 v5, 1048576, v5
    v_mfma_f32_16x16x32_bf16 v[192:195], a[40:43], v[80:83], v[192:195]
    ds_read_b64_tr_b16 a[24:25], v4 offset:3328
    s_add_u32 m0, s0, 102400
    v_mfma_f32_16x16x32_bf16 v[196:199], a[40:43], v[84:87], v[196:199]
    ds_read_b64_tr_b16 a[26:27], v4 offset:19712
    s_waitcnt lgkmcnt(6)
    v_mfma_f32_16x16x32_bf16 v[200:203], a[44:47], v[80:83], v[200:203]
    ds_read_b64_tr_b16 a[28:29], v3 offset:4096
    v_cvt_pk_bf16_f32 v151, v182, v183
    v_mfma_f32_16x16x32_bf16 v[204:207], a[44:47], v[84:87], v[204:207]
    ds_read_b64_tr_b16 a[30:31], v3 offset:20480
    v_pk_max_i16 v148, v148, 0
    v_mfma_f32_16x16x32_bf16 v[208:211], a[48:51], v[80:83], v[208:211]
    ds_read_b64_tr_b16 a[32:33], v4 offset:4096
    v_pk_max_i16 v149, v149, 0
    v_mfma_f32_16x16x32_bf16 v[212:215], a[48:51], v[84:87], v[212:215]
    ds_read_b64_tr_b16 a[34:35], v4 offset:20480
    v_pk_max_i16 v150, v150, 0
    v_mfma_f32_16x16x32_bf16 v[216:219], a[52:55], v[80:83], v[216:219]
    ds_read_b64_tr_b16 a[36:37], v3 offset:4352
    buffer_load_dwordx4 v5, s[16:19], 0 offen offset:0 lds
    v_mfma_f32_16x16x32_bf16 v[220:223], a[52:55], v[84:87], v[220:223]
    ds_read_b64_tr_b16 a[38:39], v3 offset:20736
    v_pk_max_i16 v151, v151, 0
    v_mfma_f32_16x16x32_bf16 v[192:195], a[56:59], v[88:91], v[192:195]
    ds_read_b64_tr_b16 a[40:41], v4 offset:4352
    v_cvt_pk_bf16_f32 v152, v184, v185
    v_mfma_f32_16x16x32_bf16 v[196:199], a[56:59], v[92:95], v[196:199]
    ds_read_b64_tr_b16 a[42:43], v4 offset:20736
    v_cvt_pk_bf16_f32 v153, v186, v187
    v_mfma_f32_16x16x32_bf16 v[200:203], a[0:3], v[88:91], v[200:203]
    ds_read_b64_tr_b16 a[44:45], v3 offset:5120
    v_cvt_pk_bf16_f32 v154, v188, v189
    v_mfma_f32_16x16x32_bf16 v[204:207], a[0:3], v[92:95], v[204:207]
    ds_read_b64_tr_b16 a[46:47], v3 offset:21504
    v_cvt_pk_bf16_f32 v155, v190, v191
    v_mfma_f32_16x16x32_bf16 v[208:211], a[4:7], v[88:91], v[208:211]
    ds_read_b64_tr_b16 a[48:49], v4 offset:5120
    v_pk_max_i16 v152, v152, 0
    v_mfma_f32_16x16x32_bf16 v[212:215], a[4:7], v[92:95], v[212:215]
    ds_read_b64_tr_b16 a[50:51], v4 offset:21504
    buffer_load_dwordx4 v5, s[16:19], s73 offen offset:1024 lds
    v_mfma_f32_16x16x32_bf16 v[216:219], a[8:11], v[88:91], v[216:219]
    ds_read_b64_tr_b16 a[52:53], v3 offset:5376
    v_pk_max_i16 v153, v153, 0
    v_mfma_f32_16x16x32_bf16 v[220:223], a[8:11], v[92:95], v[220:223]
    ds_read_b64_tr_b16 a[54:55], v3 offset:21760
    v_pk_max_i16 v154, v154, 0
    v_mfma_f32_16x16x32_bf16 v[192:195], a[12:15], v[96:99], v[192:195]
    ds_read_b64_tr_b16 a[56:57], v4 offset:5376
    s_waitcnt vmcnt(13)
    v_mfma_f32_16x16x32_bf16 v[196:199], a[12:15], v[100:103], v[196:199]
L_PAD2:
    s_cbranch_execz L_PAD6
    ds_read_b64_tr_b16 a[58:59], v4 offset:21760
    s_waitcnt lgkmcnt(6)
    v_mfma_f32_16x16x32_bf16 v[200:203], a[16:19], v[96:99], v[200:203]
    ds_read_b64_tr_b16 a[0:1], v3 offset:6144
    s_barrier
    v_mfma_f32_16x16x32_bf16 v[204:207], a[16:19], v[100:103], v[204:207]
    ds_read_b64_tr_b16 a[2:3], v3 offset:22528
    v_pk_max_i16 v155, v155, 0
    v_mfma_f32_16x16x32_bf16 v[208:211], a[20:23], v[96:99], v[208:211]
    buffer_store_dwordx4 v[128:131], v7, s[40:43], s92 offen offset:0 sc1
    ds_read_b64_tr_b16 a[4:5], v4 offset:6144
    v_mfma_f32_16x16x32_bf16 v[212:215], a[20:23], v[100:103], v[212:215]
    ds_read_b64_tr_b16 a[6:7], v4 offset:22528
    buffer_load_dwordx4 v5, s[16:19], s74 offen offset:2048 lds
    v_mfma_f32_16x16x32_bf16 v[216:219], a[24:27], v[96:99], v[216:219]
    ds_read_b64_tr_b16 a[8:9], v3 offset:6400
    v_add_u32 v5, 786432, v5
    v_mfma_f32_16x16x32_bf16 v[220:223], a[24:27], v[100:103], v[220:223]
    buffer_store_dwordx4 v[132:135], v7, s[40:43], s92 offen offset:1024 sc1
    ds_read_b64_tr_b16 a[10:11], v3 offset:22784
    v_mfma_f32_16x16x32_bf16 v[192:195], a[28:31], v[104:107], v[192:195]
    ds_read_b64_tr_b16 a[12:13], v4 offset:6400
    s_add_u32 m0, s0, 131072
    v_mfma_f32_16x16x32_bf16 v[196:199], a[28:31], v[108:111], v[196:199]
    ds_read_b64_tr_b16 a[14:15], v4 offset:22784
    v_accvgpr_read_b32 v11, a78
    v_mfma_f32_16x16x32_bf16 v[200:203], a[32:35], v[104:107], v[200:203]
    buffer_store_dwordx4 v[136:139], v7, s[40:43], s92 offen offset:2048 sc1
    ds_read_b64_tr_b16 a[16:17], v3 offset:32768
    v_mfma_f32_16x16x32_bf16 v[204:207], a[32:35], v[108:111], v[204:207]
    ds_read_b64_tr_b16 a[18:19], v3 offset:49152
    v_accvgpr_read_b32 v12, a84
    v_mfma_f32_16x16x32_bf16 v[208:211], a[36:39], v[104:107], v[208:211]
    ds_read_b64_tr_b16 a[20:21], v4 offset:32768
    v_mfma_f32_16x16x32_bf16 v[212:215], a[36:39], v[108:111], v[212:215]
    buffer_store_dwordx4 v[140:143], v7, s[40:43], s92 offen offset:3072 sc1
    ds_read_b64_tr_b16 a[22:23], v4 offset:49152
    v_mfma_f32_16x16x32_bf16 v[216:219], a[40:43], v[104:107], v[216:219]
    ds_read_b64_tr_b16 a[24:25], v3 offset:33024
    v_mfma_f32_16x16x32_bf16 v[220:223], a[40:43], v[108:111], v[220:223]
    ds_read_b64_tr_b16 a[26:27], v3 offset:49408
    v_mfma_f32_16x16x32_bf16 v[192:195], a[44:47], v[112:115], v[192:195]
    buffer_store_dwordx4 v[144:147], v7, s[40:43], s94 offen offset:0 sc1
    ds_read_b64_tr_b16 a[28:29], v4 offset:33024
    v_mfma_f32_16x16x32_bf16 v[196:199], a[44:47], v[116:119], v[196:199]
    ds_read_b64_tr_b16 a[30:31], v4 offset:49408
    s_waitcnt lgkmcnt(6)
    v_mfma_f32_16x16x32_bf16 v[200:203], a[48:51], v[112:115], v[200:203]
    ds_read_b64_tr_b16 a[32:33], v3 offset:33792
    buffer_load_dwordx4 v5, s[16:19], 0 offen offset:0 lds
    v_mfma_f32_16x16x32_bf16 v[204:207], a[48:51], v[116:119], v[204:207]
    buffer_store_dwordx4 v[148:151], v7, s[40:43], s94 offen offset:1024 sc1
    ds_read_b64_tr_b16 a[34:35], v3 offset:50176
    v_mfma_f32_16x16x32_bf16 v[208:211], a[52:55], v[112:115], v[208:211]
    ds_read_b64_tr_b16 a[36:37], v4 offset:33792
    v_mfma_f32_16x16x32_bf16 v[212:215], a[52:55], v[116:119], v[212:215]
    ds_read_b64_tr_b16 a[38:39], v4 offset:50176
    v_mfma_f32_16x16x32_bf16 v[216:219], a[56:59], v[112:115], v[216:219]
    buffer_store_dwordx4 v[152:155], v7, s[40:43], s94 offen offset:2048 sc1
    ds_read_b64_tr_b16 a[40:41], v3 offset:34048
    v_mfma_f32_16x16x32_bf16 v[220:223], a[56:59], v[116:119], v[220:223]
    ds_read_b64_tr_b16 a[42:43], v3 offset:50432
    buffer_load_dwordx4 v5, s[16:19], s73 offen offset:1024 lds
    v_mfma_f32_16x16x32_bf16 v[192:195], a[0:3], v[120:123], v[192:195]
    ds_read_b64_tr_b16 a[44:45], v4 offset:34048
    v_mfma_f32_16x16x32_bf16 v[196:199], a[0:3], v[124:127], v[196:199]
    ds_read_b64_tr_b16 a[46:47], v4 offset:50432
    v_mfma_f32_16x16x32_bf16 v[200:203], a[4:7], v[120:123], v[200:203]
    ds_read_b64_tr_b16 a[48:49], v3 offset:34816
    v_mfma_f32_16x16x32_bf16 v[204:207], a[4:7], v[124:127], v[204:207]
    ds_read_b64_tr_b16 a[50:51], v3 offset:51200
    v_mfma_f32_16x16x32_bf16 v[208:211], a[8:11], v[120:123], v[208:211]
    ds_read_b64_tr_b16 a[52:53], v4 offset:34816
    v_mfma_f32_16x16x32_bf16 v[212:215], a[8:11], v[124:127], v[212:215]
    ds_read_b64_tr_b16 a[54:55], v4 offset:51200
    v_mul_f32 v192, v11, v192
    v_mfma_f32_16x16x32_bf16 v[216:219], a[12:15], v[120:123], v[216:219]
    ds_read_b64_tr_b16 a[56:57], v3 offset:35072
    buffer_load_dword v10, v14, s[36:39], 0 offen sc1
    v_mfma_f32_16x16x32_bf16 v[220:223], a[12:15], v[124:127], v[220:223]
    ds_read_b64_tr_b16 a[58:59], v3 offset:51456
    buffer_load_dwordx4 v5, s[16:19], s74 offen offset:2048 lds
    v_mfma_f32_16x16x32_bf16 v[224:227], a[16:19], v[16:19], 0
    ds_read_b64_tr_b16 a[0:1], v4 offset:35072
    v_mul_f32 v193, v11, v193
    v_mfma_f32_16x16x32_bf16 v[228:231], a[16:19], v[20:23], 0
    ds_read_b64_tr_b16 a[2:3], v4 offset:51456
    s_waitcnt lgkmcnt(6)
    v_mfma_f32_16x16x32_bf16 v[232:235], a[20:23], v[16:19], 0
    ds_read_b64_tr_b16 a[4:5], v3 offset:35840
    v_mul_f32 v194, v11, v194
    v_mfma_f32_16x16x32_bf16 v[236:239], a[20:23], v[20:23], 0
    ds_read_b64_tr_b16 a[6:7], v3 offset:52224
    v_mul_f32 v195, v11, v195
    v_mfma_f32_16x16x32_bf16 v[240:243], a[24:27], v[16:19], 0
    ds_read_b64_tr_b16 a[8:9], v4 offset:35840
    v_cvt_pk_bf16_f32 v128, v192, v193
    v_mfma_f32_16x16x32_bf16 v[244:247], a[24:27], v[20:23], 0
    ds_read_b64_tr_b16 a[10:11], v4 offset:52224
    v_cvt_pk_bf16_f32 v129, v194, v195
    v_mfma_f32_16x16x32_bf16 v[248:251], a[28:31], v[16:19], 0
    ds_read_b64_tr_b16 a[12:13], v3 offset:36096
    buffer_load_dwordx4 v5, s[16:19], s75 offen offset:3072 lds
    v_mfma_f32_16x16x32_bf16 v[252:255], a[28:31], v[20:23], 0
    ds_read_b64_tr_b16 a[14:15], v3 offset:52480
    v_add_u32 v5, 1048576, v5
    v_mfma_f32_16x16x32_bf16 v[224:227], a[32:35], v[24:27], v[224:227]
    ds_read_b64_tr_b16 a[16:17], v4 offset:36096
    s_add_u32 m0, s0, 135168
    v_mfma_f32_16x16x32_bf16 v[228:231], a[32:35], v[28:31], v[228:231]
    ds_read_b64_tr_b16 a[18:19], v4 offset:52480
    v_mul_f32 v200, v11, v200
    v_mfma_f32_16x16x32_bf16 v[232:235], a[36:39], v[24:27], v[232:235]
    ds_read_b64_tr_b16 a[20:21], v3 offset:36864
    v_mul_f32 v201, v11, v201
    v_mfma_f32_16x16x32_bf16 v[236:239], a[36:39], v[28:31], v[236:239]
    ds_read_b64_tr_b16 a[22:23], v3 offset:53248
    v_mul_f32 v202, v11, v202
    v_mfma_f32_16x16x32_bf16 v[240:243], a[40:43], v[24:27], v[240:243]
    ds_read_b64_tr_b16 a[24:25], v4 offset:36864
    v_mul_f32 v203, v11, v203
    v_mfma_f32_16x16x32_bf16 v[244:247], a[40:43], v[28:31], v[244:247]
    ds_read_b64_tr_b16 a[26:27], v4 offset:53248
    v_cvt_pk_bf16_f32 v130, v200, v201
    v_mfma_f32_16x16x32_bf16 v[248:251], a[44:47], v[24:27], v[248:251]
    ds_read_b64_tr_b16 a[28:29], v3 offset:37120
    buffer_load_dwordx4 v5, s[16:19], 0 offen offset:0 lds
    v_mfma_f32_16x16x32_bf16 v[252:255], a[44:47], v[28:31], v[252:255]
    ds_read_b64_tr_b16 a[30:31], v3 offset:53504
    v_cvt_pk_bf16_f32 v131, v202, v203
    v_mfma_f32_16x16x32_bf16 v[224:227], a[48:51], v[32:35], v[224:227]
    ds_read_b64_tr_b16 a[32:33], v4 offset:37120
    v_mul_f32 v196, v12, v196
    v_mfma_f32_16x16x32_bf16 v[228:231], a[48:51], v[36:39], v[228:231]
    ds_read_b64_tr_b16 a[34:35], v4 offset:53504
    s_waitcnt lgkmcnt(6)
    v_mfma_f32_16x16x32_bf16 v[232:235], a[52:55], v[32:35], v[232:235]
    ds_read_b64_tr_b16 a[36:37], v3 offset:37888
    v_mul_f32 v197, v12, v197
    v_mfma_f32_16x16x32_bf16 v[236:239], a[52:55], v[36:39], v[236:239]
    ds_read_b64_tr_b16 a[38:39], v3 offset:54272
    v_mul_f32 v198, v12, v198
    v_mfma_f32_16x16x32_bf16 v[240:243], a[56:59], v[32:35], v[240:243]
    ds_read_b64_tr_b16 a[40:41], v4 offset:37888
    v_mul_f32 v199, v12, v199
    v_mfma_f32_16x16x32_bf16 v[244:247], a[56:59], v[36:39], v[244:247]
    ds_read_b64_tr_b16 a[42:43], v4 offset:54272
    buffer_load_dwordx4 v5, s[16:19], s73 offen offset:1024 lds
    v_mfma_f32_16x16x32_bf16 v[248:251], a[0:3], v[32:35], v[248:251]
    ds_read_b64_tr_b16 a[44:45], v3 offset:38144
    v_cvt_pk_bf16_f32 v132, v196, v197
    v_mfma_f32_16x16x32_bf16 v[252:255], a[0:3], v[36:39], v[252:255]
    ds_read_b64_tr_b16 a[46:47], v3 offset:54528
    v_cvt_pk_bf16_f32 v133, v198, v199
    v_mfma_f32_16x16x32_bf16 v[224:227], a[4:7], v[40:43], v[224:227]
    ds_read_b64_tr_b16 a[48:49], v4 offset:38144
    s_waitcnt vmcnt(21)
    v_mfma_f32_16x16x32_bf16 v[228:231], a[4:7], v[44:47], v[228:231]
    ds_read_b64_tr_b16 a[50:51], v4 offset:54528
    s_barrier
    v_mfma_f32_16x16x32_bf16 v[232:235], a[8:11], v[40:43], v[232:235]
    ds_read_b64_tr_b16 a[52:53], v3 offset:38912
    v_mul_f32 v204, v12, v204
    v_mfma_f32_16x16x32_bf16 v[236:239], a[8:11], v[44:47], v[236:239]
    ds_read_b64_tr_b16 a[54:55], v3 offset:55296
    v_mul_f32 v205, v12, v205
    v_mfma_f32_16x16x32_bf16 v[240:243], a[12:15], v[40:43], v[240:243]
    ds_read_b64_tr_b16 a[56:57], v4 offset:38912
    v_mul_f32 v206, v12, v206
    v_mfma_f32_16x16x32_bf16 v[244:247], a[12:15], v[44:47], v[244:247]
    ds_read_b64_tr_b16 a[58:59], v4 offset:55296
    buffer_load_dwordx4 v5, s[16:19], s74 offen offset:2048 lds
    v_mfma_f32_16x16x32_bf16 v[248:251], a[16:19], v[40:43], v[248:251]
    ds_read_b64_tr_b16 a[0:1], v3 offset:39168
    v_subrev_u32 v5, 2883456, v5
    v_mfma_f32_16x16x32_bf16 v[252:255], a[16:19], v[44:47], v[252:255]
    ds_read_b64_tr_b16 a[2:3], v3 offset:55552
    v_add_u32 v3, 65536, v3
    v_mfma_f32_16x16x32_bf16 v[224:227], a[20:23], v[48:51], v[224:227]
    ds_read_b64_tr_b16 a[4:5], v4 offset:39168
    v_and_b32 v5, 0xfffffdff, v5
    v_mfma_f32_16x16x32_bf16 v[228:231], a[20:23], v[52:55], v[228:231]
    ds_read_b64_tr_b16 a[6:7], v4 offset:55552
    s_waitcnt lgkmcnt(6)
    v_mfma_f32_16x16x32_bf16 v[232:235], a[24:27], v[48:51], v[232:235]
    ds_read_b64_tr_b16 a[8:9], v3 offset:0
    v_add_u32 v4, 65536, v4
    v_mfma_f32_16x16x32_bf16 v[236:239], a[24:27], v[52:55], v[236:239]
    ds_read_b64_tr_b16 a[10:11], v3 offset:16384
    s_add_u32 m0, s0, 0
    v_mfma_f32_16x16x32_bf16 v[240:243], a[28:31], v[48:51], v[240:243]
    ds_read_b64_tr_b16 a[12:13], v4 offset:0
    v_mul_f32 v207, v12, v207
    v_mfma_f32_16x16x32_bf16 v[244:247], a[28:31], v[52:55], v[244:247]
    ds_read_b64_tr_b16 a[14:15], v4 offset:16384
    v_cvt_pk_bf16_f32 v134, v204, v205
    v_mfma_f32_16x16x32_bf16 v[248:251], a[32:35], v[48:51], v[248:251]
    ds_read_b64_tr_b16 a[16:17], v3 offset:256
    v_cvt_pk_bf16_f32 v135, v206, v207
    v_mfma_f32_16x16x32_bf16 v[252:255], a[32:35], v[52:55], v[252:255]
    v_permlane16_swap_b32 v128, v130
    v_mfma_f32_16x16x32_bf16 v[224:227], a[36:39], v[56:59], v[224:227]
    ds_read_b64_tr_b16 a[18:19], v3 offset:16640
    buffer_load_dwordx4 v5, s[16:19], 0 offen offset:0 lds
    v_mfma_f32_16x16x32_bf16 v[228:231], a[36:39], v[60:63], v[228:231]
    v_permlane16_swap_b32 v129, v131
    v_mfma_f32_16x16x32_bf16 v[232:235], a[40:43], v[56:59], v[232:235]
    v_permlane16_swap_b32 v132, v134
    v_mfma_f32_16x16x32_bf16 v[236:239], a[40:43], v[60:63], v[236:239]
    v_permlane16_swap_b32 v133, v135
    v_mfma_f32_16x16x32_bf16 v[240:243], a[44:47], v[56:59], v[240:243]
    ds_read_b64_tr_b16 a[20:21], v4 offset:256
    ds_read_b64_tr_b16 a[22:23], v4 offset:16640
    v_mfma_f32_16x16x32_bf16 v[244:247], a[44:47], v[60:63], v[244:247]
    v_mul_f32 v208, v11, v208
    v_mul_f32 v209, v11, v209
    v_mfma_f32_16x16x32_bf16 v[248:251], a[48:51], v[56:59], v[248:251]
    ds_read_b64_tr_b16 a[24:25], v3 offset:1024
    ds_read_b64_tr_b16 a[26:27], v3 offset:17408
    v_mfma_f32_16x16x32_bf16 v[252:255], a[48:51], v[60:63], v[252:255]
    v_mul_f32 v210, v11, v210
    v_mul_f32 v211, v11, v211
    v_mfma_f32_16x16x32_bf16 v[224:227], a[52:55], v[64:67], v[224:227]
    ds_read_b64_tr_b16 a[28:29], v4 offset:1024
    ds_read_b64_tr_b16 a[30:31], v4 offset:17408
    v_mfma_f32_16x16x32_bf16 v[228:231], a[52:55], v[68:71], v[228:231]
    ds_read_b64_tr_b16 a[32:33], v3 offset:1280
    s_waitcnt lgkmcnt(7)
    v_mfma_f32_16x16x32_bf16 v[232:235], a[56:59], v[64:67], v[232:235]
    ds_read_b64_tr_b16 a[34:35], v3 offset:17664
    buffer_load_dwordx4 v5, s[16:19], s73 offen offset:1024 lds
    v_mfma_f32_16x16x32_bf16 v[236:239], a[56:59], v[68:71], v[236:239]
    ds_read_b64_tr_b16 a[36:37], v4 offset:1280
    v_cvt_pk_bf16_f32 v136, v208, v209
    v_mfma_f32_16x16x32_bf16 v[240:243], a[0:3], v[64:67], v[240:243]
    ds_read_b64_tr_b16 a[38:39], v4 offset:17664
    v_cvt_pk_bf16_f32 v137, v210, v211
    v_mfma_f32_16x16x32_bf16 v[244:247], a[0:3], v[68:71], v[244:247]
    ds_read_b64_tr_b16 a[40:41], v3 offset:2048
    v_mul_f32 v216, v11, v216
    v_mfma_f32_16x16x32_bf16 v[248:251], a[4:7], v[64:67], v[248:251]
    ds_read_b64_tr_b16 a[42:43], v3 offset:18432
    v_mul_f32 v217, v11, v217
    v_mfma_f32_16x16x32_bf16 v[252:255], a[4:7], v[68:71], v[252:255]
    ds_read_b64_tr_b16 a[44:45], v4 offset:2048
    buffer_load_dwordx4 v5, s[16:19], s74 offen offset:2048 lds
    v_mfma_f32_16x16x32_bf16 v[224:227], a[8:11], v[72:75], v[224:227]
    ds_read_b64_tr_b16 a[46:47], v4 offset:18432
    v_mul_f32 v218, v11, v218
    v_mfma_f32_16x16x32_bf16 v[228:231], a[8:11], v[76:79], v[228:231]
    ds_read_b64_tr_b16 a[48:49], v3 offset:2304
    v_mul_f32 v219, v11, v219
    v_mfma_f32_16x16x32_bf16 v[232:235], a[12:15], v[72:75], v[232:235]
    ds_read_b64_tr_b16 a[50:51], v3 offset:18688
    v_cvt_pk_bf16_f32 v138, v216, v217
    v_mfma_f32_16x16x32_bf16 v[236:239], a[12:15], v[76:79], v[236:239]
    ds_read_b64_tr_b16 a[52:53], v4 offset:2304
    v_cvt_pk_bf16_f32 v139, v218, v219
    v_mfma_f32_16x16x32_bf16 v[240:243], a[16:19], v[72:75], v[240:243]
    ds_read_b64_tr_b16 a[54:55], v4 offset:18688
    v_mul_f32 v212, v12, v212
    v_mfma_f32_16x16x32_bf16 v[244:247], a[16:19], v[76:79], v[244:247]
    ds_read_b64_tr_b16 a[56:57], v3 offset:3072
    s_waitcnt lgkmcnt(6)
    v_mfma_f32_16x16x32_bf16 v[248:251], a[20:23], v[72:75], v[248:251]
    ds_read_b64_tr_b16 a[58:59], v3 offset:19456
    buffer_load_dwordx4 v5, s[16:19], s75 offen offset:3072 lds
    v_mfma_f32_16x16x32_bf16 v[252:255], a[20:23], v[76:79], v[252:255]
    ds_read_b64_tr_b16 a[0:1], v4 offset:3072
    v_add_u32 v5, 1048576, v5
    v_mfma_f32_16x16x32_bf16 v[224:227], a[24:27], v[80:83], v[224:227]
    ds_read_b64_tr_b16 a[2:3], v4 offset:19456
    s_add_u32 m0, s0, 4096
    v_mfma_f32_16x16x32_bf16 v[228:231], a[24:27], v[84:87], v[228:231]
    ds_read_b64_tr_b16 a[4:5], v3 offset:3328
    v_mul_f32 v213, v12, v213
    v_mfma_f32_16x16x32_bf16 v[232:235], a[28:31], v[80:83], v[232:235]
    ds_read_b64_tr_b16 a[6:7], v3 offset:19712
    v_mul_f32 v214, v12, v214
    v_mfma_f32_16x16x32_bf16 v[236:239], a[28:31], v[84:87], v[236:239]
    ds_read_b64_tr_b16 a[8:9], v4 offset:3328
    v_mul_f32 v215, v12, v215
    v_mfma_f32_16x16x32_bf16 v[240:243], a[32:35], v[80:83], v[240:243]
    ds_read_b64_tr_b16 a[10:11], v4 offset:19712
    v_cvt_pk_bf16_f32 v140, v212, v213
    v_mfma_f32_16x16x32_bf16 v[244:247], a[32:35], v[84:87], v[244:247]
    ds_read_b64_tr_b16 a[12:13], v3 offset:4096
    v_cvt_pk_bf16_f32 v141, v214, v215
    v_mfma_f32_16x16x32_bf16 v[248:251], a[36:39], v[80:83], v[248:251]
    ds_read_b64_tr_b16 a[14:15], v3 offset:20480
    buffer_load_dwordx4 v5, s[16:19], 0 offen offset:0 lds
    v_mfma_f32_16x16x32_bf16 v[252:255], a[36:39], v[84:87], v[252:255]
    ds_read_b64_tr_b16 a[16:17], v4 offset:4096
    v_mul_f32 v220, v12, v220
    v_mfma_f32_16x16x32_bf16 v[224:227], a[40:43], v[88:91], v[224:227]
    ds_read_b64_tr_b16 a[18:19], v4 offset:20480
    v_mul_f32 v221, v12, v221
    v_mfma_f32_16x16x32_bf16 v[228:231], a[40:43], v[92:95], v[228:231]
    ds_read_b64_tr_b16 a[20:21], v3 offset:4352
    s_waitcnt lgkmcnt(6)
    v_mfma_f32_16x16x32_bf16 v[232:235], a[44:47], v[88:91], v[232:235]
    ds_read_b64_tr_b16 a[22:23], v3 offset:20736
    v_mul_f32 v222, v12, v222
    v_mfma_f32_16x16x32_bf16 v[236:239], a[44:47], v[92:95], v[236:239]
    ds_read_b64_tr_b16 a[24:25], v4 offset:4352
    v_mul_f32 v223, v12, v223
    v_mfma_f32_16x16x32_bf16 v[240:243], a[48:51], v[88:91], v[240:243]
    ds_read_b64_tr_b16 a[26:27], v4 offset:20736
    v_cvt_pk_bf16_f32 v142, v220, v221
    v_mfma_f32_16x16x32_bf16 v[244:247], a[48:51], v[92:95], v[244:247]
    ds_read_b64_tr_b16 a[28:29], v3 offset:5120
    buffer_load_dwordx4 v5, s[16:19], s73 offen offset:1024 lds
    v_mfma_f32_16x16x32_bf16 v[248:251], a[52:55], v[88:91], v[248:251]
    ds_read_b64_tr_b16 a[30:31], v3 offset:21504
    v_cvt_pk_bf16_f32 v143, v222, v223
    v_mfma_f32_16x16x32_bf16 v[252:255], a[52:55], v[92:95], v[252:255]
    v_permlane16_swap_b32 v136, v138
    v_mfma_f32_16x16x32_bf16 v[224:227], a[56:59], v[96:99], v[224:227]
    ds_read_b64_tr_b16 a[32:33], v4 offset:5120
    ds_read_b64_tr_b16 a[34:35], v4 offset:21504
    v_mfma_f32_16x16x32_bf16 v[228:231], a[56:59], v[100:103], v[228:231]
    v_permlane16_swap_b32 v137, v139
    v_mfma_f32_16x16x32_bf16 v[232:235], a[0:3], v[96:99], v[232:235]
    ds_read_b64_tr_b16 a[36:37], v3 offset:5376
    ds_read_b64_tr_b16 a[38:39], v3 offset:21760
    v_mfma_f32_16x16x32_bf16 v[236:239], a[0:3], v[100:103], v[236:239]
    v_permlane16_swap_b32 v140, v142
    v_mfma_f32_16x16x32_bf16 v[240:243], a[4:7], v[96:99], v[240:243]
    ds_read_b64_tr_b16 a[40:41], v4 offset:5376
    ds_read_b64_tr_b16 a[42:43], v4 offset:21760
    v_mfma_f32_16x16x32_bf16 v[244:247], a[4:7], v[100:103], v[244:247]
    ds_read_b64_tr_b16 a[44:45], v3 offset:6144
    s_waitcnt lgkmcnt(7)
    v_mfma_f32_16x16x32_bf16 v[248:251], a[8:11], v[96:99], v[248:251]
    s_waitcnt vmcnt(20)
    s_barrier
    ds_read_b64_tr_b16 a[46:47], v3 offset:22528
    v_mfma_f32_16x16x32_bf16 v[252:255], a[8:11], v[100:103], v[252:255]
    ds_read_b64_tr_b16 a[48:49], v4 offset:6144
    ds_read_b64_tr_b16 a[50:51], v4 offset:22528
    v_mfma_f32_16x16x32_bf16 v[224:227], a[12:15], v[104:107], v[224:227]
    v_permlane16_swap_b32 v141, v143
    v_mfma_f32_16x16x32_bf16 v[228:231], a[12:15], v[108:111], v[228:231]
    ds_read_b64_tr_b16 a[52:53], v3 offset:6400
    buffer_load_dwordx4 v5, s[16:19], s74 offen offset:2048 lds
    v_mfma_f32_16x16x32_bf16 v[232:235], a[16:19], v[104:107], v[232:235]
    ds_read_b64_tr_b16 a[54:55], v3 offset:22784
    v_add_u32 v5, 786432, v5
    v_mfma_f32_16x16x32_bf16 v[236:239], a[16:19], v[108:111], v[236:239]
    ds_read_b64_tr_b16 a[56:57], v4 offset:6400
    s_add_u32 m0, s0, 32768
    v_mfma_f32_16x16x32_bf16 v[240:243], a[20:23], v[104:107], v[240:243]
    ds_read_b64_tr_b16 a[58:59], v4 offset:22784
    v_mfma_f32_16x16x32_bf16 v[244:247], a[20:23], v[108:111], v[244:247]
    ds_read_b64_tr_b16 a[0:1], v3 offset:32768
    v_mfma_f32_16x16x32_bf16 v[248:251], a[24:27], v[104:107], v[248:251]
    ds_read_b64_tr_b16 a[2:3], v3 offset:49152
    v_mfma_f32_16x16x32_bf16 v[252:255], a[24:27], v[108:111], v[252:255]
    ds_read_b64_tr_b16 a[4:5], v4 offset:32768
    v_mfma_f32_16x16x32_bf16 v[224:227], a[28:31], v[112:115], v[224:227]
    ds_read_b64_tr_b16 a[6:7], v4 offset:49152
    buffer_load_dwordx4 v5, s[16:19], 0 offen offset:0 lds
    v_mfma_f32_16x16x32_bf16 v[228:231], a[28:31], v[116:119], v[228:231]
    ds_read_b64_tr_b16 a[8:9], v3 offset:33024
    s_waitcnt lgkmcnt(6)
    v_mfma_f32_16x16x32_bf16 v[232:235], a[32:35], v[112:115], v[232:235]
    ds_read_b64_tr_b16 a[10:11], v3 offset:49408
    v_mfma_f32_16x16x32_bf16 v[236:239], a[32:35], v[116:119], v[236:239]
    ds_read_b64_tr_b16 a[12:13], v4 offset:33024
    v_mfma_f32_16x16x32_bf16 v[240:243], a[36:39], v[112:115], v[240:243]
    ds_read_b64_tr_b16 a[14:15], v4 offset:49408
    v_mfma_f32_16x16x32_bf16 v[244:247], a[36:39], v[116:119], v[244:247]
    ds_read_b64_tr_b16 a[16:17], v3 offset:33792
    v_mfma_f32_16x16x32_bf16 v[248:251], a[40:43], v[112:115], v[248:251]
    ds_read_b64_tr_b16 a[18:19], v3 offset:50176
    v_mfma_f32_16x16x32_bf16 v[252:255], a[40:43], v[116:119], v[252:255]
    ds_read_b64_tr_b16 a[20:21], v4 offset:33792
    buffer_load_dwordx4 v5, s[16:19], s73 offen offset:1024 lds
    v_mfma_f32_16x16x32_bf16 v[224:227], a[44:47], v[120:123], v[224:227]
    ds_read_b64_tr_b16 a[22:23], v4 offset:50176
    v_mfma_f32_16x16x32_bf16 v[228:231], a[44:47], v[124:127], v[228:231]
    ds_read_b64_tr_b16 a[24:25], v3 offset:34048
    v_mfma_f32_16x16x32_bf16 v[232:235], a[48:51], v[120:123], v[232:235]
    ds_read_b64_tr_b16 a[26:27], v3 offset:50432
    v_mfma_f32_16x16x32_bf16 v[236:239], a[48:51], v[124:127], v[236:239]
    ds_read_b64_tr_b16 a[28:29], v4 offset:34048
    v_mfma_f32_16x16x32_bf16 v[240:243], a[52:55], v[120:123], v[240:243]
    ds_read_b64_tr_b16 a[30:31], v4 offset:50432
    v_mfma_f32_16x16x32_bf16 v[244:247], a[52:55], v[124:127], v[244:247]
    ds_read_b64_tr_b16 a[32:33], v3 offset:34816
    s_waitcnt lgkmcnt(6)
    v_mfma_f32_16x16x32_bf16 v[248:251], a[56:59], v[120:123], v[248:251]
    ds_read_b64_tr_b16 a[34:35], v3 offset:51200
    s_waitcnt vmcnt(16)
    v_mfma_f32_16x16x32_bf16 v[252:255], a[56:59], v[124:127], v[252:255]
    s_waitcnt vmcnt(14)
    v_cmp_ne_u32 vcc, 1, v10
    v_mfma_f32_16x16x32_bf16 v[192:195], a[0:3], v[16:19], 0
    ds_read_b64_tr_b16 a[36:37], v4 offset:34816
    ds_read_b64_tr_b16 a[38:39], v4 offset:51200
    v_mfma_f32_16x16x32_bf16 v[196:199], a[0:3], v[20:23], 0
    s_cbranch_vccnz L_SPIN0
L_OK0:
    v_mov_b32 v9, 1
    v_mfma_f32_16x16x32_bf16 v[200:203], a[4:7], v[16:19], 0
    ds_read_b64_tr_b16 a[40:41], v3 offset:35072
    ds_read_b64_tr_b16 a[42:43], v3 offset:51456
    v_mfma_f32_16x16x32_bf16 v[204:207], a[4:7], v[20:23], 0
    v_mul_f32 v224, v11, v224
    v_mul_f32 v225, v11, v225
    v_mfma_f32_16x16x32_bf16 v[208:211], a[8:11], v[16:19], 0
    buffer_store_dword v9, v8, s[40:43], 0 offen sc1
    ds_read_b64_tr_b16 a[44:45], v4 offset:35072
    ds_read_b64_tr_b16 a[46:47], v4 offset:51456
    v_mfma_f32_16x16x32_bf16 v[212:215], a[8:11], v[20:23], 0
    v_mul_f32 v226, v11, v226
    v_mul_f32 v227, v11, v227
    v_mfma_f32_16x16x32_bf16 v[216:219], a[12:15], v[16:19], 0
    ds_read_b64_tr_b16 a[48:49], v3 offset:35840
    ds_read_b64_tr_b16 a[50:51], v3 offset:52224
    v_mfma_f32_16x16x32_bf16 v[220:223], a[12:15], v[20:23], 0
    v_cvt_pk_bf16_f32 v144, v224, v225
    v_cvt_pk_bf16_f32 v145, v226, v227
    v_mfma_f32_16x16x32_bf16 v[192:195], a[16:19], v[24:27], v[192:195]
    ds_read_b64_tr_b16 a[52:53], v4 offset:35840
    buffer_load_dwordx4 v5, s[16:19], s74 offen offset:2048 lds
    ds_read_b64_tr_b16 a[54:55], v4 offset:52224
    v_mfma_f32_16x16x32_bf16 v[196:199], a[16:19], v[28:31], v[196:199]
    ds_read_b64_tr_b16 a[56:57], v3 offset:36096
    s_waitcnt lgkmcnt(7)
    v_mfma_f32_16x16x32_bf16 v[200:203], a[20:23], v[24:27], v[200:203]
    ds_read_b64_tr_b16 a[58:59], v3 offset:52480
    buffer_load_dwordx4 v5, s[16:19], s75 offen offset:3072 lds
    v_mfma_f32_16x16x32_bf16 v[204:207], a[20:23], v[28:31], v[204:207]
    ds_read_b64_tr_b16 a[0:1], v4 offset:36096
    v_add_u32 v5, 1048576, v5
    v_mfma_f32_16x16x32_bf16 v[208:211], a[24:27], v[24:27], v[208:211]
    ds_read_b64_tr_b16 a[2:3], v4 offset:52480
    s_add_u32 m0, s0, 36864
    v_mfma_f32_16x16x32_bf16 v[212:215], a[24:27], v[28:31], v[212:215]
    ds_read_b64_tr_b16 a[4:5], v3 offset:36864
    v_mul_f32 v232, v11, v232
    v_mfma_f32_16x16x32_bf16 v[216:219], a[28:31], v[24:27], v[216:219]
    ds_read_b64_tr_b16 a[6:7], v3 offset:53248
    buffer_load_dwordx4 v5, s[16:19], 0 offen offset:0 lds
    v_mfma_f32_16x16x32_bf16 v[220:223], a[28:31], v[28:31], v[220:223]
    ds_read_b64_tr_b16 a[8:9], v4 offset:36864
    v_mul_f32 v233, v11, v233
    v_mfma_f32_16x16x32_bf16 v[192:195], a[32:35], v[32:35], v[192:195]
    ds_read_b64_tr_b16 a[10:11], v4 offset:53248
    v_mul_f32 v234, v11, v234
    v_mfma_f32_16x16x32_bf16 v[196:199], a[32:35], v[36:39], v[196:199]
    ds_read_b64_tr_b16 a[12:13], v3 offset:37120
    v_mul_f32 v235, v11, v235
    v_mfma_f32_16x16x32_bf16 v[200:203], a[36:39], v[32:35], v[200:203]
    ds_read_b64_tr_b16 a[14:15], v3 offset:53504
    v_cvt_pk_bf16_f32 v146, v232, v233
    v_mfma_f32_16x16x32_bf16 v[204:207], a[36:39], v[36:39], v[204:207]
    ds_read_b64_tr_b16 a[16:17], v4 offset:37120
    v_cvt_pk_bf16_f32 v147, v234, v235
    v_mfma_f32_16x16x32_bf16 v[208:211], a[40:43], v[32:35], v[208:211]
    ds_read_b64_tr_b16 a[18:19], v4 offset:53504
    v_mul_f32 v228, v12, v228
    v_mfma_f32_16x16x32_bf16 v[212:215], a[40:43], v[36:39], v[212:215]
    ds_read_b64_tr_b16 a[20:21], v3 offset:37888
    s_waitcnt lgkmcnt(6)
    v_mfma_f32_16x16x32_bf16 v[216:219], a[44:47], v[32:35], v[216:219]
    ds_read_b64_tr_b16 a[22:23], v3 offset:54272
    buffer_load_dwordx4 v5, s[16:19], s73 offen offset:1024 lds
    v_mfma_f32_16x16x32_bf16 v[220:223], a[44:47], v[36:39], v[220:223]
    ds_read_b64_tr_b16 a[24:25], v4 offset:37888
    v_mul_f32 v229, v12, v229
    v_mfma_f32_16x16x32_bf16 v[192:195], a[48:51], v[40:43], v[192:195]
    ds_read_b64_tr_b16 a[26:27], v4 offset:54272
    s_waitcnt vmcnt(14)
    v_mfma_f32_16x16x32_bf16 v[196:199], a[48:51], v[44:47], v[196:199]
    ds_read_b64_tr_b16 a[28:29], v3 offset:38144
    s_barrier
    v_mfma_f32_16x16x32_bf16 v[200:203], a[52:55], v[40:43], v[200:203]
    ds_read_b64_tr_b16 a[30:31], v3 offset:54528
    v_mul_f32 v230, v12, v230
    v_mfma_f32_16x16x32_bf16 v[204:207], a[52:55], v[44:47], v[204:207]
    ds_read_b64_tr_b16 a[32:33], v4 offset:38144
    v_mul_f32 v231, v12, v231
    v_mfma_f32_16x16x32_bf16 v[208:211], a[56:59], v[40:43], v[208:211]
    ds_read_b64_tr_b16 a[34:35], v4 offset:54528
    v_cvt_pk_bf16_f32 v148, v228, v229
    v_mfma_f32_16x16x32_bf16 v[212:215], a[56:59], v[44:47], v[212:215]
    ds_read_b64_tr_b16 a[36:37], v3 offset:38912
    buffer_load_dwordx4 v5, s[16:19], s74 offen offset:2048 lds
    v_mfma_f32_16x16x32_bf16 v[216:219], a[0:3], v[40:43], v[216:219]
    ds_read_b64_tr_b16 a[38:39], v3 offset:55296
    v_accvgpr_read_b32 v6, a80
    v_mfma_f32_16x16x32_bf16 v[220:223], a[0:3], v[44:47], v[220:223]
    ds_read_b64_tr_b16 a[40:41], v4 offset:38912
    s_add_u32 m0, s47, 65536
    v_mfma_f32_16x16x32_bf16 v[192:195], a[4:7], v[48:51], v[192:195]
    ds_read_b64_tr_b16 a[42:43], v4 offset:55296
    v_cvt_pk_bf16_f32 v149, v230, v231
    v_mfma_f32_16x16x32_bf16 v[196:199], a[4:7], v[52:55], v[196:199]
    ds_read_b64_tr_b16 a[44:45], v3 offset:39168
    s_waitcnt lgkmcnt(6)
    v_mfma_f32_16x16x32_bf16 v[200:203], a[8:11], v[48:51], v[200:203]
    ds_read_b64_tr_b16 a[46:47], v3 offset:55552
    v_add_u32 v3, 65536, v3
    v_mfma_f32_16x16x32_bf16 v[204:207], a[8:11], v[52:55], v[204:207]
    ds_read_b64_tr_b16 a[48:49], v4 offset:39168
    v_mul_f32 v236, v12, v236
    v_mfma_f32_16x16x32_bf16 v[208:211], a[12:15], v[48:51], v[208:211]
    ds_read_b64_tr_b16 a[50:51], v4 offset:55552
    v_add_u32 v4, 65536, v4
    v_mfma_f32_16x16x32_bf16 v[212:215], a[12:15], v[52:55], v[212:215]
    ds_read_b64_tr_b16 a[52:53], v3 offset:0
    v_mul_f32 v237, v12, v237
    v_mfma_f32_16x16x32_bf16 v[216:219], a[16:19], v[48:51], v[216:219]
    ds_read_b64_tr_b16 a[54:55], v3 offset:16384
    v_mul_f32 v238, v12, v238
    v_mfma_f32_16x16x32_bf16 v[220:223], a[16:19], v[52:55], v[220:223]
    ds_read_b64_tr_b16 a[56:57], v4 offset:0
    v_mul_f32 v239, v12, v239
    v_mfma_f32_16x16x32_bf16 v[192:195], a[20:23], v[56:59], v[192:195]
    ds_read_b64_tr_b16 a[58:59], v4 offset:16384
    buffer_load_dwordx4 v6, s[8:11], s88 offen offset:0 lds
    v_mfma_f32_16x16x32_bf16 v[196:199], a[20:23], v[60:63], v[196:199]
    ds_read_b64_tr_b16 a[0:1], v3 offset:256
    v_cvt_pk_bf16_f32 v150, v236, v237
    v_mfma_f32_16x16x32_bf16 v[200:203], a[24:27], v[56:59], v[200:203]
    ds_read_b64_tr_b16 a[2:3], v3 offset:16640
    v_cvt_pk_bf16_f32 v151, v238, v239
    v_mfma_f32_16x16x32_bf16 v[204:207], a[24:27], v[60:63], v[204:207]
    v_permlane16_swap_b32 v144, v146
    v_mfma_f32_16x16x32_bf16 v[208:211], a[28:31], v[56:59], v[208:211]
    ds_read_b64_tr_b16 a[4:5], v4 offset:256
    ds_read_b64_tr_b16 a[6:7], v4 offset:16640
    v_mfma_f32_16x16x32_bf16 v[212:215], a[28:31], v[60:63], v[212:215]
    ds_read_b64_tr_b16 a[8:9], v3 offset:1024
    s_waitcnt lgkmcnt(6)
    v_mfma_f32_16x16x32_bf16 v[216:219], a[32:35], v[56:59], v[216:219]
    ds_read_b64_tr_b16 a[10:11], v3 offset:17408
    ds_read_b64_tr_b16 a[12:13], v4 offset:1024
    v_mfma_f32_16x16x32_bf16 v[220:223], a[32:35], v[60:63], v[220:223]
    v_permlane16_swap_b32 v145, v147
    v_mfma_f32_16x16x32_bf16 v[192:195], a[36:39], v[64:67], v[192:195]
    ds_read_b64_tr_b16 a[14:15], v4 offset:17408
    ds_read_b64_tr_b16 a[16:17], v3 offset:1280
    v_mfma_f32_16x16x32_bf16 v[196:199], a[36:39], v[68:71], v[196:199]
    v_permlane16_swap_b32 v148, v150
    v_mfma_f32_16x16x32_bf16 v[200:203], a[40:43], v[64:67], v[200:203]
    ds_read_b64_tr_b16 a[18:19], v3 offset:17664
    ds_read_b64_tr_b16 a[20:21], v4 offset:1280
    v_mfma_f32_16x16x32_bf16 v[204:207], a[40:43], v[68:71], v[204:207]
    v_permlane16_swap_b32 v149, v151
    v_mfma_f32_16x16x32_bf16 v[208:211], a[44:47], v[64:67], v[208:211]
    ds_read_b64_tr_b16 a[22:23], v4 offset:17664
    v_mul_f32 v240, v11, v240
    v_mfma_f32_16x16x32_bf16 v[212:215], a[44:47], v[68:71], v[212:215]
    ds_read_b64_tr_b16 a[24:25], v3 offset:2048
    buffer_load_dwordx4 v6, s[8:11], s89 offen offset:1024 lds
    v_mfma_f32_16x16x32_bf16 v[216:219], a[48:51], v[64:67], v[216:219]
L_PAD3:
    s_cbranch_execz L_PAD7
    ds_read_b64_tr_b16 a[26:27], v3 offset:18432
    v_mul_f32 v241, v11, v241
    v_mfma_f32_16x16x32_bf16 v[220:223], a[48:51], v[68:71], v[220:223]
    ds_read_b64_tr_b16 a[28:29], v4 offset:2048
    v_mul_f32 v242, v11, v242
    v_mfma_f32_16x16x32_bf16 v[192:195], a[52:55], v[72:75], v[192:195]
    ds_read_b64_tr_b16 a[30:31], v4 offset:18432
    v_mul_f32 v243, v11, v243
    v_mfma_f32_16x16x32_bf16 v[196:199], a[52:55], v[76:79], v[196:199]
    ds_read_b64_tr_b16 a[32:33], v3 offset:2304
    s_waitcnt lgkmcnt(6)
    v_mfma_f32_16x16x32_bf16 v[200:203], a[56:59], v[72:75], v[200:203]
    ds_read_b64_tr_b16 a[34:35], v3 offset:18688
    v_cvt_pk_bf16_f32 v152, v240, v241
    v_mfma_f32_16x16x32_bf16 v[204:207], a[56:59], v[76:79], v[204:207]
    ds_read_b64_tr_b16 a[36:37], v4 offset:2304
    v_cvt_pk_bf16_f32 v153, v242, v243
    v_mfma_f32_16x16x32_bf16 v[208:211], a[0:3], v[72:75], v[208:211]
    ds_read_b64_tr_b16 a[38:39], v4 offset:18688
    v_mul_f32 v248, v11, v248
    v_mfma_f32_16x16x32_bf16 v[212:215], a[0:3], v[76:79], v[212:215]
    ds_read_b64_tr_b16 a[40:41], v3 offset:3072
    v_mul_f32 v249, v11, v249
    v_mfma_f32_16x16x32_bf16 v[216:219], a[4:7], v[72:75], v[216:219]
    ds_read_b64_tr_b16 a[42:43], v3 offset:19456
    v_mul_f32 v250, v11, v250
    v_mfma_f32_16x16x32_bf16 v[220:223], a[4:7], v[76:79], v[220:223]
    ds_read_b64_tr_b16 a[44:45], v4 offset:3072
    v_mul_f32 v251, v11, v251
    v_mfma_f32_16x16x32_bf16 v[192:195], a[8:11], v[80:83], v[192:195]
    ds_read_b64_tr_b16 a[46:47], v4 offset:19456
    v_cvt_pk_bf16_f32 v154, v248, v249
    v_mfma_f32_16x16x32_bf16 v[196:199], a[8:11], v[84:87], v[196:199]
    ds_read_b64_tr_b16 a[48:49], v3 offset:3328
    v_cvt_pk_bf16_f32 v155, v250, v251
    v_mfma_f32_16x16x32_bf16 v[200:203], a[12:15], v[80:83], v[200:203]
    ds_read_b64_tr_b16 a[50:51], v3 offset:19712
    buffer_load_dwordx4 v6, s[8:11], s90 offen offset:2048 lds
    v_mfma_f32_16x16x32_bf16 v[204:207], a[12:15], v[84:87], v[204:207]
    ds_read_b64_tr_b16 a[52:53], v4 offset:3328
    v_mul_f32 v244, v12, v244
    v_mfma_f32_16x16x32_bf16 v[208:211], a[16:19], v[80:83], v[208:211]
    ds_read_b64_tr_b16 a[54:55], v4 offset:19712
    v_mul_f32 v245, v12, v245
    v_mfma_f32_16x16x32_bf16 v[212:215], a[16:19], v[84:87], v[212:215]
    ds_read_b64_tr_b16 a[56:57], v3 offset:4096
    s_waitcnt lgkmcnt(6)
    v_mfma_f32_16x16x32_bf16 v[216:219], a[20:23], v[80:83], v[216:219]
    ds_read_b64_tr_b16 a[58:59], v3 offset:20480
    v_mul_f32 v246, v12, v246
    v_mfma_f32_16x16x32_bf16 v[220:223], a[20:23], v[84:87], v[220:223]
    ds_read_b64_tr_b16 a[0:1], v4 offset:4096
    v_mul_f32 v247, v12, v247
    v_mfma_f32_16x16x32_bf16 v[192:195], a[24:27], v[88:91], v[192:195]
    ds_read_b64_tr_b16 a[2:3], v4 offset:20480
    v_cvt_pk_bf16_f32 v156, v244, v245
    v_mfma_f32_16x16x32_bf16 v[196:199], a[24:27], v[92:95], v[196:199]
    ds_read_b64_tr_b16 a[4:5], v3 offset:4352
    v_cvt_pk_bf16_f32 v157, v246, v247
    v_mfma_f32_16x16x32_bf16 v[200:203], a[28:31], v[88:91], v[200:203]
    ds_read_b64_tr_b16 a[6:7], v3 offset:20736
    v_mul_f32 v252, v12, v252
    v_mfma_f32_16x16x32_bf16 v[204:207], a[28:31], v[92:95], v[204:207]
    ds_read_b64_tr_b16 a[8:9], v4 offset:4352
    v_mul_f32 v253, v12, v253
    v_mfma_f32_16x16x32_bf16 v[208:211], a[32:35], v[88:91], v[208:211]
    ds_read_b64_tr_b16 a[10:11], v4 offset:20736
    v_mul_f32 v254, v12, v254
    v_mfma_f32_16x16x32_bf16 v[212:215], a[32:35], v[92:95], v[212:215]
    ds_read_b64_tr_b16 a[12:13], v3 offset:5120
    v_mul_f32 v255, v12, v255
    v_mfma_f32_16x16x32_bf16 v[216:219], a[36:39], v[88:91], v[216:219]
    ds_read_b64_tr_b16 a[14:15], v3 offset:21504
    v_cvt_pk_bf16_f32 v158, v252, v253
    v_mfma_f32_16x16x32_bf16 v[220:223], a[36:39], v[92:95], v[220:223]
    ds_read_b64_tr_b16 a[16:17], v4 offset:5120
    buffer_load_dwordx4 v6, s[8:11], s91 offen offset:3072 lds
    v_mfma_f32_16x16x32_bf16 v[192:195], a[40:43], v[96:99], v[192:195]
    ds_read_b64_tr_b16 a[18:19], v4 offset:21504
    s_waitcnt vmcnt(12)
    v_mfma_f32_16x16x32_bf16 v[196:199], a[40:43], v[100:103], v[196:199]
    ds_read_b64_tr_b16 a[20:21], v3 offset:5376
    s_waitcnt lgkmcnt(6)
    v_mfma_f32_16x16x32_bf16 v[200:203], a[44:47], v[96:99], v[200:203]
    ds_read_b64_tr_b16 a[22:23], v3 offset:21760
    s_barrier
    v_mfma_f32_16x16x32_bf16 v[204:207], a[44:47], v[100:103], v[204:207]
    ds_read_b64_tr_b16 a[24:25], v4 offset:5376
    v_cvt_pk_bf16_f32 v159, v254, v255
    v_mfma_f32_16x16x32_bf16 v[208:211], a[48:51], v[96:99], v[208:211]
    ds_read_b64_tr_b16 a[26:27], v4 offset:21760
    ds_read_b64_tr_b16 a[28:29], v3 offset:6144
    v_mfma_f32_16x16x32_bf16 v[212:215], a[48:51], v[100:103], v[212:215]
    v_permlane16_swap_b32 v152, v154
    v_mfma_f32_16x16x32_bf16 v[216:219], a[52:55], v[96:99], v[216:219]
    ds_read_b64_tr_b16 a[30:31], v3 offset:22528
    ds_read_b64_tr_b16 a[32:33], v4 offset:6144
    v_mfma_f32_16x16x32_bf16 v[220:223], a[52:55], v[100:103], v[220:223]
    v_permlane16_swap_b32 v153, v155
    v_mfma_f32_16x16x32_bf16 v[192:195], a[56:59], v[104:107], v[192:195]
    ds_read_b64_tr_b16 a[34:35], v4 offset:22528
    ds_read_b64_tr_b16 a[36:37], v3 offset:6400
    v_mfma_f32_16x16x32_bf16 v[196:199], a[56:59], v[108:111], v[196:199]
    v_permlane16_swap_b32 v156, v158
    v_mfma_f32_16x16x32_bf16 v[200:203], a[0:3], v[104:107], v[200:203]
    ds_read_b64_tr_b16 a[38:39], v3 offset:22784
    ds_read_b64_tr_b16 a[40:41], v4 offset:6400
    v_mfma_f32_16x16x32_bf16 v[204:207], a[0:3], v[108:111], v[204:207]
    v_permlane16_swap_b32 v157, v159
    v_mfma_f32_16x16x32_bf16 v[208:211], a[4:7], v[104:107], v[208:211]
    ds_read_b64_tr_b16 a[42:43], v4 offset:22784
    v_subrev_u32 v3, 131072, v3
    v_mfma_f32_16x16x32_bf16 v[212:215], a[4:7], v[108:111], v[212:215]
    ds_read_b64_tr_b16 a[44:45], v3 offset:0
    s_waitcnt lgkmcnt(6)
    v_mfma_f32_16x16x32_bf16 v[216:219], a[8:11], v[104:107], v[216:219]
    ds_read_b64_tr_b16 a[46:47], v3 offset:16384
    v_subrev_u32 v4, 131072, v4
    v_mfma_f32_16x16x32_bf16 v[220:223], a[8:11], v[108:111], v[220:223]
    ds_read_b64_tr_b16 a[48:49], v4 offset:0
    v_add_u32 v6, 16384, v6
    v_mfma_f32_16x16x32_bf16 v[192:195], a[12:15], v[112:115], v[192:195]
    ds_read_b64_tr_b16 a[50:51], v4 offset:16384
    v_and_b32 v6, 0x3ffff, v6
    v_mfma_f32_16x16x32_bf16 v[196:199], a[12:15], v[116:119], v[196:199]
    ds_read_b64_tr_b16 a[52:53], v3 offset:256
    s_add_u32 m0, s47, 98304
    v_mfma_f32_16x16x32_bf16 v[200:203], a[16:19], v[112:115], v[200:203]
    ds_read_b64_tr_b16 a[54:55], v3 offset:16640
    buffer_load_dwordx4 v6, s[8:11], s88 offen offset:0 lds
    v_mfma_f32_16x16x32_bf16 v[204:207], a[16:19], v[116:119], v[204:207]
    ds_read_b64_tr_b16 a[56:57], v4 offset:256
    v_mfma_f32_16x16x32_bf16 v[208:211], a[20:23], v[112:115], v[208:211]
    ds_read_b64_tr_b16 a[58:59], v4 offset:16640
    v_mfma_f32_16x16x32_bf16 v[212:215], a[20:23], v[116:119], v[212:215]
    ds_read_b64_tr_b16 a[0:1], v3 offset:1024
    v_mfma_f32_16x16x32_bf16 v[216:219], a[24:27], v[112:115], v[216:219]
    ds_read_b64_tr_b16 a[2:3], v3 offset:17408
    buffer_load_dwordx4 v6, s[8:11], s89 offen offset:1024 lds
    v_mfma_f32_16x16x32_bf16 v[220:223], a[24:27], v[116:119], v[220:223]
    ds_read_b64_tr_b16 a[4:5], v4 offset:1024
    v_mfma_f32_16x16x32_bf16 v[192:195], a[28:31], v[120:123], v[192:195]
    ds_read_b64_tr_b16 a[6:7], v4 offset:17408
    v_mfma_f32_16x16x32_bf16 v[196:199], a[28:31], v[124:127], v[196:199]
    ds_read_b64_tr_b16 a[8:9], v3 offset:1280
    s_waitcnt lgkmcnt(6)
    v_mfma_f32_16x16x32_bf16 v[200:203], a[32:35], v[120:123], v[200:203]
    ds_read_b64_tr_b16 a[10:11], v3 offset:17664
    v_mfma_f32_16x16x32_bf16 v[204:207], a[32:35], v[124:127], v[204:207]
    ds_read_b64_tr_b16 a[12:13], v4 offset:1280
    v_mfma_f32_16x16x32_bf16 v[208:211], a[36:39], v[120:123], v[208:211]
    ds_read_b64_tr_b16 a[14:15], v4 offset:17664
    v_mfma_f32_16x16x32_bf16 v[212:215], a[36:39], v[124:127], v[212:215]
    ds_read_b64_tr_b16 a[16:17], v3 offset:2048
    v_mul_f32 v192, v11, v192
    v_mfma_f32_16x16x32_bf16 v[216:219], a[40:43], v[120:123], v[216:219]
    ds_read_b64_tr_b16 a[18:19], v3 offset:18432
    v_mul_f32 v193, v11, v193
    v_mfma_f32_16x16x32_bf16 v[220:223], a[40:43], v[124:127], v[220:223]
    ds_read_b64_tr_b16 a[20:21], v4 offset:2048
    v_mul_f32 v194, v11, v194
    v_mfma_f32_16x16x32_bf16 v[224:227], a[44:47], v[16:19], 0
    ds_read_b64_tr_b16 a[22:23], v4 offset:18432
    v_mul_f32 v195, v11, v195
    v_mfma_f32_16x16x32_bf16 v[228:231], a[44:47], v[20:23], 0
    ds_read_b64_tr_b16 a[24:25], v3 offset:2304
    v_cvt_pk_bf16_f32 v160, v192, v193
    v_mfma_f32_16x16x32_bf16 v[232:235], a[48:51], v[16:19], 0
    ds_read_b64_tr_b16 a[26:27], v3 offset:18688
    v_cvt_pk_bf16_f32 v161, v194, v195
    v_mfma_f32_16x16x32_bf16 v[236:239], a[48:51], v[20:23], 0
    ds_read_b64_tr_b16 a[28:29], v4 offset:2304
    v_mul_f32 v200, v11, v200
    v_mfma_f32_16x16x32_bf16 v[240:243], a[52:55], v[16:19], 0
    ds_read_b64_tr_b16 a[30:31], v4 offset:18688
    v_mul_f32 v201, v11, v201
    v_mfma_f32_16x16x32_bf16 v[244:247], a[52:55], v[20:23], 0
    buffer_load_dwordx4 v6, s[8:11], s90 offen offset:2048 lds
    ds_read_b64_tr_b16 a[32:33], v3 offset:3072
    s_waitcnt lgkmcnt(6)
    v_mfma_f32_16x16x32_bf16 v[248:251], a[56:59], v[16:19], 0
    ds_read_b64_tr_b16 a[34:35], v3 offset:19456
    v_mul_f32 v202, v11, v202
    v_mfma_f32_16x16x32_bf16 v[252:255], a[56:59], v[20:23], 0
    ds_read_b64_tr_b16 a[36:37], v4 offset:3072
    v_mul_f32 v203, v11, v203
    v_mfma_f32_16x16x32_bf16 v[224:227], a[0:3], v[24:27], v[224:227]
    ds_read_b64_tr_b16 a[38:39], v4 offset:19456
    v_cvt_pk_bf16_f32 v162, v200, v201
    v_mfma_f32_16x16x32_bf16 v[228:231], a[0:3], v[28:31], v[228:231]
    ds_read_b64_tr_b16 a[40:41], v3 offset:3328
    v_cvt_pk_bf16_f32 v163, v202, v203
    v_mfma_f32_16x16x32_bf16 v[232:235], a[4:7], v[24:27], v[232:235]
    ds_read_b64_tr_b16 a[42:43], v3 offset:19712
    v_mul_f32 v196, v12, v196
    v_mfma_f32_16x16x32_bf16 v[236:239], a[4:7], v[28:31], v[236:239]
    ds_read_b64_tr_b16 a[44:45], v4 offset:3328
    v_mul_f32 v197, v12, v197
    v_mfma_f32_16x16x32_bf16 v[240:243], a[8:11], v[24:27], v[240:243]
    buffer_load_dwordx4 v6, s[8:11], s91 offen offset:3072 lds
    ds_read_b64_tr_b16 a[46:47], v4 offset:19712
    v_mfma_f32_16x16x32_bf16 v[244:247], a[8:11], v[28:31], v[244:247]
    ds_read_b64_tr_b16 a[48:49], v3 offset:4096
    v_mul_f32 v198, v12, v198
    v_mfma_f32_16x16x32_bf16 v[248:251], a[12:15], v[24:27], v[248:251]
    ds_read_b64_tr_b16 a[50:51], v3 offset:20480
    v_add_u32 v6, 16384, v6
    v_mfma_f32_16x16x32_bf16 v[252:255], a[12:15], v[28:31], v[252:255]
    ds_read_b64_tr_b16 a[52:53], v4 offset:4096
    v_and_b32 v6, 0x3ffff, v6
    v_mfma_f32_16x16x32_bf16 v[224:227], a[16:19], v[32:35], v[224:227]
    ds_read_b64_tr_b16 a[54:55], v4 offset:20480
    v_accvgpr_read_b32 v5, a81
    v_mfma_f32_16x16x32_bf16 v[228:231], a[16:19], v[36:39], v[228:231]
    s_add_u32 m0, s47, 114688
    ds_read_b64_tr_b16 a[56:57], v3 offset:4352
    s_waitcnt lgkmcnt(6)
    v_mfma_f32_16x16x32_bf16 v[232:235], a[20:23], v[32:35], v[232:235]
    ds_read_b64_tr_b16 a[58:59], v3 offset:20736
    v_mul_f32 v199, v12, v199
    v_mfma_f32_16x16x32_bf16 v[236:239], a[20:23], v[36:39], v[236:239]
    buffer_load_dwordx4 v5, s[12:15], 0 offen offset:0 lds
    ds_read_b64_tr_b16 a[0:1], v4 offset:4352
    v_mfma_f32_16x16x32_bf16 v[240:243], a[24:27], v[32:35], v[240:243]
    ds_read_b64_tr_b16 a[2:3], v4 offset:20736
    v_cvt_pk_bf16_f32 v164, v196, v197
    v_mfma_f32_16x16x32_bf16 v[244:247], a[24:27], v[36:39], v[244:247]
    ds_read_b64_tr_b16 a[4:5], v3 offset:5120
    v_cvt_pk_bf16_f32 v165, v198, v199
    v_mfma_f32_16x16x32_bf16 v[248:251], a[28:31], v[32:35], v[248:251]
    ds_read_b64_tr_b16 a[6:7], v3 offset:21504
    v_mul_f32 v204, v12, v204
    v_mfma_f32_16x16x32_bf16 v[252:255], a[28:31], v[36:39], v[252:255]
    ds_read_b64_tr_b16 a[8:9], v4 offset:5120
    v_mul_f32 v205, v12, v205
    v_mfma_f32_16x16x32_bf16 v[224:227], a[32:35], v[40:43], v[224:227]
    ds_read_b64_tr_b16 a[10:11], v4 offset:21504
    v_mul_f32 v206, v12, v206
    v_mfma_f32_16x16x32_bf16 v[228:231], a[32:35], v[44:47], v[228:231]
    buffer_load_dwordx4 v5, s[12:15], s85 offen offset:1024 lds
    ds_read_b64_tr_b16 a[12:13], v3 offset:5376
    v_mfma_f32_16x16x32_bf16 v[232:235], a[36:39], v[40:43], v[232:235]
    ds_read_b64_tr_b16 a[14:15], v3 offset:21760
    v_mul_f32 v207, v12, v207
    v_mfma_f32_16x16x32_bf16 v[236:239], a[36:39], v[44:47], v[236:239]
    ds_read_b64_tr_b16 a[16:17], v4 offset:5376
    v_cvt_pk_bf16_f32 v166, v204, v205
    v_mfma_f32_16x16x32_bf16 v[240:243], a[40:43], v[40:43], v[240:243]
    ds_read_b64_tr_b16 a[18:19], v4 offset:21760
    v_cvt_pk_bf16_f32 v167, v206, v207
    v_mfma_f32_16x16x32_bf16 v[244:247], a[40:43], v[44:47], v[244:247]
    ds_read_b64_tr_b16 a[20:21], v3 offset:6144
    s_waitcnt lgkmcnt(6)
    v_mfma_f32_16x16x32_bf16 v[248:251], a[44:47], v[40:43], v[248:251]
    s_waitcnt vmcnt(10)
    s_barrier
    ds_read_b64_tr_b16 a[22:23], v3 offset:22528
    v_mfma_f32_16x16x32_bf16 v[252:255], a[44:47], v[44:47], v[252:255]
    v_permlane16_swap_b32 v160, v162
    v_mfma_f32_16x16x32_bf16 v[224:227], a[48:51], v[48:51], v[224:227]
    ds_read_b64_tr_b16 a[24:25], v4 offset:6144
    buffer_load_dwordx4 v5, s[12:15], s86 offen offset:2048 lds
    ds_read_b64_tr_b16 a[26:27], v4 offset:22528
    v_mfma_f32_16x16x32_bf16 v[228:231], a[48:51], v[52:55], v[228:231]
    v_permlane16_swap_b32 v161, v163
    v_mfma_f32_16x16x32_bf16 v[232:235], a[52:55], v[48:51], v[232:235]
    ds_read_b64_tr_b16 a[28:29], v3 offset:6400
    ds_read_b64_tr_b16 a[30:31], v3 offset:22784
    v_mfma_f32_16x16x32_bf16 v[236:239], a[52:55], v[52:55], v[236:239]
    v_permlane16_swap_b32 v164, v166
    v_mfma_f32_16x16x32_bf16 v[240:243], a[56:59], v[48:51], v[240:243]
    ds_read_b64_tr_b16 a[32:33], v4 offset:6400
    ds_read_b64_tr_b16 a[34:35], v4 offset:22784
    v_mfma_f32_16x16x32_bf16 v[244:247], a[56:59], v[52:55], v[244:247]
    v_permlane16_swap_b32 v165, v167
    v_mfma_f32_16x16x32_bf16 v[248:251], a[0:3], v[48:51], v[248:251]
    ds_read_b64_tr_b16 a[36:37], v3 offset:32768
    ds_read_b64_tr_b16 a[38:39], v3 offset:49152
    v_mfma_f32_16x16x32_bf16 v[252:255], a[0:3], v[52:55], v[252:255]
    buffer_load_dwordx4 v5, s[12:15], s87 offen offset:3072 lds
    ds_read_b64_tr_b16 a[40:41], v3 offset:33792
    v_mfma_f32_16x16x32_bf16 v[224:227], a[4:7], v[56:59], v[224:227]
    ds_read_b64_tr_b16 a[42:43], v3 offset:50176
    v_mul_f32 v208, v11, v208
    v_mfma_f32_16x16x32_bf16 v[228:231], a[4:7], v[60:63], v[228:231]
    ds_read_b64_tr_b16 a[44:45], v3 offset:34816
    s_waitcnt lgkmcnt(7)
    v_mfma_f32_16x16x32_bf16 v[232:235], a[8:11], v[56:59], v[232:235]
    ds_read_b64_tr_b16 a[46:47], v3 offset:51200
    v_mul_f32 v209, v11, v209
    v_mfma_f32_16x16x32_bf16 v[236:239], a[8:11], v[60:63], v[236:239]
    ds_read_b64_tr_b16 a[48:49], v3 offset:35840
    v_mul_f32 v210, v11, v210
    v_mfma_f32_16x16x32_bf16 v[240:243], a[12:15], v[56:59], v[240:243]
    ds_read_b64_tr_b16 a[50:51], v3 offset:52224
    v_add_u32 v5, 16384, v5
    v_mfma_f32_16x16x32_bf16 v[244:247], a[12:15], v[60:63], v[244:247]
    ds_read_b64_tr_b16 a[52:53], v3 offset:36864
    v_and_b32 v5, 0x3ffff, v5
    v_mfma_f32_16x16x32_bf16 v[248:251], a[16:19], v[56:59], v[248:251]
    s_add_u32 m0, s47, 131072
    ds_read_b64_tr_b16 a[54:55], v3 offset:53248
    v_mfma_f32_16x16x32_bf16 v[252:255], a[16:19], v[60:63], v[252:255]
    ds_read_b64_tr_b16 a[56:57], v3 offset:37888
    v_mul_f32 v211, v11, v211
    v_mfma_f32_16x16x32_bf16 v[224:227], a[20:23], v[64:67], v[224:227]
    buffer_load_dwordx4 v6, s[8:11], s88 offen offset:0 lds
    ds_read_b64_tr_b16 a[58:59], v3 offset:54272
    v_mfma_f32_16x16x32_bf16 v[228:231], a[20:23], v[68:71], v[228:231]
    ds_read_b64_tr_b16 a[0:1], v3 offset:38912
    v_cvt_pk_bf16_f32 v168, v208, v209
    v_mfma_f32_16x16x32_bf16 v[232:235], a[24:27], v[64:67], v[232:235]
    ds_read_b64_tr_b16 a[2:3], v3 offset:55296
    v_cvt_pk_bf16_f32 v169, v210, v211
    v_mfma_f32_16x16x32_bf16 v[236:239], a[24:27], v[68:71], v[236:239]
    ds_read_b64_tr_b16 a[4:5], v4 offset:32768
    v_mul_f32 v216, v11, v216
    v_mfma_f32_16x16x32_bf16 v[240:243], a[28:31], v[64:67], v[240:243]
    ds_read_b64_tr_b16 a[6:7], v4 offset:49152
    v_mul_f32 v217, v11, v217
    v_mfma_f32_16x16x32_bf16 v[244:247], a[28:31], v[68:71], v[244:247]
    ds_read_b64_tr_b16 a[8:9], v4 offset:33792
    s_waitcnt lgkmcnt(6)
    v_mfma_f32_16x16x32_bf16 v[248:251], a[32:35], v[64:67], v[248:251]
    ds_read_b64_tr_b16 a[10:11], v4 offset:50176
    v_mul_f32 v218, v11, v218
    v_mfma_f32_16x16x32_bf16 v[252:255], a[32:35], v[68:71], v[252:255]
    buffer_load_dwordx4 v6, s[8:11], s89 offen offset:1024 lds
    ds_read_b64_tr_b16 a[12:13], v4 offset:34816
    v_mfma_f32_16x16x32_bf16 v[224:227], a[36:39], v[72:75], v[224:227]
    ds_read_b64_tr_b16 a[14:15], v4 offset:51200
    v_mul_f32 v219, v11, v219
    v_mfma_f32_16x16x32_bf16 v[228:231], a[36:39], v[76:79], v[228:231]
    ds_read_b64_tr_b16 a[16:17], v4 offset:35840
    v_cvt_pk_bf16_f32 v170, v216, v217
    v_mfma_f32_16x16x32_bf16 v[224:227], a[40:43], v[80:83], v[224:227]
    ds_read_b64_tr_b16 a[18:19], v4 offset:52224
    v_cvt_pk_bf16_f32 v171, v218, v219
    v_mfma_f32_16x16x32_bf16 v[228:231], a[40:43], v[84:87], v[228:231]
    ds_read_b64_tr_b16 a[20:21], v4 offset:36864
    v_mul_f32 v212, v12, v212
    v_mfma_f32_16x16x32_bf16 v[224:227], a[44:47], v[88:91], v[224:227]
    ds_read_b64_tr_b16 a[22:23], v4 offset:53248
    v_mul_f32 v213, v12, v213
    v_mfma_f32_16x16x32_bf16 v[228:231], a[44:47], v[92:95], v[228:231]
    buffer_load_dwordx4 v6, s[8:11], s90 offen offset:2048 lds
    ds_read_b64_tr_b16 a[24:25], v4 offset:37888
    v_mfma_f32_16x16x32_bf16 v[224:227], a[48:51], v[96:99], v[224:227]
    ds_read_b64_tr_b16 a[26:27], v4 offset:54272
    v_mul_f32 v214, v12, v214
    v_mfma_f32_16x16x32_bf16 v[228:231], a[48:51], v[100:103], v[228:231]
    ds_read_b64_tr_b16 a[28:29], v4 offset:38912
    v_mul_f32 v215, v12, v215
    v_mfma_f32_16x16x32_bf16 v[224:227], a[52:55], v[104:107], v[224:227]
    ds_read_b64_tr_b16 a[30:31], v4 offset:55296
    v_cvt_pk_bf16_f32 v172, v212, v213
    v_mfma_f32_16x16x32_bf16 v[228:231], a[52:55], v[108:111], v[228:231]
    ds_read_b64_tr_b16 a[32:33], v3 offset:33024
    s_waitcnt lgkmcnt(6)
    v_mfma_f32_16x16x32_bf16 v[224:227], a[56:59], v[112:115], v[224:227]
    ds_read_b64_tr_b16 a[34:35], v3 offset:49408
    v_cvt_pk_bf16_f32 v173, v214, v215
    v_mfma_f32_16x16x32_bf16 v[228:231], a[56:59], v[116:119], v[228:231]
    ds_read_b64_tr_b16 a[36:37], v3 offset:34048
    v_mul_f32 v220, v12, v220
    v_mfma_f32_16x16x32_bf16 v[224:227], a[0:3], v[120:123], v[224:227]
    buffer_load_dwordx4 v6, s[8:11], s91 offen offset:3072 lds
    ds_read_b64_tr_b16 a[38:39], v3 offset:50432
    v_mfma_f32_16x16x32_bf16 v[228:231], a[0:3], v[124:127], v[228:231]
    ds_read_b64_tr_b16 a[40:41], v3 offset:35072
    v_mul_f32 v221, v12, v221
    v_mfma_f32_16x16x32_bf16 v[232:235], a[4:7], v[72:75], v[232:235]
    ds_read_b64_tr_b16 a[42:43], v3 offset:51456
    v_mul_f32 v222, v12, v222
    v_mfma_f32_16x16x32_bf16 v[236:239], a[4:7], v[76:79], v[236:239]
    ds_read_b64_tr_b16 a[44:45], v3 offset:36096
    v_add_u32 v6, 16384, v6
    v_mfma_f32_16x16x32_bf16 v[232:235], a[8:11], v[80:83], v[232:235]
    ds_read_b64_tr_b16 a[46:47], v3 offset:52480
    v_and_b32 v6, 0x3ffff, v6
    v_mfma_f32_16x16x32_bf16 v[236:239], a[8:11], v[84:87], v[236:239]
    s_add_u32 m0, s47, 147456
    ds_read_b64_tr_b16 a[48:49], v3 offset:37120
    v_mfma_f32_16x16x32_bf16 v[232:235], a[12:15], v[88:91], v[232:235]
    ds_read_b64_tr_b16 a[50:51], v3 offset:53504
    v_mul_f32 v223, v12, v223
    v_mfma_f32_16x16x32_bf16 v[236:239], a[12:15], v[92:95], v[236:239]
    buffer_load_dwordx4 v5, s[12:15], 0 offen offset:0 lds
    ds_read_b64_tr_b16 a[52:53], v3 offset:38144
    v_mfma_f32_16x16x32_bf16 v[232:235], a[16:19], v[96:99], v[232:235]
    ds_read_b64_tr_b16 a[54:55], v3 offset:54528
    v_cvt_pk_bf16_f32 v174, v220, v221
    v_mfma_f32_16x16x32_bf16 v[236:239], a[16:19], v[100:103], v[236:239]
    ds_read_b64_tr_b16 a[56:57], v3 offset:39168
    s_waitcnt lgkmcnt(6)
    v_mfma_f32_16x16x32_bf16 v[232:235], a[20:23], v[104:107], v[232:235]
    ds_read_b64_tr_b16 a[58:59], v3 offset:55552
    v_cvt_pk_bf16_f32 v175, v222, v223
    v_mfma_f32_16x16x32_bf16 v[236:239], a[20:23], v[108:111], v[236:239]
    ds_read_b64_tr_b16 a[0:1], v4 offset:33024
    v_accvgpr_read_b32 v3, a83
    v_mfma_f32_16x16x32_bf16 v[232:235], a[24:27], v[112:115], v[232:235]
    ds_read_b64_tr_b16 a[2:3], v4 offset:49408
    v_add_u32 v3, 65536, v3
    v_mfma_f32_16x16x32_bf16 v[236:239], a[24:27], v[116:119], v[236:239]
    buffer_load_dwordx4 v5, s[12:15], s85 offen offset:1024 lds
    ds_read_b64_tr_b16 a[4:5], v4 offset:34048
    v_mfma_f32_16x16x32_bf16 v[232:235], a[28:31], v[120:123], v[232:235]
    ds_read_b64_tr_b16 a[6:7], v4 offset:50432
    ds_read_b64_tr_b16 a[8:9], v4 offset:35072
    v_mfma_f32_16x16x32_bf16 v[236:239], a[28:31], v[124:127], v[236:239]
    v_permlane16_swap_b32 v168, v170
    v_mfma_f32_16x16x32_bf16 v[240:243], a[32:35], v[72:75], v[240:243]
    ds_read_b64_tr_b16 a[10:11], v4 offset:51456
    ds_read_b64_tr_b16 a[12:13], v4 offset:36096
    v_mfma_f32_16x16x32_bf16 v[244:247], a[32:35], v[76:79], v[244:247]
    v_permlane16_swap_b32 v169, v171
    v_mfma_f32_16x16x32_bf16 v[240:243], a[36:39], v[80:83], v[240:243]
    s_waitcnt vmcnt(14)
    s_barrier
    ds_read_b64_tr_b16 a[14:15], v4 offset:52480
    v_mfma_f32_16x16x32_bf16 v[244:247], a[36:39], v[84:87], v[244:247]
    v_permlane16_swap_b32 v172, v174
    v_mfma_f32_16x16x32_bf16 v[240:243], a[40:43], v[88:91], v[240:243]
    ds_read_b64_tr_b16 a[16:17], v4 offset:37120
    buffer_load_dwordx4 v5, s[12:15], s86 offen offset:2048 lds
    ds_read_b64_tr_b16 a[18:19], v4 offset:53504
    v_mfma_f32_16x16x32_bf16 v[244:247], a[40:43], v[92:95], v[244:247]
    ds_read_b64_tr_b16 a[20:21], v4 offset:38144
    s_waitcnt lgkmcnt(6)
    v_mfma_f32_16x16x32_bf16 v[240:243], a[44:47], v[96:99], v[240:243]
    ds_read_b64_tr_b16 a[22:23], v4 offset:54528
    ds_read_b64_tr_b16 a[24:25], v4 offset:39168
    v_mfma_f32_16x16x32_bf16 v[244:247], a[44:47], v[100:103], v[244:247]
    v_permlane16_swap_b32 v173, v175
    v_mfma_f32_16x16x32_bf16 v[240:243], a[48:51], v[104:107], v[240:243]
    ds_read_b64_tr_b16 a[26:27], v4 offset:55552
    v_mul_f32 v224, v11, v224
    v_mfma_f32_16x16x32_bf16 v[244:247], a[48:51], v[108:111], v[244:247]
    ds_read_b128 a[28:31], v3 offset:0
    v_accvgpr_read_b32 v4, a83
    v_mfma_f32_16x16x32_bf16 v[240:243], a[52:55], v[112:115], v[240:243]
    v_xor_b32 v4, 64, v4
    v_mul_f32 v225, v11, v225
    v_mfma_f32_16x16x32_bf16 v[244:247], a[52:55], v[116:119], v[244:247]
    buffer_load_dwordx4 v5, s[12:15], s87 offen offset:3072 lds
    v_add_u32 v4, 65536, v4
    v_mfma_f32_16x16x32_bf16 v[240:243], a[56:59], v[120:123], v[240:243]
    ds_read_b128 a[32:35], v4 offset:0
    v_mul_f32 v226, v11, v226
    v_mfma_f32_16x16x32_bf16 v[244:247], a[56:59], v[124:127], v[244:247]
    ds_read_b128 a[36:39], v3 offset:1024
    v_add_u32 v5, 16384, v5
    v_mfma_f32_16x16x32_bf16 v[248:251], a[0:3], v[72:75], v[248:251]
    ds_read_b128 a[40:43], v4 offset:1024
    v_and_b32 v5, 0x3ffff, v5
    v_mfma_f32_16x16x32_bf16 v[252:255], a[0:3], v[76:79], v[252:255]
    s_add_u32 m0, s47, 0
    ds_read_b128 a[44:47], v3 offset:2048
    v_mfma_f32_16x16x32_bf16 v[248:251], a[4:7], v[80:83], v[248:251]
    ds_read_b128 a[48:51], v4 offset:2048
    v_mul_f32 v227, v11, v227
    v_mfma_f32_16x16x32_bf16 v[252:255], a[4:7], v[84:87], v[252:255]
    buffer_load_dwordx4 v6, s[8:11], s88 offen offset:0 lds
    s_waitcnt lgkmcnt(5)
    v_mfma_f32_16x16x32_bf16 v[248:251], a[8:11], v[88:91], v[248:251]
    ds_read_b128 a[52:55], v3 offset:3072
    v_cvt_pk_bf16_f32 v176, v224, v225
    v_mfma_f32_16x16x32_bf16 v[252:255], a[8:11], v[92:95], v[252:255]
    ds_read_b128 a[56:59], v4 offset:3072
    v_cvt_pk_bf16_f32 v177, v226, v227
    v_mfma_f32_16x16x32_bf16 v[248:251], a[12:15], v[96:99], v[248:251]
    ds_read_b128 a[0:3], v3 offset:8192
    v_mul_f32 v232, v11, v232
    v_mfma_f32_16x16x32_bf16 v[252:255], a[12:15], v[100:103], v[252:255]
    buffer_load_dwordx4 v6, s[8:11], s89 offen offset:1024 lds
    ds_read_b128 a[4:7], v4 offset:8192
    v_mfma_f32_16x16x32_bf16 v[248:251], a[16:19], v[104:107], v[248:251]
    ds_read_b128 a[8:11], v3 offset:9216
    v_mul_f32 v233, v11, v233
    v_mfma_f32_16x16x32_bf16 v[252:255], a[16:19], v[108:111], v[252:255]
    ds_read_b128 a[12:15], v4 offset:9216
    v_mul_f32 v234, v11, v234
    v_mfma_f32_16x16x32_bf16 v[248:251], a[20:23], v[112:115], v[248:251]
    buffer_load_dwordx4 v6, s[8:11], s90 offen offset:2048 lds
    ds_read_b128 a[16:19], v3 offset:10240
    v_mfma_f32_16x16x32_bf16 v[252:255], a[20:23], v[116:119], v[252:255]
    v_mul_f32 v235, v11, v235
    v_cvt_pk_bf16_f32 v178, v232, v233
    v_mfma_f32_16x16x32_bf16 v[248:251], a[24:27], v[120:123], v[248:251]
    ds_read_b128 a[20:23], v4 offset:10240
    v_cvt_pk_bf16_f32 v179, v234, v235
    v_mfma_f32_16x16x32_bf16 v[252:255], a[24:27], v[124:127], v[252:255]
    v_mul_f32 v228, v12, v228
    v_mul_f32 v229, v12, v229
    v_mfma_f32_16x16x32_bf16 v[208:211], a[28:31], v[128:131], 0
    buffer_load_dwordx4 v6, s[8:11], s91 offen offset:3072 lds
    v_add_u32 v6, 16384, v6
    v_mfma_f32_16x16x32_bf16 v[212:215], a[28:31], v[132:135], 0
    v_and_b32 v6, 0x3ffff, v6
    s_waitcnt lgkmcnt(2)
    v_mfma_f32_16x16x32_bf16 v[208:211], a[32:35], v[136:139], v[208:211]
    s_add_u32 m0, s47, 16384
    ds_read_b128 a[24:27], v3 offset:11264
    v_mfma_f32_16x16x32_bf16 v[212:215], a[32:35], v[140:143], v[212:215]
    ds_read_b128 a[28:31], v4 offset:11264
    v_mul_f32 v230, v12, v230
    v_mfma_f32_16x16x32_bf16 v[208:211], a[36:39], v[144:147], v[208:211]
    buffer_load_dwordx4 v5, s[12:15], 0 offen offset:0 lds
    v_mul_f32 v231, v12, v231
    v_mfma_f32_16x16x32_bf16 v[212:215], a[36:39], v[148:151], v[212:215]
    v_cvt_pk_bf16_f32 v180, v228, v229
    v_cvt_pk_bf16_f32 v181, v230, v231
    v_mfma_f32_16x16x32_bf16 v[208:211], a[40:43], v[152:155], v[208:211]
    s_waitcnt vmcnt(13)
    s_barrier
    v_mfma_f32_16x16x32_bf16 v[212:215], a[40:43], v[156:159], v[212:215]
    buffer_load_dwordx4 v5, s[12:15], s85 offen offset:1024 lds
    ds_read_b128 a[32:35], v3 offset:32768
    v_mfma_f32_16x16x32_bf16 v[208:211], a[44:47], v[160:163], v[208:211]
    ds_read_b128 a[36:39], v4 offset:32768
    v_mul_f32 v236, v12, v236
    v_mfma_f32_16x16x32_bf16 v[212:215], a[44:47], v[164:167], v[212:215]
    ds_read_b128 a[40:43], v3 offset:33792
    v_mul_f32 v237, v12, v237
    v_mfma_f32_16x16x32_bf16 v[208:211], a[48:51], v[168:171], v[208:211]
    v_mul_f32 v238, v12, v238
    v_mul_f32 v239, v12, v239
    v_cvt_pk_bf16_f32 v182, v236, v237
    v_cvt_pk_bf16_f32 v183, v238, v239
    v_permlane16_swap_b32 v176, v178
    v_permlane16_swap_b32 v177, v179
    v_permlane16_swap_b32 v180, v182
    v_permlane16_swap_b32 v181, v183
    v_mfma_f32_16x16x32_bf16 v[212:215], a[48:51], v[172:175], v[212:215]
    buffer_load_dwordx4 v5, s[12:15], s86 offen offset:2048 lds
    ds_read_b128 a[44:47], v4 offset:33792
    v_mfma_f32_16x16x32_bf16 v[208:211], a[52:55], v[176:179], v[208:211]
    v_mul_f32 v240, v11, v240
    v_mul_f32 v241, v11, v241
    v_mul_f32 v242, v11, v242
    v_mul_f32 v243, v11, v243
    v_cvt_pk_bf16_f32 v184, v240, v241
    v_cvt_pk_bf16_f32 v185, v242, v243
    v_mul_f32 v248, v11, v248
    v_mul_f32 v249, v11, v249
    v_mul_f32 v250, v11, v250
    v_mul_f32 v251, v11, v251
    v_cvt_pk_bf16_f32 v186, v248, v249
    v_cvt_pk_bf16_f32 v187, v250, v251
    v_mul_f32 v244, v12, v244
    v_mul_f32 v245, v12, v245
    v_mul_f32 v246, v12, v246
    v_mul_f32 v247, v12, v247
    v_cvt_pk_bf16_f32 v188, v244, v245
    v_cvt_pk_bf16_f32 v189, v246, v247
    v_mul_f32 v252, v12, v252
    v_mul_f32 v253, v12, v253
    v_mul_f32 v254, v12, v254
    v_mul_f32 v255, v12, v255
    v_cvt_pk_bf16_f32 v190, v252, v253
    v_cvt_pk_bf16_f32 v191, v254, v255
    v_permlane16_swap_b32 v184, v186
    v_permlane16_swap_b32 v185, v187
    v_permlane16_swap_b32 v188, v190
    v_permlane16_swap_b32 v189, v191
    v_mfma_f32_16x16x32_bf16 v[212:215], a[52:55], v[180:183], v[212:215]
    ds_read_b128 a[48:51], v3 offset:34816
    buffer_load_dwordx4 v5, s[12:15], s87 offen offset:3072 lds
    v_mfma_f32_16x16x32_bf16 v[208:211], a[56:59], v[184:187], v[208:211]
    ds_read_b128 a[52:55], v4 offset:34816
    v_add_u32 v5, 16384, v5
    v_mfma_f32_16x16x32_bf16 v[212:215], a[56:59], v[188:191], v[212:215]
L_PAD4:
    s_cbranch_execz L_PAD8
    v_and_b32 v5, 0x3ffff, v5
    s_add_u32 m0, s47, 32768
    v_mfma_f32_16x16x32_bf16 v[216:219], a[0:3], v[128:131], 0
    ds_read_b128 a[56:59], v3 offset:35840
    buffer_load_dwordx4 v6, s[8:11], s88 offen offset:0 lds
    v_mfma_f32_16x16x32_bf16 v[220:223], a[0:3], v[132:135], 0
    v_add_u32 v1, 65536, v1
    v_accvgpr_read_b32 v11, a86
    v_mfma_f32_16x16x32_bf16 v[216:219], a[4:7], v[136:139], v[216:219]
    ds_read_b128 a[0:3], v4 offset:35840
    v_xor_b32 v12, 32, v11
    v_mfma_f32_16x16x32_bf16 v[220:223], a[4:7], v[140:143], v[220:223]
    v_max3_f32 v248, v208, v209, v210
    v_max_f32 v248, v248, v211
    v_mfma_f32_16x16x32_bf16 v[216:219], a[8:11], v[144:147], v[216:219]
    ds_read_b128 a[4:7], v3 offset:40960
    v_mov_b32 v249, v248
    v_mfma_f32_16x16x32_bf16 v[220:223], a[8:11], v[148:151], v[220:223]
    v_max3_f32 v250, v212, v213, v214
    v_max_f32 v250, v250, v215
    v_mfma_f32_16x16x32_bf16 v[216:219], a[12:15], v[152:155], v[216:219]
    buffer_load_dwordx4 v6, s[8:11], s89 offen offset:1024 lds
    v_mov_b32 v251, v250
    v_mfma_f32_16x16x32_bf16 v[220:223], a[12:15], v[156:159], v[220:223]
    v_add_u32 v2, 65536, v2
    s_waitcnt lgkmcnt(2)
    v_mfma_f32_16x16x32_bf16 v[216:219], a[16:19], v[160:163], v[216:219]
    v_permlane16_swap_b32 v248, v249
    v_mfma_f32_16x16x32_bf16 v[220:223], a[16:19], v[164:167], v[220:223]
    v_permlane16_swap_b32 v250, v251
    v_mfma_f32_16x16x32_bf16 v[216:219], a[20:23], v[168:171], v[216:219]
    ds_read_b64_tr_b16 a[8:9], v1 offset:49152
    v_max_f32 v248, v248, v249
    v_mfma_f32_16x16x32_bf16 v[220:223], a[20:23], v[172:175], v[220:223]
    ds_read_b64_tr_b16 a[10:11], v1 offset:51200
    v_mov_b32 v249, v248
    v_mfma_f32_16x16x32_bf16 v[216:219], a[24:27], v[176:179], v[216:219]
    ds_read_b128 a[12:15], v4 offset:40960
    v_max_f32 v250, v250, v251
    v_mfma_f32_16x16x32_bf16 v[220:223], a[24:27], v[180:183], v[220:223]
    ds_read_b64_tr_b16 a[16:17], v2 offset:49152
    v_mov_b32 v251, v250
    v_mfma_f32_16x16x32_bf16 v[216:219], a[28:31], v[184:187], v[216:219]
    v_permlane32_swap_b32 v248, v249
    v_permlane32_swap_b32 v250, v251
    v_max_f32 v248, v248, v249
    v_max_f32 v250, v250, v251
    v_sub_f32 v240, 0, v248
    v_sub_f32 v241, 0, v248
    v_sub_f32 v242, 0, v248
    v_sub_f32 v243, 0, v248
    v_sub_f32 v244, 0, v250
    v_sub_f32 v245, 0, v250
    v_sub_f32 v246, 0, v250
    v_sub_f32 v247, 0, v250
    v_mfma_f32_16x16x32_bf16 v[220:223], a[28:31], v[188:191], v[220:223]
    v_add_f32 v208, v240, v208
    v_add_f32 v209, v240, v209
    v_add_f32 v210, v240, v210
    v_add_f32 v211, v240, v211
    v_add_f32 v212, v244, v212
    v_add_f32 v213, v244, v213
    v_add_f32 v214, v244, v214
    v_add_f32 v215, v244, v215
    v_exp_f32 v208, v208
    v_exp_f32 v209, v209
    v_exp_f32 v210, v210
    v_exp_f32 v211, v211
    v_exp_f32 v212, v212
    v_exp_f32 v213, v213
    v_cvt_pk_bf16_f32 v224, v208, v209
    v_exp_f32 v214, v214
    v_cvt_pk_bf16_f32 v225, v210, v211
    v_cvt_pk_bf16_f32 v228, v212, v213
    v_exp_f32 v215, v215
    s_nop 0
    v_cvt_pk_bf16_f32 v229, v214, v215
    v_mfma_f32_16x16x32_bf16 v[208:211], a[32:35], v[128:131], v[240:243]
    ds_read_b64_tr_b16 a[18:19], v2 offset:51200
    buffer_load_dword v14, v13, s[40:43], s76 offen sc1
    v_mfma_f32_16x16x32_bf16 v[212:215], a[32:35], v[132:135], v[244:247]
    ds_read_b128 a[20:23], v3 offset:41984
    buffer_load_dwordx4 v6, s[8:11], s90 offen offset:2048 lds
    v_mfma_f32_16x16x32_bf16 v[208:211], a[36:39], v[136:139], v[208:211]
    ds_read_b64_tr_b16 a[24:25], v1 offset:49408
    buffer_load_dwordx4 v6, s[8:11], s91 offen offset:3072 lds
    v_mfma_f32_16x16x32_bf16 v[212:215], a[36:39], v[140:143], v[212:215]
    ds_read_b64_tr_b16 a[26:27], v1 offset:51456
    v_add_f32 v216, v240, v216
    v_mfma_f32_16x16x32_bf16 v[208:211], a[40:43], v[144:147], v[208:211]
    ds_read_b128 a[28:31], v4 offset:41984
    v_add_f32 v217, v240, v217
    v_mfma_f32_16x16x32_bf16 v[212:215], a[40:43], v[148:151], v[212:215]
    ds_read_b64_tr_b16 a[32:33], v2 offset:49408
    v_add_f32 v218, v240, v218
    v_mfma_f32_16x16x32_bf16 v[208:211], a[44:47], v[152:155], v[208:211]
    ds_read_b64_tr_b16 a[34:35], v2 offset:51456
    v_add_f32 v219, v240, v219
    v_mfma_f32_16x16x32_bf16 v[212:215], a[44:47], v[156:159], v[212:215]
    ds_read_b128 a[36:39], v3 offset:43008
    v_add_f32 v220, v244, v220
    v_mfma_f32_16x16x32_bf16 v[208:211], a[48:51], v[160:163], v[208:211]
    ds_read_b64_tr_b16 a[40:41], v1 offset:53248
    v_add_f32 v221, v244, v221
    v_mfma_f32_16x16x32_bf16 v[212:215], a[48:51], v[164:167], v[212:215]
    ds_read_b64_tr_b16 a[42:43], v1 offset:55296
    v_add_f32 v222, v244, v222
    v_mfma_f32_16x16x32_bf16 v[208:211], a[52:55], v[168:171], v[208:211]
    ds_read_b128 a[44:47], v4 offset:43008
    v_add_f32 v223, v244, v223
    v_mfma_f32_16x16x32_bf16 v[212:215], a[52:55], v[172:175], v[212:215]
    v_add_u32 v6, 16384, v6
    v_max3_f32 v10, v216, v217, v218
    v_mfma_f32_16x16x32_bf16 v[208:211], a[56:59], v[176:179], v[208:211]
    ds_read_b64_tr_b16 a[48:49], v2 offset:53248
    v_and_b32 v6, 0x3ffff, v6
    v_mfma_f32_16x16x32_bf16 v[212:215], a[56:59], v[180:183], v[212:215]
    s_add_u32 m0, s47, 49152
    s_waitcnt lgkmcnt(4)
    v_mfma_f32_16x16x32_bf16 v[208:211], a[0:3], v[184:187], v[208:211]
    ds_read_b64_tr_b16 a[50:51], v2 offset:55296
    v_max3_f32 v255, v219, v220, v221
    v_mfma_f32_16x16x32_bf16 v[212:215], a[0:3], v[188:191], v[212:215]
    v_max3_f32 v10, v222, v223, v10
    v_max_f32 v10, v10, v255
    v_cmp_lt_f32 vcc, s98, v10
    s_cbranch_vccnz L_RARE0
L_BACK0:
    v_exp_f32 v216, v216
    v_exp_f32 v217, v217
    v_exp_f32 v218, v218
    v_exp_f32 v219, v219
    v_exp_f32 v220, v220
    v_exp_f32 v221, v221
    v_cvt_pk_bf16_f32 v226, v216, v217
    v_exp_f32 v222, v222
    v_cvt_pk_bf16_f32 v227, v218, v219
    v_cvt_pk_bf16_f32 v230, v220, v221
    v_exp_f32 v223, v223
    buffer_load_dwordx4 v5, s[12:15], 0 offen offset:0 lds
    v_cvt_pk_bf16_f32 v231, v222, v223
    v_mfma_f32_16x16x32_bf16 v[216:219], a[4:7], v[128:131], v[240:243]
    ds_read_b128 a[52:55], v3 offset:44032
    v_add_u32 v3, 65536, v3
    v_mfma_f32_16x16x32_bf16 v[220:223], a[4:7], v[132:135], v[244:247]
    ds_read_b64_tr_b16 a[56:57], v1 offset:53504
    buffer_load_dwordx4 v5, s[12:15], s85 offen offset:1024 lds
    v_mfma_f32_16x16x32_bf16 a[64:67], a[60:63], v[224:227], 0
    ds_read_b64_tr_b16 a[58:59], v1 offset:55552
    v_add_u32 v1, 65536, v1
    v_mfma_f32_16x16x32_bf16 a[68:71], a[60:63], v[228:231], 0
    ds_read_b128 a[0:3], v4 offset:44032
    v_add_u32 v4, 65536, v4
    v_mfma_f32_16x16x32_bf16 v[16:19], a[8:11], v[224:227], 0
    ds_read_b64_tr_b16 a[4:5], v2 offset:53504
    v_max3_f32 v10, v208, v209, v210
    v_mfma_f32_16x16x32_bf16 v[20:23], a[8:11], v[228:231], 0
    ds_read_b64_tr_b16 a[6:7], v2 offset:55552
    v_add_u32 v2, 65536, v2
    v_mfma_f32_16x16x32_bf16 v[216:219], a[12:15], v[136:139], v[216:219]
    s_waitcnt vmcnt(15)
    s_barrier
    v_mfma_f32_16x16x32_bf16 v[220:223], a[12:15], v[140:143], v[220:223]
    ds_read_b128 a[8:11], v3 offset:0
    v_max3_f32 v255, v211, v212, v213
    v_mfma_f32_16x16x32_bf16 v[24:27], a[16:19], v[224:227], 0
    ds_read_b64_tr_b16 a[12:13], v1 offset:24576
    v_max3_f32 v10, v214, v215, v10
    v_mfma_f32_16x16x32_bf16 v[28:31], a[16:19], v[228:231], 0
    ds_read_b64_tr_b16 a[14:15], v1 offset:26624
    v_max_f32 v10, v10, v255
    v_mfma_f32_16x16x32_bf16 v[216:219], a[20:23], v[144:147], v[216:219]
    ds_read_b128 a[16:19], v4 offset:0
    buffer_load_dwordx4 v5, s[12:15], s86 offen offset:2048 lds
    v_mfma_f32_16x16x32_bf16 v[220:223], a[20:23], v[148:151], v[220:223]
    buffer_load_dwordx4 v5, s[12:15], s87 offen offset:3072 lds
    v_cmp_lt_f32 vcc, s98, v10
    v_mfma_f32_16x16x32_bf16 v[32:35], a[24:27], v[224:227], 0
    ds_read_b64_tr_b16 a[20:21], v2 offset:24576
    s_mul_i32 s69, s68, 12544
    v_mfma_f32_16x16x32_bf16 v[36:39], a[24:27], v[228:231], 0
    s_cbranch_vccnz L_RARE1
L_BACK1:
    v_add_u32 v5, 16384, v5
    v_mfma_f32_16x16x32_bf16 v[216:219], a[28:31], v[152:155], v[216:219]
    v_exp_f32 v208, v208
    v_mfma_f32_16x16x32_bf16 v[220:223], a[28:31], v[156:159], v[220:223]
    v_exp_f32 v209, v209
    v_mfma_f32_16x16x32_bf16 v[40:43], a[32:35], v[224:227], 0
    v_exp_f32 v210, v210
    v_mfma_f32_16x16x32_bf16 v[44:47], a[32:35], v[228:231], 0
    ds_read_b64_tr_b16 a[22:23], v2 offset:26624
    buffer_load_dword a87, v0, s[28:31], s69 offen
    v_mfma_f32_16x16x32_bf16 v[216:219], a[36:39], v[160:163], v[216:219]
    v_exp_f32 v211, v211
    v_mfma_f32_16x16x32_bf16 v[220:223], a[36:39], v[164:167], v[220:223]
    ds_read_b128 a[24:27], v3 offset:1024
    s_waitcnt lgkmcnt(2)
    v_mfma_f32_16x16x32_bf16 v[48:51], a[40:43], v[224:227], 0
    ds_read_b64_tr_b16 a[28:29], v1 offset:24832
    v_and_b32 v5, 0x3ffff, v5
    v_mfma_f32_16x16x32_bf16 v[52:55], a[40:43], v[228:231], 0
    v_exp_f32 v212, v212
    v_mfma_f32_16x16x32_bf16 v[216:219], a[44:47], v[168:171], v[216:219]
    ds_read_b64_tr_b16 a[30:31], v1 offset:26880
    s_add_u32 m0, s47, 65536
    v_mfma_f32_16x16x32_bf16 v[220:223], a[44:47], v[172:175], v[220:223]
    ds_read_b128 a[32:35], v4 offset:1024
    buffer_load_dwordx4 v6, s[8:11], s88 offen offset:0 lds
    v_mfma_f32_16x16x32_bf16 v[56:59], a[48:51], v[224:227], 0
    v_exp_f32 v213, v213
    v_mfma_f32_16x16x32_bf16 v[60:63], a[48:51], v[228:231], 0
    ds_read_b64_tr_b16 a[36:37], v2 offset:24832
    v_cvt_pk_bf16_f32 v232, v208, v209
    v_mfma_f32_16x16x32_bf16 v[216:219], a[52:55], v[176:179], v[216:219]
    v_exp_f32 v214, v214
    v_mfma_f32_16x16x32_bf16 v[220:223], a[52:55], v[180:183], v[220:223]
    ds_read_b64_tr_b16 a[38:39], v2 offset:26880
    v_cvt_pk_bf16_f32 v233, v210, v211
    v_mfma_f32_16x16x32_bf16 v[64:67], a[56:59], v[224:227], 0
    ds_read_b128 a[40:43], v3 offset:2048
    ds_read_b64_tr_b16 a[44:45], v1 offset:28672
    v_mfma_f32_16x16x32_bf16 v[68:71], a[56:59], v[228:231], 0
    v_exp_f32 v215, v215
    v_mfma_f32_16x16x32_bf16 v[216:219], a[0:3], v[184:187], v[216:219]
    ds_read_b64_tr_b16 a[46:47], v1 offset:30720
    v_cvt_pk_bf16_f32 v236, v212, v213
    v_mfma_f32_16x16x32_bf16 v[220:223], a[0:3], v[188:191], v[220:223]
    ds_read_b128 a[48:51], v4 offset:2048
    v_cvt_pk_bf16_f32 v237, v214, v215
    v_mfma_f32_16x16x32_bf16 v[72:75], a[4:7], v[224:227], 0
    ds_read_b64_tr_b16 a[52:53], v2 offset:28672
    buffer_load_dwordx4 v6, s[8:11], s89 offen offset:1024 lds
    v_mfma_f32_16x16x32_bf16 v[76:79], a[4:7], v[228:231], 0
    ds_read_b64_tr_b16 a[54:55], v2 offset:30720
    buffer_load_dwordx4 v6, s[8:11], s90 offen offset:2048 lds
    v_mfma_f32_16x16x32_bf16 v[208:211], a[8:11], v[128:131], v[240:243]
    ds_read_b128 a[56:59], v3 offset:3072
    s_and_b32 s24, s45, 3
    v_mfma_f32_16x16x32_bf16 v[212:215], a[8:11], v[132:135], v[244:247]
    ds_read_b64_tr_b16 a[0:1], v1 offset:28928
    v_max3_f32 v10, v216, v217, v218
    v_mfma_f32_16x16x32_bf16 v[80:83], a[12:15], v[224:227], 0
    ds_read_b64_tr_b16 a[2:3], v1 offset:30976
    v_max3_f32 v255, v219, v220, v221
    v_mfma_f32_16x16x32_bf16 v[84:87], a[12:15], v[228:231], 0
    ds_read_b128 a[4:7], v4 offset:3072
    v_max3_f32 v10, v222, v223, v10
    v_mfma_f32_16x16x32_bf16 v[208:211], a[16:19], v[136:139], v[208:211]
    ds_read_b64_tr_b16 a[8:9], v2 offset:28928
    v_max_f32 v10, v10, v255
    v_mfma_f32_16x16x32_bf16 v[212:215], a[16:19], v[140:143], v[212:215]
    ds_read_b64_tr_b16 a[10:11], v2 offset:30976
    s_waitcnt lgkmcnt(6)
    v_mfma_f32_16x16x32_bf16 v[88:91], a[20:23], v[224:227], 0
    ds_read_b128 a[12:15], v3 offset:8192
    v_cmp_lt_f32 vcc, s98, v10
    v_mfma_f32_16x16x32_bf16 v[92:95], a[20:23], v[228:231], 0
    buffer_load_dwordx4 v6, s[8:11], s91 offen offset:3072 lds
    v_add_u32 v6, 16384, v6
    v_mfma_f32_16x16x32_bf16 v[208:211], a[24:27], v[144:147], v[208:211]
    s_cbranch_vccnz L_RARE2
L_BACK2:
    v_and_b32 v6, 0x3ffff, v6
    v_mfma_f32_16x16x32_bf16 v[212:215], a[24:27], v[148:151], v[212:215]
    v_exp_f32 v216, v216
    v_mfma_f32_16x16x32_bf16 v[96:99], a[28:31], v[224:227], 0
    v_exp_f32 v217, v217
    v_mfma_f32_16x16x32_bf16 v[100:103], a[28:31], v[228:231], 0
    v_exp_f32 v218, v218
    v_mfma_f32_16x16x32_bf16 v[208:211], a[32:35], v[152:155], v[208:211]
    v_exp_f32 v219, v219
    v_mfma_f32_16x16x32_bf16 v[212:215], a[32:35], v[156:159], v[212:215]
    v_exp_f32 v220, v220
    v_mfma_f32_16x16x32_bf16 v[104:107], a[36:39], v[224:227], 0
    ds_read_b64_tr_b16 a[16:17], v1 offset:16384
    s_add_u32 m0, s47, 81920
    v_mfma_f32_16x16x32_bf16 v[108:111], a[36:39], v[228:231], 0
    ds_read_b64_tr_b16 a[18:19], v1 offset:18432
    buffer_load_dwordx4 v5, s[12:15], 0 offen offset:0 lds
    v_mfma_f32_16x16x32_bf16 v[208:211], a[40:43], v[160:163], v[208:211]
    v_exp_f32 v221, v221
    v_mfma_f32_16x16x32_bf16 v[212:215], a[40:43], v[164:167], v[212:215]
    ds_read_b128 a[20:23], v4 offset:8192
    v_cvt_pk_bf16_f32 v234, v216, v217
    v_mfma_f32_16x16x32_bf16 v[112:115], a[44:47], v[224:227], 0
    v_exp_f32 v222, v222
    v_mfma_f32_16x16x32_bf16 v[116:119], a[44:47], v[228:231], 0
    ds_read_b64_tr_b16 a[24:25], v2 offset:16384
    ds_read_b64_tr_b16 a[26:27], v2 offset:18432
    v_mfma_f32_16x16x32_bf16 v[208:211], a[48:51], v[168:171], v[208:211]
    v_exp_f32 v223, v223
    v_mfma_f32_16x16x32_bf16 v[212:215], a[48:51], v[172:175], v[212:215]
    ds_read_b128 a[28:31], v3 offset:9216
    v_cvt_pk_bf16_f32 v235, v218, v219
    v_mfma_f32_16x16x32_bf16 v[120:123], a[52:55], v[224:227], 0
    ds_read_b64_tr_b16 a[32:33], v1 offset:16640
    v_cvt_pk_bf16_f32 v238, v220, v221
    v_mfma_f32_16x16x32_bf16 v[124:127], a[52:55], v[228:231], 0
    ds_read_b64_tr_b16 a[34:35], v1 offset:18688
    s_waitcnt lgkmcnt(5)
    v_mfma_f32_16x16x32_bf16 v[208:211], a[56:59], v[176:179], v[208:211]
    ds_read_b128 a[36:39], v4 offset:9216
    v_cvt_pk_bf16_f32 v239, v222, v223
    v_mfma_f32_16x16x32_bf16 v[212:215], a[56:59], v[180:183], v[212:215]
    ds_read_b64_tr_b16 a[40:41], v2 offset:16640
    buffer_load_dwordx4 v5, s[12:15], s85 offen offset:1024 lds
    v_mfma_f32_16x16x32_bf16 v[192:195], a[0:3], v[224:227], 0
    ds_read_b64_tr_b16 a[42:43], v2 offset:18688
    s_mul_i32 s24, s24, 7
    v_mfma_f32_16x16x32_bf16 v[196:199], a[0:3], v[228:231], 0
    ds_read_b128 a[44:47], v3 offset:10240
    s_mul_i32 s94, s44, 28
    v_mfma_f32_16x16x32_bf16 v[208:211], a[4:7], v[184:187], v[208:211]
    ds_read_b64_tr_b16 a[48:49], v1 offset:20480
    s_add_u32 s24, s24, s94
    v_mfma_f32_16x16x32_bf16 v[212:215], a[4:7], v[188:191], v[212:215]
    ds_read_b64_tr_b16 a[50:51], v1 offset:22528
    s_lshl_b32 s24, s24, 14
    v_mfma_f32_16x16x32_bf16 v[200:203], a[8:11], v[224:227], 0
    ds_read_b128 a[52:55], v4 offset:10240
    s_lshl1_add_u32 s25, s71, s94
    v_mfma_f32_16x16x32_bf16 v[204:207], a[8:11], v[228:231], 0
    ds_read_b64_tr_b16 a[56:57], v2 offset:20480
    buffer_load_dwordx4 v5, s[12:15], s86 offen offset:2048 lds
    v_mfma_f32_16x16x32_bf16 v[216:219], a[12:15], v[128:131], v[240:243]
    ds_read_b64_tr_b16 a[58:59], v2 offset:22528
    s_lshl_b32 s25, s25, 14
    v_mfma_f32_16x16x32_bf16 v[220:223], a[12:15], v[132:135], v[244:247]
    ds_read_b128 a[0:3], v3 offset:11264
    v_subrev_u32 v3, 131072, v3
    v_mfma_f32_16x16x32_bf16 a[64:67], a[60:63], v[232:235], a[64:67]
    ds_read_b64_tr_b16 a[4:5], v1 offset:20736
    v_max3_f32 v10, v208, v209, v210
    v_mfma_f32_16x16x32_bf16 a[68:71], a[60:63], v[236:239], a[68:71]
    ds_read_b64_tr_b16 a[6:7], v1 offset:22784
    v_subrev_u32 v1, 131072, v1
    v_mfma_f32_16x16x32_bf16 v[16:19], a[16:19], v[232:235], v[16:19]
    ds_read_b128 a[8:11], v4 offset:11264
    v_subrev_u32 v4, 131072, v4
    v_mfma_f32_16x16x32_bf16 v[20:23], a[16:19], v[236:239], v[20:23]
    ds_read_b64_tr_b16 a[12:13], v2 offset:20736
    s_waitcnt vmcnt(17)
    v_mfma_f32_16x16x32_bf16 v[216:219], a[20:23], v[136:139], v[216:219]
    ds_read_b64_tr_b16 a[14:15], v2 offset:22784
    v_subrev_u32 v2, 131072, v2
    v_mfma_f32_16x16x32_bf16 v[220:223], a[20:23], v[140:143], v[220:223]
    s_barrier
    s_waitcnt lgkmcnt(5)
    v_mfma_f32_16x16x32_bf16 v[24:27], a[24:27], v[232:235], v[24:27]
    ds_read_b128 a[16:19], v3 offset:0
    v_max3_f32 v255, v211, v212, v213
    v_mfma_f32_16x16x32_bf16 v[28:31], a[24:27], v[236:239], v[28:31]
    ds_read_b64_tr_b16 a[20:21], v1 offset:24576
    v_max3_f32 v10, v214, v215, v10
    v_mfma_f32_16x16x32_bf16 v[216:219], a[28:31], v[144:147], v[216:219]
    ds_read_b64_tr_b16 a[22:23], v1 offset:26624
    v_max_f32 v10, v10, v255
    v_mfma_f32_16x16x32_bf16 v[220:223], a[28:31], v[148:151], v[220:223]
    ds_read_b128 a[24:27], v4 offset:0
    v_cmp_lt_f32 vcc, s98, v10
    v_mfma_f32_16x16x32_bf16 v[32:35], a[32:35], v[232:235], v[32:35]
    ds_read_b64_tr_b16 a[28:29], v2 offset:24576
    buffer_load_dwordx4 v5, s[12:15], s87 offen offset:3072 lds
    v_mfma_f32_16x16x32_bf16 v[36:39], a[32:35], v[236:239], v[36:39]
    s_cbranch_vccnz L_RARE3
L_BACK3:
    v_add_u32 v5, 16384, v5
    v_mfma_f32_16x16x32_bf16 v[216:219], a[36:39], v[152:155], v[216:219]
    v_exp_f32 v208, v208
    v_mfma_f32_16x16x32_bf16 v[220:223], a[36:39], v[156:159], v[220:223]
    v_exp_f32 v209, v209
    v_mfma_f32_16x16x32_bf16 v[40:43], a[40:43], v[232:235], v[40:43]
    v_exp_f32 v210, v210
    v_mfma_f32_16x16x32_bf16 v[44:47], a[40:43], v[236:239], v[44:47]
    v_exp_f32 v211, v211
    v_mfma_f32_16x16x32_bf16 v[216:219], a[44:47], v[160:163], v[216:219]
    s_waitcnt vmcnt(15)
    v_cmp_gt_u32 s[26:27], 1, v14
    v_mfma_f32_16x16x32_bf16 v[220:223], a[44:47], v[164:167], v[220:223]
    ds_read_b64_tr_b16 a[30:31], v2 offset:26624
    v_and_b32 v5, 0x3ffff, v5
    v_mfma_f32_16x16x32_bf16 v[48:51], a[48:51], v[232:235], v[48:51]
    ds_read_b128 a[32:35], v3 offset:1024
    s_cmp_lg_u64 s[26:27], 0
    s_cbranch_scc1 L_SPIN1
L_OK1:
    v_mfma_f32_16x16x32_bf16 v[52:55], a[48:51], v[236:239], v[52:55]
    ds_read_b64_tr_b16 a[36:37], v1 offset:24832
    buffer_load_dwordx4 a[144:147], v7, s[40:43], s1 offen offset:0 sc1
    v_mfma_f32_16x16x32_bf16 v[216:219], a[52:55], v[168:171], v[216:219]
    v_exp_f32 v212, v212
    v_mfma_f32_16x16x32_bf16 v[220:223], a[52:55], v[172:175], v[220:223]
    ds_read_b64_tr_b16 a[38:39], v1 offset:26880
    s_add_u32 m0, s47, 98304
    v_mfma_f32_16x16x32_bf16 v[56:59], a[56:59], v[232:235], v[56:59]
    ds_read_b128 a[40:43], v4 offset:1024
    buffer_load_dwordx4 v6, s[8:11], s88 offen offset:0 lds
    v_mfma_f32_16x16x32_bf16 v[60:63], a[56:59], v[236:239], v[60:63]
    v_exp_f32 v213, v213
    v_mfma_f32_16x16x32_bf16 v[216:219], a[0:3], v[176:179], v[216:219]
    ds_read_b64_tr_b16 a[44:45], v2 offset:24832
    v_cvt_pk_bf16_f32 v224, v208, v209
    v_mfma_f32_16x16x32_bf16 v[220:223], a[0:3], v[180:183], v[220:223]
    ds_read_b64_tr_b16 a[46:47], v2 offset:26880
    s_waitcnt lgkmcnt(4)
    v_mfma_f32_16x16x32_bf16 v[64:67], a[4:7], v[232:235], v[64:67]
    ds_read_b128 a[48:51], v3 offset:2048
    buffer_load_dwordx4 a[148:151], v7, s[40:43], s1 offen offset:1024 sc1
    v_mfma_f32_16x16x32_bf16 v[68:71], a[4:7], v[236:239], v[68:71]
    v_exp_f32 v214, v214
    v_mfma_f32_16x16x32_bf16 v[216:219], a[8:11], v[184:187], v[216:219]
    ds_read_b64_tr_b16 a[52:53], v1 offset:28672
    v_cvt_pk_bf16_f32 v225, v210, v211
    v_mfma_f32_16x16x32_bf16 v[220:223], a[8:11], v[188:191], v[220:223]
    ds_read_b64_tr_b16 a[54:55], v1 offset:30720
    ds_read_b128 a[56:59], v4 offset:2048
    v_mfma_f32_16x16x32_bf16 v[72:75], a[12:15], v[232:235], v[72:75]
    v_exp_f32 v215, v215
    v_mfma_f32_16x16x32_bf16 v[76:79], a[12:15], v[236:239], v[76:79]
    v_cvt_pk_bf16_f32 v228, v212, v213
    v_cvt_pk_bf16_f32 v229, v214, v215
    v_mfma_f32_16x16x32_bf16 v[208:211], a[16:19], v[128:131], v[240:243]
    ds_read_b64_tr_b16 a[0:1], v2 offset:28672
    buffer_load_dwordx4 v6, s[8:11], s89 offen offset:1024 lds
    v_mfma_f32_16x16x32_bf16 v[212:215], a[16:19], v[132:135], v[244:247]
    ds_read_b64_tr_b16 a[2:3], v2 offset:30720
    buffer_load_dwordx4 a[152:155], v7, s[40:43], s1 offen offset:2048 sc1
    v_mfma_f32_16x16x32_bf16 v[80:83], a[20:23], v[232:235], v[80:83]
    ds_read_b128 a[4:7], v3 offset:3072
    v_max3_f32 v10, v216, v217, v218
    v_mfma_f32_16x16x32_bf16 v[84:87], a[20:23], v[236:239], v[84:87]
    ds_read_b64_tr_b16 a[8:9], v1 offset:28928
    v_max3_f32 v255, v219, v220, v221
    v_mfma_f32_16x16x32_bf16 v[208:211], a[24:27], v[136:139], v[208:211]
    ds_read_b64_tr_b16 a[10:11], v1 offset:30976
    v_max3_f32 v10, v222, v223, v10
    v_mfma_f32_16x16x32_bf16 v[212:215], a[24:27], v[140:143], v[212:215]
    ds_read_b128 a[12:15], v4 offset:3072
    v_max_f32 v10, v10, v255
    v_mfma_f32_16x16x32_bf16 v[88:91], a[28:31], v[232:235], v[88:91]
    ds_read_b64_tr_b16 a[16:17], v2 offset:28928
    buffer_load_dwordx4 v6, s[8:11], s90 offen offset:2048 lds
    v_mfma_f32_16x16x32_bf16 v[92:95], a[28:31], v[236:239], v[92:95]
    ds_read_b64_tr_b16 a[18:19], v2 offset:30976
    v_cmp_lt_f32 vcc, s98, v10
    v_mfma_f32_16x16x32_bf16 v[208:211], a[32:35], v[144:147], v[208:211]
    ds_read_b128 a[20:23], v3 offset:8192
    buffer_load_dwordx4 a[156:159], v7, s[40:43], s1 offen offset:3072 sc1
    v_mfma_f32_16x16x32_bf16 v[212:215], a[32:35], v[148:151], v[212:215]
    ds_read_b64_tr_b16 a[24:25], v1 offset:16384
    s_waitcnt lgkmcnt(6)
    v_mfma_f32_16x16x32_bf16 v[96:99], a[36:39], v[232:235], v[96:99]
    ds_read_b64_tr_b16 a[26:27], v1 offset:18432
    s_add_u32 s1, s1, 4096
    v_mfma_f32_16x16x32_bf16 v[100:103], a[36:39], v[236:239], v[100:103]
    s_cbranch_vccnz L_RARE4
L_BACK4:
    s_add_u32 s94, s47, 41943040
    v_mfma_f32_16x16x32_bf16 v[208:211], a[40:43], v[152:155], v[208:211]
    v_exp_f32 v216, v216
    v_mfma_f32_16x16x32_bf16 v[212:215], a[40:43], v[156:159], v[212:215]
    v_exp_f32 v217, v217
    v_mfma_f32_16x16x32_bf16 v[104:107], a[44:47], v[232:235], v[104:107]
    ds_read_b128 a[28:31], v4 offset:8192
    buffer_load_dwordx4 v6, s[8:11], s91 offen offset:3072 lds
    v_mfma_f32_16x16x32_bf16 v[108:111], a[44:47], v[236:239], v[108:111]
    v_exp_f32 v218, v218
    v_mfma_f32_16x16x32_bf16 v[208:211], a[48:51], v[160:163], v[208:211]
    v_exp_f32 v219, v219
    v_mfma_f32_16x16x32_bf16 v[212:215], a[48:51], v[164:167], v[212:215]
    ds_read_b64_tr_b16 a[32:33], v2 offset:16384
    buffer_load_dwordx4 a[160:163], v7, s[40:43], s1 offen offset:0 sc1
    v_mfma_f32_16x16x32_bf16 v[112:115], a[52:55], v[232:235], v[112:115]
    ds_read_b64_tr_b16 a[34:35], v2 offset:18432
    v_add_u32 v6, 16384, v6
    v_mfma_f32_16x16x32_bf16 v[116:119], a[52:55], v[236:239], v[116:119]
    ds_read_b128 a[36:39], v3 offset:9216
    v_and_b32 v6, 0x3ffff, v6
    v_mfma_f32_16x16x32_bf16 v[208:211], a[56:59], v[168:171], v[208:211]
    v_exp_f32 v220, v220
    v_mfma_f32_16x16x32_bf16 v[212:215], a[56:59], v[172:175], v[212:215]
    ds_read_b64_tr_b16 a[40:41], v1 offset:16640
    s_add_u32 m0, s47, 114688
    v_mfma_f32_16x16x32_bf16 v[120:123], a[0:3], v[232:235], v[120:123]
    ds_read_b64_tr_b16 a[42:43], v1 offset:18688
    buffer_load_dwordx4 v5, s[12:15], 0 offen offset:0 lds
    v_mfma_f32_16x16x32_bf16 v[124:127], a[0:3], v[236:239], v[124:127]
    v_exp_f32 v221, v221
    v_mfma_f32_16x16x32_bf16 v[208:211], a[4:7], v[176:179], v[208:211]
    ds_read_b128 a[44:47], v4 offset:9216
    buffer_load_dwordx4 a[164:167], v7, s[40:43], s1 offen offset:1024 sc1
    v_mfma_f32_16x16x32_bf16 v[212:215], a[4:7], v[180:183], v[212:215]
    ds_read_b64_tr_b16 a[48:49], v2 offset:16640
    s_waitcnt lgkmcnt(4)
    v_mfma_f32_16x16x32_bf16 v[192:195], a[8:11], v[232:235], v[192:195]
    ds_read_b64_tr_b16 a[50:51], v2 offset:18688
    v_cvt_pk_bf16_f32 v226, v216, v217
    v_mfma_f32_16x16x32_bf16 v[196:199], a[8:11], v[236:239], v[196:199]
    v_exp_f32 v222, v222
    v_mfma_f32_16x16x32_bf16 v[208:211], a[12:15], v[184:187], v[208:211]
    ds_read_b128 a[52:55], v3 offset:10240
    v_cvt_pk_bf16_f32 v227, v218, v219
    v_mfma_f32_16x16x32_bf16 v[212:215], a[12:15], v[188:191], v[212:215]
    ds_read_b64_tr_b16 a[56:57], v1 offset:20480
    ds_read_b64_tr_b16 a[58:59], v1 offset:22528
    v_mfma_f32_16x16x32_bf16 v[200:203], a[16:19], v[232:235], v[200:203]
    v_exp_f32 v223, v223
    v_mfma_f32_16x16x32_bf16 v[204:207], a[16:19], v[236:239], v[204:207]
    v_cvt_pk_bf16_f32 v230, v220, v221
    v_cvt_pk_bf16_f32 v231, v222, v223
    v_mfma_f32_16x16x32_bf16 v[216:219], a[20:23], v[128:131], v[240:243]
    ds_read_b128 a[0:3], v4 offset:10240
    buffer_load_dwordx2 a[192:193], v7, s[40:43], s1 offen offset:2048 sc1
    v_mfma_f32_16x16x32_bf16 v[220:223], a[20:23], v[132:135], v[244:247]
    buffer_load_dwordx4 v5, s[12:15], s85 offen offset:1024 lds
    ds_read_b64_tr_b16 a[4:5], v2 offset:20480
    v_mfma_f32_16x16x32_bf16 a[64:67], a[60:63], v[224:227], a[64:67]
    ds_read_b64_tr_b16 a[6:7], v2 offset:22528
    v_max3_f32 v10, v208, v209, v210
    v_mfma_f32_16x16x32_bf16 a[68:71], a[60:63], v[228:231], a[68:71]
    ds_read_b128 a[8:11], v3 offset:11264
    s_waitcnt vmcnt(22)
    v_mfma_f32_16x16x32_bf16 v[16:19], a[24:27], v[224:227], v[16:19]
    ds_read_b64_tr_b16 a[12:13], v1 offset:20736
    s_barrier
    v_mfma_f32_16x16x32_bf16 v[20:23], a[24:27], v[228:231], v[20:23]
    ds_read_b64_tr_b16 a[14:15], v1 offset:22784
    v_max3_f32 v255, v211, v212, v213
    v_mfma_f32_16x16x32_bf16 v[216:219], a[28:31], v[136:139], v[216:219]
    ds_read_b128 a[16:19], v4 offset:11264
    buffer_load_dwordx4 v5, s[12:15], s86 offen offset:2048 lds
    v_mfma_f32_16x16x32_bf16 v[220:223], a[28:31], v[140:143], v[220:223]
    ds_read_b64_tr_b16 a[20:21], v2 offset:20736
    buffer_load_dwordx2 a[196:197], v7, s[40:43], s1 offen offset:2056 sc1
    v_mfma_f32_16x16x32_bf16 v[24:27], a[32:35], v[224:227], v[24:27]
    ds_read_b64_tr_b16 a[22:23], v2 offset:22784
    s_add_u32 s1, s1, 3072
    v_mfma_f32_16x16x32_bf16 v[28:31], a[32:35], v[228:231], v[28:31]
    ds_read_b128 a[24:27], v3 offset:32768
    v_max3_f32 v10, v214, v215, v10
    v_mfma_f32_16x16x32_bf16 v[216:219], a[36:39], v[144:147], v[216:219]
    ds_read_b64_tr_b16 a[28:29], v1 offset:57344
    v_max_f32 v10, v10, v255
    v_mfma_f32_16x16x32_bf16 v[220:223], a[36:39], v[148:151], v[220:223]
    ds_read_b64_tr_b16 a[30:31], v1 offset:59392
    s_waitcnt lgkmcnt(6)
    v_mfma_f32_16x16x32_bf16 v[32:35], a[40:43], v[224:227], v[32:35]
    ds_read_b128 a[32:35], v4 offset:32768
    v_cmp_lt_f32 vcc, s98, v10
    v_mfma_f32_16x16x32_bf16 v[36:39], a[40:43], v[228:231], v[36:39]
    ds_read_b64_tr_b16 a[36:37], v2 offset:57344
    buffer_load_dwordx4 v5, s[12:15], s87 offen offset:3072 lds
    v_mfma_f32_16x16x32_bf16 v[216:219], a[44:47], v[152:155], v[216:219]
    s_cbranch_vccnz L_RARE5
L_BACK5:
    v_add_u32 v5, 16384, v5
    v_mfma_f32_16x16x32_bf16 v[220:223], a[44:47], v[156:159], v[220:223]
    ds_read_b64_tr_b16 a[38:39], v2 offset:59392
    buffer_load_dwordx4 a[168:171], v7, s[40:43], s1 offen offset:0 sc1
    v_mfma_f32_16x16x32_bf16 v[40:43], a[48:51], v[224:227], v[40:43]
    v_exp_f32 v208, v208
    v_mfma_f32_16x16x32_bf16 v[44:47], a[48:51], v[228:231], v[44:47]
    v_exp_f32 v209, v209
    v_mfma_f32_16x16x32_bf16 v[216:219], a[52:55], v[160:163], v[216:219]
    v_exp_f32 v210, v210
    v_mfma_f32_16x16x32_bf16 v[220:223], a[52:55], v[164:167], v[220:223]
    ds_read_b128 a[40:43], v3 offset:33792
    v_and_b32 v5, 0x3ffff, v5
    v_mfma_f32_16x16x32_bf16 v[48:51], a[56:59], v[224:227], v[48:51]
    v_exp_f32 v211, v211
    v_mfma_f32_16x16x32_bf16 v[52:55], a[56:59], v[228:231], v[52:55]
    ds_read_b64_tr_b16 a[44:45], v1 offset:57600
    s_mov_b32 s77, 13312
    v_mfma_f32_16x16x32_bf16 v[216:219], a[0:3], v[168:171], v[216:219]
    ds_read_b64_tr_b16 a[46:47], v1 offset:59648
    buffer_load_dwordx4 a[172:175], v7, s[40:43], s1 offen offset:1024 sc1
    v_mfma_f32_16x16x32_bf16 v[220:223], a[0:3], v[172:175], v[220:223]
    ds_read_b128 a[48:51], v4 offset:33792
    s_mov_b32 s78, 26624
    v_mfma_f32_16x16x32_bf16 v[56:59], a[4:7], v[224:227], v[56:59]
    v_exp_f32 v212, v212
    v_mfma_f32_16x16x32_bf16 v[60:63], a[4:7], v[228:231], v[60:63]
    s_mov_b32 s79, 39936
    ds_read_b64_tr_b16 a[52:53], v2 offset:57600
    v_mfma_f32_16x16x32_bf16 v[216:219], a[8:11], v[176:179], v[216:219]
L_PAD5:
    s_cbranch_execz L_PAD9
    ds_read_b64_tr_b16 a[54:55], v2 offset:59648
    v_accvgpr_read_b32 v15, a79
    v_mfma_f32_16x16x32_bf16 v[220:223], a[8:11], v[180:183], v[220:223]
    ds_read_b128 a[56:59], v3 offset:34816
    v_add_u32 v15, s101, v15
    v_mfma_f32_16x16x32_bf16 v[64:67], a[12:15], v[224:227], v[64:67]
    s_add_u32 m0, s47, 131072
    ds_read_b64_tr_b16 a[0:1], v1 offset:61440
    v_mfma_f32_16x16x32_bf16 v[68:71], a[12:15], v[228:231], v[68:71]
    ds_read_b64_tr_b16 a[2:3], v1 offset:63488
    s_waitcnt lgkmcnt(5)
    v_mfma_f32_16x16x32_bf16 v[216:219], a[16:19], v[184:187], v[216:219]
    buffer_load_dwordx4 v15, s[28:31], 0 offen offset:0 lds
    ds_read_b128 a[4:7], v4 offset:34816
    v_mfma_f32_16x16x32_bf16 v[220:223], a[16:19], v[188:191], v[220:223]
    v_exp_f32 v213, v213
    v_mfma_f32_16x16x32_bf16 v[72:75], a[20:23], v[224:227], v[72:75]
    buffer_load_dwordx4 a[176:179], v7, s[40:43], s1 offen offset:2048 sc1
    ds_read_b64_tr_b16 a[8:9], v2 offset:61440
    v_mfma_f32_16x16x32_bf16 v[76:79], a[20:23], v[228:231], v[76:79]
    v_cvt_pk_bf16_f32 v232, v208, v209
    v_exp_f32 v214, v214
    v_cvt_pk_bf16_f32 v233, v210, v211
    v_cvt_pk_bf16_f32 v236, v212, v213
    v_exp_f32 v215, v215
    s_nop 0
    v_cvt_pk_bf16_f32 v237, v214, v215
    v_mfma_f32_16x16x32_bf16 v[208:211], a[24:27], v[128:131], v[240:243]
    ds_read_b64_tr_b16 a[10:11], v2 offset:63488
    buffer_load_dwordx4 v15, s[28:31], s77 offen offset:1024 lds
    v_mfma_f32_16x16x32_bf16 v[212:215], a[24:27], v[132:135], v[244:247]
    ds_read_b128 a[12:15], v3 offset:35840
    v_max3_f32 v10, v216, v217, v218
    v_mfma_f32_16x16x32_bf16 v[80:83], a[28:31], v[224:227], v[80:83]
    ds_read_b64_tr_b16 a[16:17], v1 offset:61696
    v_max3_f32 v255, v219, v220, v221
    v_mfma_f32_16x16x32_bf16 v[84:87], a[28:31], v[228:231], v[84:87]
    ds_read_b64_tr_b16 a[18:19], v1 offset:63744
    v_max3_f32 v10, v222, v223, v10
    v_mfma_f32_16x16x32_bf16 v[208:211], a[32:35], v[136:139], v[208:211]
    ds_read_b128 a[20:23], v4 offset:35840
    v_max_f32 v10, v10, v255
    v_mfma_f32_16x16x32_bf16 v[212:215], a[32:35], v[140:143], v[212:215]
    ds_read_b64_tr_b16 a[24:25], v2 offset:61696
    buffer_load_dwordx4 a[180:183], v7, s[40:43], s1 offen offset:3072 sc1
    v_mfma_f32_16x16x32_bf16 v[88:91], a[36:39], v[224:227], v[88:91]
    ds_read_b64_tr_b16 a[26:27], v2 offset:63744
    s_add_u32 s1, s1, 4096
    v_mfma_f32_16x16x32_bf16 v[92:95], a[36:39], v[228:231], v[92:95]
    ds_read_b128 a[28:31], v3 offset:40960
    v_cmp_lt_f32 vcc, s98, v10
    v_mfma_f32_16x16x32_bf16 v[208:211], a[40:43], v[144:147], v[208:211]
    ds_read_b64_tr_b16 a[32:33], v1 offset:49152
    buffer_load_dwordx4 v15, s[28:31], s78 offen offset:2048 lds
    v_mfma_f32_16x16x32_bf16 v[212:215], a[40:43], v[148:151], v[212:215]
    s_cbranch_vccnz L_RARE6
L_BACK6:
    s_add_u32 s25, s25, s94
    v_mfma_f32_16x16x32_bf16 v[96:99], a[44:47], v[224:227], v[96:99]
    v_exp_f32 v216, v216
    v_mfma_f32_16x16x32_bf16 v[100:103], a[44:47], v[228:231], v[100:103]
    v_exp_f32 v217, v217
    v_mfma_f32_16x16x32_bf16 v[208:211], a[48:51], v[152:155], v[208:211]
    v_exp_f32 v218, v218
    v_mfma_f32_16x16x32_bf16 v[212:215], a[48:51], v[156:159], v[212:215]
    ds_read_b64_tr_b16 a[34:35], v1 offset:51200
    s_waitcnt lgkmcnt(2)
    v_mfma_f32_16x16x32_bf16 v[104:107], a[52:55], v[224:227], v[104:107]
    ds_read_b128 a[36:39], v4 offset:40960
    buffer_load_dwordx4 a[184:187], v7, s[40:43], s1 offen offset:0 sc1
    v_mfma_f32_16x16x32_bf16 v[108:111], a[52:55], v[228:231], v[108:111]
    v_exp_f32 v219, v219
    v_mfma_f32_16x16x32_bf16 v[208:211], a[56:59], v[160:163], v[208:211]
    v_exp_f32 v220, v220
    v_mfma_f32_16x16x32_bf16 v[212:215], a[56:59], v[164:167], v[212:215]
    v_exp_f32 v221, v221
    v_mfma_f32_16x16x32_bf16 v[112:115], a[0:3], v[224:227], v[112:115]
    ds_read_b64_tr_b16 a[40:41], v2 offset:49152
    v_cvt_pk_bf16_f32 v234, v216, v217
    v_mfma_f32_16x16x32_bf16 v[116:119], a[0:3], v[228:231], v[116:119]
    v_exp_f32 v222, v222
    v_mfma_f32_16x16x32_bf16 v[208:211], a[4:7], v[168:171], v[208:211]
    ds_read_b64_tr_b16 a[42:43], v2 offset:51200
    buffer_load_dwordx4 v15, s[28:31], s79 offen offset:3072 lds
    v_mfma_f32_16x16x32_bf16 v[212:215], a[4:7], v[172:175], v[212:215]
    ds_read_b128 a[44:47], v3 offset:41984
    buffer_load_dwordx4 a[188:191], v7, s[40:43], s1 offen offset:1024 sc1
    v_mfma_f32_16x16x32_bf16 v[120:123], a[8:11], v[224:227], v[120:123]
    ds_read_b64_tr_b16 a[48:49], v1 offset:49408
    v_cvt_pk_bf16_f32 v235, v218, v219
    v_mfma_f32_16x16x32_bf16 v[124:127], a[8:11], v[228:231], v[124:127]
    ds_read_b64_tr_b16 a[50:51], v1 offset:51456
    ds_read_b128 a[52:55], v4 offset:41984
    v_mfma_f32_16x16x32_bf16 v[208:211], a[12:15], v[176:179], v[208:211]
    v_exp_f32 v223, v223
    v_mfma_f32_16x16x32_bf16 v[212:215], a[12:15], v[180:183], v[212:215]
    ds_read_b64_tr_b16 a[56:57], v2 offset:49408
    v_cvt_pk_bf16_f32 v238, v220, v221
    v_mfma_f32_16x16x32_bf16 v[192:195], a[16:19], v[224:227], v[192:195]
    ds_read_b64_tr_b16 a[58:59], v2 offset:51456
    v_cvt_pk_bf16_f32 v239, v222, v223
    v_mfma_f32_16x16x32_bf16 v[196:199], a[16:19], v[228:231], v[196:199]
    ds_read_b128 a[0:3], v3 offset:43008
    v_add_u32 v15, 57344, v15
    v_mfma_f32_16x16x32_bf16 v[208:211], a[20:23], v[184:187], v[208:211]
    ds_read_b64_tr_b16 a[4:5], v1 offset:53248
    buffer_load_dwordx2 a[194:195], v7, s[40:43], s1 offen offset:2048 sc1
    v_mfma_f32_16x16x32_bf16 v[212:215], a[20:23], v[188:191], v[212:215]
    ds_read_b64_tr_b16 a[6:7], v1 offset:55296
    s_add_u32 m0, s47, 147456
    v_mfma_f32_16x16x32_bf16 v[200:203], a[24:27], v[224:227], v[200:203]
    ds_read_b128 a[8:11], v4 offset:43008
    buffer_load_dwordx4 v15, s[28:31], 0 offen offset:0 lds
    v_mfma_f32_16x16x32_bf16 v[204:207], a[24:27], v[228:231], v[204:207]
    ds_read_b64_tr_b16 a[12:13], v2 offset:53248
    s_add_u32 s24, s24, s94
    v_mfma_f32_16x16x32_bf16 v[216:219], a[28:31], v[128:131], v[240:243]
    ds_read_b64_tr_b16 a[14:15], v2 offset:55296
    s_lshr_b32 s94, s45, 2
    v_mfma_f32_16x16x32_bf16 v[220:223], a[28:31], v[132:135], v[244:247]
    ds_read_b128 a[16:19], v3 offset:44032
    v_add_u32 v3, 65536, v3
    v_mfma_f32_16x16x32_bf16 a[64:67], a[60:63], v[232:235], a[64:67]
    ds_read_b64_tr_b16 a[20:21], v1 offset:53504
    v_max3_f32 v10, v208, v209, v210
    v_mfma_f32_16x16x32_bf16 a[68:71], a[60:63], v[236:239], a[68:71]
    ds_read_b64_tr_b16 a[22:23], v1 offset:55552
    s_waitcnt lgkmcnt(6)
    v_mfma_f32_16x16x32_bf16 v[16:19], a[32:35], v[232:235], v[16:19]
    ds_read_b128 a[24:27], v4 offset:44032
    buffer_load_dwordx2 a[198:199], v7, s[40:43], s1 offen offset:2056 sc1
    v_mfma_f32_16x16x32_bf16 v[20:23], a[32:35], v[236:239], v[20:23]
    ds_read_b64_tr_b16 a[28:29], v2 offset:53504
    v_add_u32 v1, 65536, v1
    v_mfma_f32_16x16x32_bf16 v[216:219], a[36:39], v[136:139], v[216:219]
    ds_read_b64_tr_b16 a[30:31], v2 offset:55552
    s_add_u32 s1, s1, 3072
    v_mfma_f32_16x16x32_bf16 v[220:223], a[36:39], v[140:143], v[220:223]
    v_add_u32 v4, 65536, v4
    s_sub_u32 s69, s1, s72
    v_mfma_f32_16x16x32_bf16 v[24:27], a[40:43], v[232:235], v[24:27]
    s_waitcnt vmcnt(29)
    s_barrier
    v_mfma_f32_16x16x32_bf16 v[28:31], a[40:43], v[236:239], v[28:31]
    ds_read_b128 a[32:35], v3 offset:0
    v_add_u32 v2, 65536, v2
    v_mfma_f32_16x16x32_bf16 v[216:219], a[44:47], v[144:147], v[216:219]
    s_cmp_eq_u32 s69, 28672
    s_cselect_b32 s1, s72, s1
    v_mfma_f32_16x16x32_bf16 v[220:223], a[44:47], v[148:151], v[220:223]
    ds_read_b64_tr_b16 a[36:37], v1 offset:24576
    v_max3_f32 v255, v211, v212, v213
    v_mfma_f32_16x16x32_bf16 v[32:35], a[48:51], v[232:235], v[32:35]
    ds_read_b64_tr_b16 a[38:39], v1 offset:26624
    v_max3_f32 v10, v214, v215, v10
    v_mfma_f32_16x16x32_bf16 v[36:39], a[48:51], v[236:239], v[36:39]
    ds_read_b128 a[40:43], v4 offset:0
    v_max_f32 v10, v10, v255
    v_mfma_f32_16x16x32_bf16 v[216:219], a[52:55], v[152:155], v[216:219]
    ds_read_b64_tr_b16 a[44:45], v2 offset:24576
    v_cmp_lt_f32 vcc, s98, v10
    v_mfma_f32_16x16x32_bf16 v[220:223], a[52:55], v[156:159], v[220:223]
    ds_read_b64_tr_b16 a[46:47], v2 offset:26624
    buffer_load_dwordx4 v15, s[28:31], s77 offen offset:1024 lds
    v_mfma_f32_16x16x32_bf16 v[40:43], a[56:59], v[232:235], v[40:43]
    s_cbranch_vccnz L_RARE7
L_BACK7:
    v_add_u32 v15, 28672, v15
    v_mfma_f32_16x16x32_bf16 v[44:47], a[56:59], v[236:239], v[44:47]
    v_exp_f32 v208, v208
    v_mfma_f32_16x16x32_bf16 v[216:219], a[0:3], v[160:163], v[216:219]
    ds_read_b128 a[48:51], v3 offset:1024
    buffer_load_dwordx4 a[200:203], v7, s[40:43], s1 offen offset:0 sc1
    v_mfma_f32_16x16x32_bf16 v[220:223], a[0:3], v[164:167], v[220:223]
    v_exp_f32 v209, v209
    v_mfma_f32_16x16x32_bf16 v[48:51], a[4:7], v[232:235], v[48:51]
    v_exp_f32 v210, v210
    v_mfma_f32_16x16x32_bf16 v[52:55], a[4:7], v[236:239], v[52:55]
    ds_read_b64_tr_b16 a[52:53], v1 offset:24832
    s_waitcnt lgkmcnt(2)
    v_mfma_f32_16x16x32_bf16 v[216:219], a[8:11], v[168:171], v[216:219]
    v_exp_f32 v211, v211
    v_mfma_f32_16x16x32_bf16 v[220:223], a[8:11], v[172:175], v[220:223]
    v_exp_f32 v212, v212
    v_mfma_f32_16x16x32_bf16 v[56:59], a[12:15], v[232:235], v[56:59]
    ds_read_b64_tr_b16 a[54:55], v1 offset:26880
    s_add_u32 m0, s47, 0
    v_mfma_f32_16x16x32_bf16 v[60:63], a[12:15], v[236:239], v[60:63]
    ds_read_b128 a[56:59], v4 offset:1024
    buffer_load_dwordx4 a[204:207], v7, s[40:43], s1 offen offset:1024 sc1
    v_mfma_f32_16x16x32_bf16 v[216:219], a[16:19], v[176:179], v[216:219]
    ds_read_b64_tr_b16 a[0:1], v2 offset:24832
    buffer_load_dwordx4 v6, s[8:11], s88 offen offset:0 lds
    v_mfma_f32_16x16x32_bf16 v[220:223], a[16:19], v[180:183], v[220:223]
    v_exp_f32 v213, v213
    v_mfma_f32_16x16x32_bf16 v[64:67], a[20:23], v[232:235], v[64:67]
    ds_read_b64_tr_b16 a[2:3], v2 offset:26880
    v_cvt_pk_bf16_f32 v224, v208, v209
    v_mfma_f32_16x16x32_bf16 v[68:71], a[20:23], v[236:239], v[68:71]
    v_exp_f32 v214, v214
    v_mfma_f32_16x16x32_bf16 v[216:219], a[24:27], v[184:187], v[216:219]
    ds_read_b128 a[4:7], v3 offset:2048
    v_cvt_pk_bf16_f32 v225, v210, v211
    v_mfma_f32_16x16x32_bf16 v[220:223], a[24:27], v[188:191], v[220:223]
    ds_read_b64_tr_b16 a[8:9], v1 offset:28672
    ds_read_b64_tr_b16 a[10:11], v1 offset:30720
    v_mfma_f32_16x16x32_bf16 v[72:75], a[28:31], v[232:235], v[72:75]
    v_exp_f32 v215, v215
    v_mfma_f32_16x16x32_bf16 v[76:79], a[28:31], v[236:239], v[76:79]
    v_cvt_pk_bf16_f32 v228, v212, v213
    v_cvt_pk_bf16_f32 v229, v214, v215
    v_mfma_f32_16x16x32_bf16 v[208:211], a[32:35], v[128:131], v[240:243]
    ds_read_b128 a[12:15], v4 offset:2048
    buffer_load_dwordx4 a[208:211], v7, s[40:43], s1 offen offset:2048 sc1
    v_mfma_f32_16x16x32_bf16 v[212:215], a[32:35], v[132:135], v[244:247]
    buffer_load_dwordx4 v6, s[8:11], s89 offen offset:1024 lds
    ds_read_b64_tr_b16 a[16:17], v2 offset:28672
    v_mfma_f32_16x16x32_bf16 v[80:83], a[36:39], v[232:235], v[80:83]
    ds_read_b64_tr_b16 a[18:19], v2 offset:30720
    v_max3_f32 v10, v216, v217, v218
    v_mfma_f32_16x16x32_bf16 v[84:87], a[36:39], v[236:239], v[84:87]
    ds_read_b128 a[20:23], v3 offset:3072
    v_max3_f32 v255, v219, v220, v221
    v_mfma_f32_16x16x32_bf16 v[208:211], a[40:43], v[136:139], v[208:211]
    ds_read_b64_tr_b16 a[24:25], v1 offset:28928
    v_max3_f32 v10, v222, v223, v10
    v_mfma_f32_16x16x32_bf16 v[212:215], a[40:43], v[140:143], v[212:215]
    ds_read_b64_tr_b16 a[26:27], v1 offset:30976
    v_max_f32 v10, v10, v255
    v_mfma_f32_16x16x32_bf16 v[88:91], a[44:47], v[232:235], v[88:91]
    ds_read_b128 a[28:31], v4 offset:3072
    buffer_load_dwordx4 v6, s[8:11], s90 offen offset:2048 lds
    v_mfma_f32_16x16x32_bf16 v[92:95], a[44:47], v[236:239], v[92:95]
    ds_read_b64_tr_b16 a[32:33], v2 offset:28928
    s_waitcnt lgkmcnt(6)
    v_mfma_f32_16x16x32_bf16 v[208:211], a[48:51], v[144:147], v[208:211]
    ds_read_b64_tr_b16 a[34:35], v2 offset:30976
    buffer_load_dwordx4 a[212:215], v7, s[40:43], s1 offen offset:3072 sc1
    v_mfma_f32_16x16x32_bf16 v[212:215], a[48:51], v[148:151], v[212:215]
    ds_read_b128 a[36:39], v3 offset:8192
    s_add_u32 s1, s1, 4096
    v_mfma_f32_16x16x32_bf16 v[96:99], a[52:55], v[232:235], v[96:99]
    ds_read_b64_tr_b16 a[40:41], v1 offset:16384
    v_cmp_lt_f32 vcc, s98, v10
    v_mfma_f32_16x16x32_bf16 v[100:103], a[52:55], v[236:239], v[100:103]
    ds_read_b64_tr_b16 a[42:43], v1 offset:18432
    buffer_load_dwordx4 v6, s[8:11], s91 offen offset:3072 lds
    v_mfma_f32_16x16x32_bf16 v[208:211], a[56:59], v[152:155], v[208:211]
    s_cbranch_vccnz L_RARE8
L_BACK8:
    v_add_u32 v6, 16384, v6
    v_mfma_f32_16x16x32_bf16 v[212:215], a[56:59], v[156:159], v[212:215]
    v_exp_f32 v216, v216
    v_mfma_f32_16x16x32_bf16 v[104:107], a[0:3], v[232:235], v[104:107]
    v_exp_f32 v217, v217
    v_mfma_f32_16x16x32_bf16 v[108:111], a[0:3], v[236:239], v[108:111]
    v_exp_f32 v218, v218
    v_mfma_f32_16x16x32_bf16 v[208:211], a[4:7], v[160:163], v[208:211]
    ds_read_b128 a[44:47], v4 offset:8192
    buffer_load_dwordx4 a[216:219], v7, s[40:43], s1 offen offset:0 sc1
    v_mfma_f32_16x16x32_bf16 v[212:215], a[4:7], v[164:167], v[212:215]
    v_exp_f32 v219, v219
    v_mfma_f32_16x16x32_bf16 v[112:115], a[8:11], v[232:235], v[112:115]
    ds_read_b64_tr_b16 a[48:49], v2 offset:16384
    v_and_b32 v6, 0x3ffff, v6
    v_mfma_f32_16x16x32_bf16 v[116:119], a[8:11], v[236:239], v[116:119]
    v_exp_f32 v220, v220
    v_mfma_f32_16x16x32_bf16 v[208:211], a[12:15], v[168:171], v[208:211]
    ds_read_b64_tr_b16 a[50:51], v2 offset:18432
    s_add_u32 m0, s47, 16384
    v_mfma_f32_16x16x32_bf16 v[212:215], a[12:15], v[172:175], v[212:215]
    ds_read_b128 a[52:55], v3 offset:9216
    s_waitcnt lgkmcnt(4)
    v_mfma_f32_16x16x32_bf16 v[120:123], a[16:19], v[232:235], v[120:123]
    ds_read_b64_tr_b16 a[56:57], v1 offset:16640
    buffer_load_dwordx4 v5, s[12:15], 0 offen offset:0 lds
    v_mfma_f32_16x16x32_bf16 v[124:127], a[16:19], v[236:239], v[124:127]
    ds_read_b64_tr_b16 a[58:59], v1 offset:18688
    buffer_load_dwordx4 a[220:223], v7, s[40:43], s1 offen offset:1024 sc1
    v_mfma_f32_16x16x32_bf16 v[208:211], a[20:23], v[176:179], v[208:211]
    v_exp_f32 v221, v221
    v_mfma_f32_16x16x32_bf16 v[212:215], a[20:23], v[180:183], v[212:215]
    ds_read_b128 a[0:3], v4 offset:9216
    v_cvt_pk_bf16_f32 v226, v216, v217
    v_mfma_f32_16x16x32_bf16 v[192:195], a[24:27], v[232:235], v[192:195]
    v_exp_f32 v222, v222
    v_mfma_f32_16x16x32_bf16 v[196:199], a[24:27], v[236:239], v[196:199]
    ds_read_b64_tr_b16 a[4:5], v2 offset:16640
    ds_read_b64_tr_b16 a[6:7], v2 offset:18688
    v_mfma_f32_16x16x32_bf16 v[208:211], a[28:31], v[184:187], v[208:211]
    v_exp_f32 v223, v223
    v_mfma_f32_16x16x32_bf16 v[212:215], a[28:31], v[188:191], v[212:215]
    ds_read_b128 a[8:11], v3 offset:10240
    v_cvt_pk_bf16_f32 v227, v218, v219
    v_mfma_f32_16x16x32_bf16 v[200:203], a[32:35], v[232:235], v[200:203]
    ds_read_b64_tr_b16 a[12:13], v1 offset:20480
    v_cvt_pk_bf16_f32 v230, v220, v221
    v_mfma_f32_16x16x32_bf16 v[204:207], a[32:35], v[236:239], v[204:207]
    ds_read_b64_tr_b16 a[14:15], v1 offset:22528
    v_cvt_pk_bf16_f32 v231, v222, v223
    v_mfma_f32_16x16x32_bf16 v[216:219], a[36:39], v[128:131], v[240:243]
    ds_read_b128 a[16:19], v4 offset:10240
    buffer_load_dwordx2 a[248:249], v7, s[40:43], s1 offen offset:2048 sc1
    v_mfma_f32_16x16x32_bf16 v[220:223], a[36:39], v[132:135], v[244:247]
    buffer_load_dwordx4 v5, s[12:15], s85 offen offset:1024 lds
    ds_read_b64_tr_b16 a[20:21], v2 offset:20480
    v_mfma_f32_16x16x32_bf16 a[64:67], a[60:63], v[224:227], a[64:67]
    ds_read_b64_tr_b16 a[22:23], v2 offset:22528
    v_max3_f32 v10, v208, v209, v210
    v_mfma_f32_16x16x32_bf16 a[68:71], a[60:63], v[228:231], a[68:71]
    ds_read_b128 a[24:27], v3 offset:11264
    s_waitcnt vmcnt(27)
    v_mfma_f32_16x16x32_bf16 v[16:19], a[40:43], v[224:227], v[16:19]
    ds_read_b64_tr_b16 a[28:29], v1 offset:20736
    s_barrier
    v_mfma_f32_16x16x32_bf16 v[20:23], a[40:43], v[228:231], v[20:23]
    ds_read_b64_tr_b16 a[30:31], v1 offset:22784
    s_waitcnt lgkmcnt(6)
    v_mfma_f32_16x16x32_bf16 v[216:219], a[44:47], v[136:139], v[216:219]
    ds_read_b128 a[32:35], v4 offset:11264
    v_max3_f32 v255, v211, v212, v213
    v_mfma_f32_16x16x32_bf16 v[220:223], a[44:47], v[140:143], v[220:223]
    ds_read_b64_tr_b16 a[36:37], v2 offset:20736
    buffer_load_dwordx2 a[252:253], v7, s[40:43], s1 offen offset:2056 sc1
    v_mfma_f32_16x16x32_bf16 v[24:27], a[48:51], v[224:227], v[24:27]
    ds_read_b64_tr_b16 a[38:39], v2 offset:22784
    s_add_u32 s1, s1, 3072
    v_mfma_f32_16x16x32_bf16 v[28:31], a[48:51], v[228:231], v[28:31]
    buffer_load_dwordx4 v5, s[12:15], s86 offen offset:2048 lds
    ds_read_b128 a[40:43], v3 offset:32768
    v_mfma_f32_16x16x32_bf16 v[216:219], a[52:55], v[144:147], v[216:219]
    ds_read_b64_tr_b16 a[44:45], v1 offset:57344
    v_max3_f32 v10, v214, v215, v10
    v_mfma_f32_16x16x32_bf16 v[220:223], a[52:55], v[148:151], v[220:223]
    ds_read_b64_tr_b16 a[46:47], v1 offset:59392
    v_max_f32 v10, v10, v255
    v_mfma_f32_16x16x32_bf16 v[32:35], a[56:59], v[224:227], v[32:35]
    ds_read_b128 a[48:51], v4 offset:32768
    v_cmp_lt_f32 vcc, s98, v10
    v_mfma_f32_16x16x32_bf16 v[36:39], a[56:59], v[228:231], v[36:39]
    ds_read_b64_tr_b16 a[52:53], v2 offset:57344
    buffer_load_dwordx4 v5, s[12:15], s87 offen offset:3072 lds
    v_mfma_f32_16x16x32_bf16 v[216:219], a[0:3], v[152:155], v[216:219]
    s_cbranch_vccnz L_RARE9
L_BACK9:
    v_add_u32 v5, 16384, v5
    v_mfma_f32_16x16x32_bf16 v[220:223], a[0:3], v[156:159], v[220:223]
    ds_read_b64_tr_b16 a[54:55], v2 offset:59392
    buffer_load_dwordx4 a[224:227], v7, s[40:43], s1 offen offset:0 sc1
    v_mfma_f32_16x16x32_bf16 v[40:43], a[4:7], v[224:227], v[40:43]
    v_exp_f32 v208, v208
    v_mfma_f32_16x16x32_bf16 v[44:47], a[4:7], v[228:231], v[44:47]
    v_exp_f32 v209, v209
    v_mfma_f32_16x16x32_bf16 v[216:219], a[8:11], v[160:163], v[216:219]
    v_exp_f32 v210, v210
    v_mfma_f32_16x16x32_bf16 v[220:223], a[8:11], v[164:167], v[220:223]
    v_exp_f32 v211, v211
    v_mfma_f32_16x16x32_bf16 v[48:51], a[12:15], v[224:227], v[48:51]
    ds_read_b128 a[56:59], v3 offset:33792
    v_and_b32 v5, 0x3ffff, v5
    v_mfma_f32_16x16x32_bf16 v[52:55], a[12:15], v[228:231], v[52:55]
    ds_read_b64_tr_b16 a[0:1], v1 offset:57600
    s_waitcnt lgkmcnt(2)
    v_mfma_f32_16x16x32_bf16 v[216:219], a[16:19], v[168:171], v[216:219]
    ds_read_b64_tr_b16 a[2:3], v1 offset:59648
    buffer_load_dwordx4 a[228:231], v7, s[40:43], s1 offen offset:1024 sc1
    v_mfma_f32_16x16x32_bf16 v[220:223], a[16:19], v[172:175], v[220:223]
    v_exp_f32 v212, v212
    v_mfma_f32_16x16x32_bf16 v[56:59], a[20:23], v[224:227], v[56:59]
    ds_read_b128 a[4:7], v4 offset:33792
    s_add_u32 m0, s47, 32768
    v_mfma_f32_16x16x32_bf16 v[60:63], a[20:23], v[228:231], v[60:63]
    ds_read_b64_tr_b16 a[8:9], v2 offset:57600
    buffer_load_dwordx4 v15, s[28:31], 0 offen offset:0 lds
    v_mfma_f32_16x16x32_bf16 v[216:219], a[24:27], v[176:179], v[216:219]
    v_exp_f32 v213, v213
    v_mfma_f32_16x16x32_bf16 v[220:223], a[24:27], v[180:183], v[220:223]
    ds_read_b64_tr_b16 a[10:11], v2 offset:59648
    v_cvt_pk_bf16_f32 v232, v208, v209
    v_mfma_f32_16x16x32_bf16 v[64:67], a[28:31], v[224:227], v[64:67]
    v_exp_f32 v214, v214
    v_mfma_f32_16x16x32_bf16 v[68:71], a[28:31], v[228:231], v[68:71]
    ds_read_b128 a[12:15], v3 offset:34816
    buffer_load_dwordx4 a[232:235], v7, s[40:43], s1 offen offset:2048 sc1
    v_mfma_f32_16x16x32_bf16 v[216:219], a[32:35], v[184:187], v[216:219]
    ds_read_b64_tr_b16 a[16:17], v1 offset:61440
    v_cvt_pk_bf16_f32 v233, v210, v211
    v_mfma_f32_16x16x32_bf16 v[220:223], a[32:35], v[188:191], v[220:223]
    ds_read_b64_tr_b16 a[18:19], v1 offset:63488
    ds_read_b128 a[20:23], v4 offset:34816
    v_mfma_f32_16x16x32_bf16 v[72:75], a[36:39], v[224:227], v[72:75]
    v_exp_f32 v215, v215
    v_mfma_f32_16x16x32_bf16 v[76:79], a[36:39], v[228:231], v[76:79]
    v_cvt_pk_bf16_f32 v236, v212, v213
    v_cvt_pk_bf16_f32 v237, v214, v215
    v_mfma_f32_16x16x32_bf16 v[208:211], a[40:43], v[128:131], v[240:243]
    ds_read_b64_tr_b16 a[24:25], v2 offset:61440
    buffer_load_dwordx4 v15, s[28:31], s77 offen offset:1024 lds
    v_mfma_f32_16x16x32_bf16 v[212:215], a[40:43], v[132:135], v[244:247]
    ds_read_b64_tr_b16 a[26:27], v2 offset:63488
    v_max3_f32 v10, v216, v217, v218
    v_mfma_f32_16x16x32_bf16 v[80:83], a[44:47], v[224:227], v[80:83]
    ds_read_b128 a[28:31], v3 offset:35840
    buffer_load_dwordx4 a[236:239], v7, s[40:43], s1 offen offset:3072 sc1
    v_mfma_f32_16x16x32_bf16 v[84:87], a[44:47], v[228:231], v[84:87]
    ds_read_b64_tr_b16 a[32:33], v1 offset:61696
    s_add_u32 s1, s1, 4096
    v_mfma_f32_16x16x32_bf16 v[208:211], a[48:51], v[136:139], v[208:211]
    ds_read_b64_tr_b16 a[34:35], v1 offset:63744
    v_max3_f32 v255, v219, v220, v221
    v_mfma_f32_16x16x32_bf16 v[212:215], a[48:51], v[140:143], v[212:215]
    ds_read_b128 a[36:39], v4 offset:35840
    v_max3_f32 v10, v222, v223, v10
    v_mfma_f32_16x16x32_bf16 v[88:91], a[52:55], v[224:227], v[88:91]
    ds_read_b64_tr_b16 a[40:41], v2 offset:61696
    v_max_f32 v10, v10, v255
    v_mfma_f32_16x16x32_bf16 v[92:95], a[52:55], v[228:231], v[92:95]
    ds_read_b64_tr_b16 a[42:43], v2 offset:63744
    s_waitcnt lgkmcnt(6)
    v_mfma_f32_16x16x32_bf16 v[208:211], a[56:59], v[144:147], v[208:211]
    ds_read_b128 a[44:47], v3 offset:40960
    buffer_load_dwordx4 v15, s[28:31], s78 offen offset:2048 lds
    v_mfma_f32_16x16x32_bf16 v[212:215], a[56:59], v[148:151], v[212:215]
    ds_read_b64_tr_b16 a[48:49], v1 offset:49152
    v_cmp_lt_f32 vcc, s98, v10
    v_mfma_f32_16x16x32_bf16 v[96:99], a[0:3], v[224:227], v[96:99]
    ds_read_b64_tr_b16 a[50:51], v1 offset:51200
    buffer_load_dwordx4 a[240:243], v7, s[40:43], s1 offen offset:0 sc1
    v_mfma_f32_16x16x32_bf16 v[100:103], a[0:3], v[228:231], v[100:103]
    s_cbranch_vccnz L_RARE10
L_BACK10:
    s_lshl_b32 s94, s94, 10
    v_mfma_f32_16x16x32_bf16 v[208:211], a[4:7], v[152:155], v[208:211]
    v_exp_f32 v216, v216
    v_mfma_f32_16x16x32_bf16 v[212:215], a[4:7], v[156:159], v[212:215]
    v_exp_f32 v217, v217
    v_mfma_f32_16x16x32_bf16 v[104:107], a[8:11], v[224:227], v[104:107]
    ds_read_b128 a[52:55], v4 offset:40960
    buffer_load_dwordx4 v15, s[28:31], s79 offen offset:3072 lds
    v_mfma_f32_16x16x32_bf16 v[108:111], a[8:11], v[228:231], v[108:111]
    v_exp_f32 v218, v218
    v_mfma_f32_16x16x32_bf16 v[208:211], a[12:15], v[160:163], v[208:211]
    v_exp_f32 v219, v219
    v_mfma_f32_16x16x32_bf16 v[212:215], a[12:15], v[164:167], v[212:215]
    ds_read_b64_tr_b16 a[56:57], v2 offset:49152
    buffer_load_dwordx4 a[244:247], v7, s[40:43], s1 offen offset:1024 sc1
    v_mfma_f32_16x16x32_bf16 v[112:115], a[16:19], v[224:227], v[112:115]
    ds_read_b64_tr_b16 a[58:59], v2 offset:51200
    v_add_u32 v15, 57344, v15
    v_mfma_f32_16x16x32_bf16 v[116:119], a[16:19], v[228:231], v[116:119]
    v_exp_f32 v220, v220
    v_mfma_f32_16x16x32_bf16 v[208:211], a[20:23], v[168:171], v[208:211]
    ds_read_b128 a[0:3], v3 offset:41984
    s_add_u32 m0, s47, 49152
    v_mfma_f32_16x16x32_bf16 v[212:215], a[20:23], v[172:175], v[212:215]
    ds_read_b64_tr_b16 a[4:5], v1 offset:49408
    buffer_load_dwordx4 v15, s[28:31], 0 offen offset:0 lds
    v_mfma_f32_16x16x32_bf16 v[120:123], a[24:27], v[224:227], v[120:123]
    v_exp_f32 v221, v221
    v_mfma_f32_16x16x32_bf16 v[124:127], a[24:27], v[228:231], v[124:127]
    ds_read_b64_tr_b16 a[6:7], v1 offset:51456
    s_waitcnt lgkmcnt(4)
    v_mfma_f32_16x16x32_bf16 v[208:211], a[28:31], v[176:179], v[208:211]
    ds_read_b128 a[8:11], v4 offset:41984
    buffer_load_dwordx2 a[250:251], v7, s[40:43], s1 offen offset:2048 sc1
    v_mfma_f32_16x16x32_bf16 v[212:215], a[28:31], v[180:183], v[212:215]
    ds_read_b64_tr_b16 a[12:13], v2 offset:49408
    v_cvt_pk_bf16_f32 v234, v216, v217
    v_mfma_f32_16x16x32_bf16 v[192:195], a[32:35], v[224:227], v[192:195]
    v_exp_f32 v222, v222
    v_mfma_f32_16x16x32_bf16 v[196:199], a[32:35], v[228:231], v[196:199]
    ds_read_b64_tr_b16 a[14:15], v2 offset:51456
    v_cvt_pk_bf16_f32 v235, v218, v219
    v_mfma_f32_16x16x32_bf16 v[208:211], a[36:39], v[184:187], v[208:211]
    ds_read_b128 a[16:19], v3 offset:43008
    ds_read_b64_tr_b16 a[20:21], v1 offset:53248
    v_mfma_f32_16x16x32_bf16 v[212:215], a[36:39], v[188:191], v[212:215]
    v_exp_f32 v223, v223
    v_mfma_f32_16x16x32_bf16 v[200:203], a[40:43], v[224:227], v[200:203]
    ds_read_b64_tr_b16 a[22:23], v1 offset:55296
    v_cvt_pk_bf16_f32 v238, v220, v221
    v_mfma_f32_16x16x32_bf16 v[204:207], a[40:43], v[228:231], v[204:207]
    ds_read_b128 a[24:27], v4 offset:43008
    v_cvt_pk_bf16_f32 v239, v222, v223
    v_mfma_f32_16x16x32_bf16 v[216:219], a[44:47], v[128:131], v[240:243]
    ds_read_b64_tr_b16 a[28:29], v2 offset:53248
    v_add_u32 v11, 131072, v11
    v_mfma_f32_16x16x32_bf16 v[220:223], a[44:47], v[132:135], v[244:247]
    buffer_load_dwordx4 v15, s[28:31], s77 offen offset:1024 lds
    ds_read_b64_tr_b16 a[30:31], v2 offset:55296
    v_mfma_f32_16x16x32_bf16 a[64:67], a[60:63], v[232:235], a[64:67]
    buffer_load_dwordx2 a[254:255], v7, s[40:43], s1 offen offset:2056 sc1
    ds_read_b128 a[32:35], v3 offset:44032
    v_mfma_f32_16x16x32_bf16 a[68:71], a[60:63], v[236:239], a[68:71]
    ds_read_b64_tr_b16 a[36:37], v1 offset:53504
    v_add_u32 v12, 131072, v12
    v_mfma_f32_16x16x32_bf16 v[16:19], a[48:51], v[232:235], v[16:19]
    ds_read_b64_tr_b16 a[38:39], v1 offset:55552
    s_waitcnt vmcnt(30)
    v_mfma_f32_16x16x32_bf16 v[20:23], a[48:51], v[236:239], v[20:23]
    ds_read_b128 a[40:43], v4 offset:44032
    s_barrier
    v_mfma_f32_16x16x32_bf16 v[216:219], a[52:55], v[136:139], v[216:219]
    ds_read_b64_tr_b16 a[44:45], v2 offset:53504
    buffer_load_dwordx4 v15, s[28:31], s78 offen offset:2048 lds
    v_mfma_f32_16x16x32_bf16 v[220:223], a[52:55], v[140:143], v[220:223]
    ds_read_b64_tr_b16 a[46:47], v2 offset:55552
    s_waitcnt lgkmcnt(6)
    v_mfma_f32_16x16x32_bf16 v[24:27], a[56:59], v[232:235], v[24:27]
    ds_read_b64_tr_b16 a[48:49], v11 offset:0
    buffer_load_dwordx4 v15, s[28:31], s79 offen offset:3072 lds
    v_mfma_f32_16x16x32_bf16 v[28:31], a[56:59], v[236:239], v[28:31]
    ds_read_b64_tr_b16 a[50:51], v11 offset:1024
    s_xor_b32 s101, s101, 200704
    v_mfma_f32_16x16x32_bf16 v[216:219], a[0:3], v[144:147], v[216:219]
    ds_read_b64_tr_b16 a[52:53], v12 offset:0
    s_add_u32 m0, s47, 65536
    v_mfma_f32_16x16x32_bf16 v[220:223], a[0:3], v[148:151], v[220:223]
    ds_read_b64_tr_b16 a[54:55], v12 offset:1024
    v_max3_f32 v10, v208, v209, v210
    v_mfma_f32_16x16x32_bf16 v[32:35], a[4:7], v[232:235], v[32:35]
    ds_read_b64_tr_b16 a[56:57], v11 offset:256
    v_max3_f32 v255, v211, v212, v213
    v_mfma_f32_16x16x32_bf16 v[36:39], a[4:7], v[236:239], v[36:39]
    ds_read_b64_tr_b16 a[58:59], v11 offset:1280
    v_max3_f32 v10, v214, v215, v10
    v_mfma_f32_16x16x32_bf16 v[216:219], a[8:11], v[152:155], v[216:219]
    ds_read_b64_tr_b16 a[0:1], v12 offset:256
    v_max_f32 v10, v10, v255
    v_mfma_f32_16x16x32_bf16 v[220:223], a[8:11], v[156:159], v[220:223]
    ds_read_b64_tr_b16 a[2:3], v12 offset:1280
    v_cmp_lt_f32 vcc, s98, v10
    v_mfma_f32_16x16x32_bf16 v[40:43], a[12:15], v[232:235], v[40:43]
    ds_read_b64_tr_b16 a[4:5], v11 offset:512
    s_add_u32 s24, s24, s94
    v_mfma_f32_16x16x32_bf16 v[44:47], a[12:15], v[236:239], v[44:47]
    s_cbranch_vccnz L_RARE11
L_BACK11:
    s_cmp_ge_u32 s71, 14
    s_cselect_b32 s25, 2147418112, s25
    v_mfma_f32_16x16x32_bf16 v[216:219], a[16:19], v[160:163], v[216:219]
    ds_read_b64_tr_b16 a[6:7], v11 offset:1536
    buffer_load_dwordx4 v6, s[8:11], s88 offen offset:0 lds
    v_mfma_f32_16x16x32_bf16 v[220:223], a[16:19], v[164:167], v[220:223]
    v_exp_f32 v208, v208
    v_mfma_f32_16x16x32_bf16 v[48:51], a[20:23], v[232:235], v[48:51]
    v_exp_f32 v209, v209
    v_mfma_f32_16x16x32_bf16 v[52:55], a[20:23], v[236:239], v[52:55]
    v_exp_f32 v210, v210
    v_mfma_f32_16x16x32_bf16 v[216:219], a[24:27], v[168:171], v[216:219]
    ds_read_b64_tr_b16 a[8:9], v12 offset:512
    buffer_load_dwordx4 v6, s[8:11], s89 offen offset:1024 lds
    v_mfma_f32_16x16x32_bf16 v[220:223], a[24:27], v[172:175], v[220:223]
    ds_read_b64_tr_b16 a[10:11], v12 offset:1536
    v_mbcnt_lo_u32_b32 v0, -1, 0
    v_mfma_f32_16x16x32_bf16 v[56:59], a[28:31], v[232:235], v[56:59]
    ds_read_b64_tr_b16 a[12:13], v11 offset:768
    v_mbcnt_hi_u32_b32 v0, -1, v0
    v_mfma_f32_16x16x32_bf16 v[60:63], a[28:31], v[236:239], v[60:63]
    ds_read_b64_tr_b16 a[14:15], v11 offset:1792
    s_waitcnt lgkmcnt(4)
    v_mfma_f32_16x16x32_bf16 v[216:219], a[32:35], v[176:179], v[216:219]
    ds_read_b64_tr_b16 a[16:17], v11 offset:2048
    v_cmp_gt_u32 s[96:97], 28, v0
    v_mfma_f32_16x16x32_bf16 v[220:223], a[32:35], v[180:183], v[220:223]
L_PAD6:
    s_cbranch_execz L_PAD10
    ds_read_b64_tr_b16 a[18:19], v11 offset:3072
    buffer_load_dwordx4 v6, s[8:11], s90 offen offset:2048 lds
    v_mfma_f32_16x16x32_bf16 v[64:67], a[36:39], v[232:235], v[64:67]
    ds_read_b64_tr_b16 a[20:21], v12 offset:2048
    v_mov_b32 v254, 2147418112
    v_mfma_f32_16x16x32_bf16 v[68:71], a[36:39], v[236:239], v[68:71]
    ds_read_b64_tr_b16 a[22:23], v12 offset:3072
    v_lshlrev_b32 v0, 7, v0
    v_mfma_f32_16x16x32_bf16 v[216:219], a[40:43], v[184:187], v[216:219]
    ds_read_b64_tr_b16 a[24:25], v11 offset:2304
    v_cndmask_b32 v0, v254, v0, s[96:97]
    v_mfma_f32_16x16x32_bf16 v[220:223], a[40:43], v[188:191], v[220:223]
    ds_read_b64_tr_b16 a[26:27], v11 offset:3328
    v_mfma_f32_16x16x32_bf16 v[72:75], a[44:47], v[232:235], v[72:75]
    ds_read_b64_tr_b16 a[28:29], v12 offset:2304
    buffer_load_dwordx4 v6, s[8:11], s91 offen offset:3072 lds
    v_mfma_f32_16x16x32_bf16 v[76:79], a[44:47], v[236:239], v[76:79]
    ds_read_b64_tr_b16 a[30:31], v12 offset:3328
    v_add_u32 v6, 16384, v6
    v_mfma_f32_16x16x32_bf16 a[88:91], a[48:51], a[144:147], 0
    ds_read_b64_tr_b16 a[32:33], v11 offset:2560
    v_and_b32 v6, 0x3ffff, v6
    v_mfma_f32_16x16x32_bf16 a[92:95], a[48:51], a[148:151], 0
    ds_read_b64_tr_b16 a[34:35], v11 offset:3584
    s_add_u32 m0, s47, 81920
    v_mfma_f32_16x16x32_bf16 a[96:99], a[52:55], a[144:147], 0
    v_exp_f32 v211, v211
    v_mfma_f32_16x16x32_bf16 a[100:103], a[52:55], a[148:151], 0
    ds_read_b64_tr_b16 a[36:37], v12 offset:2560
    ds_read_b64_tr_b16 a[38:39], v12 offset:3584
    v_mfma_f32_16x16x32_bf16 a[104:107], a[56:59], a[144:147], 0
    v_exp_f32 v212, v212
    v_mfma_f32_16x16x32_bf16 a[108:111], a[56:59], a[148:151], 0
    ds_read_b64_tr_b16 a[40:41], v11 offset:2816
    ds_read_b64_tr_b16 a[42:43], v11 offset:3840
    v_mfma_f32_16x16x32_bf16 a[112:115], a[0:3], a[144:147], 0
    v_exp_f32 v213, v213
    v_mfma_f32_16x16x32_bf16 a[116:119], a[0:3], a[148:151], 0
    ds_read_b64_tr_b16 a[44:45], v11 offset:16384
    ds_read_b64_tr_b16 a[46:47], v11 offset:17408
    v_mfma_f32_16x16x32_bf16 a[120:123], a[4:7], a[144:147], 0
    v_exp_f32 v214, v214
    v_mfma_f32_16x16x32_bf16 a[124:127], a[4:7], a[148:151], 0
    v_subrev_u32 v3, 65536, v3
    s_waitcnt lgkmcnt(4)
    v_mfma_f32_16x16x32_bf16 a[128:131], a[8:11], a[144:147], 0
    buffer_load_dwordx4 v5, s[12:15], 0 offen offset:0 lds
    ds_read_b64_tr_b16 a[48:49], v12 offset:16384
    v_mfma_f32_16x16x32_bf16 a[132:135], a[8:11], a[148:151], 0
    ds_read_b64_tr_b16 a[50:51], v12 offset:17408
    v_subrev_u32 v1, 65536, v1
    v_mfma_f32_16x16x32_bf16 a[136:139], a[12:15], a[144:147], 0
    ds_read_b64_tr_b16 a[52:53], v11 offset:16640
    v_subrev_u32 v4, 65536, v4
    v_mfma_f32_16x16x32_bf16 a[140:143], a[12:15], a[148:151], 0
    ds_read_b64_tr_b16 a[54:55], v11 offset:17664
    ds_read_b64_tr_b16 a[56:57], v12 offset:16640
    v_mfma_f32_16x16x32_bf16 a[88:91], a[16:19], a[152:155], a[88:91]
    v_exp_f32 v215, v215
    v_mfma_f32_16x16x32_bf16 a[92:95], a[16:19], a[156:159], a[92:95]
    buffer_load_dwordx4 v5, s[12:15], s85 offen offset:1024 lds
    ds_read_b64_tr_b16 a[58:59], v12 offset:17664
    v_subrev_u32 v2, 65536, v2
    v_mfma_f32_16x16x32_bf16 a[96:99], a[20:23], a[152:155], a[96:99]
    s_waitcnt vmcnt(22)
    s_barrier
    v_mfma_f32_16x16x32_bf16 a[100:103], a[20:23], a[156:159], a[100:103]
    ds_read_b64_tr_b16 a[0:1], v11 offset:16896
    buffer_load_dwordx4 v5, s[12:15], s86 offen offset:2048 lds
    v_mfma_f32_16x16x32_bf16 a[104:107], a[24:27], a[152:155], a[104:107]
    ds_read_b64_tr_b16 a[2:3], v11 offset:17920
    buffer_load_dwordx4 v5, s[12:15], s87 offen offset:3072 lds
    v_mfma_f32_16x16x32_bf16 a[108:111], a[24:27], a[156:159], a[108:111]
    ds_read_b64_tr_b16 a[4:5], v12 offset:16896
    s_mul_i32 s69, s68, 7168
    v_mfma_f32_16x16x32_bf16 a[112:115], a[28:31], a[152:155], a[112:115]
    ds_read_b64_tr_b16 a[6:7], v12 offset:17920
    buffer_load_dword a87, v0, s[20:23], s69 offen offset:0
    v_mfma_f32_16x16x32_bf16 a[116:119], a[28:31], a[156:159], a[116:119]
    ds_read_b64_tr_b16 a[8:9], v11 offset:17152
    v_add_u32 v5, 16384, v5
    v_mfma_f32_16x16x32_bf16 a[120:123], a[32:35], a[152:155], a[120:123]
    ds_read_b64_tr_b16 a[10:11], v11 offset:18176
    v_and_b32 v5, 0x3ffff, v5
    v_mfma_f32_16x16x32_bf16 a[124:127], a[32:35], a[156:159], a[124:127]
    ds_read_b128 a[12:15], v3 offset:0
    v_accvgpr_read_b32 v15, a79
    v_mfma_f32_16x16x32_bf16 a[128:131], a[36:39], a[152:155], a[128:131]
    ds_read_b64_tr_b16 a[16:17], v1 offset:24576
    v_add_u32 v15, s101, v15
    v_mfma_f32_16x16x32_bf16 a[132:135], a[36:39], a[156:159], a[132:135]
    ds_read_b64_tr_b16 a[18:19], v1 offset:26624
    s_waitcnt lgkmcnt(6)
    v_mfma_f32_16x16x32_bf16 a[136:139], a[40:43], a[152:155], a[136:139]
    ds_read_b128 a[20:23], v4 offset:0
    s_add_u32 m0, s47, 98304
    v_mfma_f32_16x16x32_bf16 a[140:143], a[40:43], a[156:159], a[140:143]
    ds_read_b64_tr_b16 a[24:25], v2 offset:24576
    v_cvt_pk_bf16_f32 v224, v208, v209
    v_mfma_f32_16x16x32_bf16 a[88:91], a[44:47], a[160:163], a[88:91]
    ds_read_b64_tr_b16 a[26:27], v2 offset:26624
    buffer_load_dwordx4 v15, s[28:31], 0 offen offset:0 lds
    v_mfma_f32_16x16x32_bf16 a[92:95], a[44:47], a[164:167], a[92:95]
    ds_read_b128 a[28:31], v3 offset:1024
    v_cvt_pk_bf16_f32 v225, v210, v211
    v_mfma_f32_16x16x32_bf16 a[96:99], a[48:51], a[160:163], a[96:99]
    ds_read_b64_tr_b16 a[32:33], v1 offset:24832
    v_cvt_pk_bf16_f32 v228, v212, v213
    v_mfma_f32_16x16x32_bf16 a[100:103], a[48:51], a[164:167], a[100:103]
    ds_read_b64_tr_b16 a[34:35], v1 offset:26880
    v_cvt_pk_bf16_f32 v229, v214, v215
    v_mfma_f32_16x16x32_bf16 a[104:107], a[52:55], a[160:163], a[104:107]
    ds_read_b128 a[36:39], v4 offset:1024
    v_max3_f32 v10, v216, v217, v218
    v_mfma_f32_16x16x32_bf16 a[108:111], a[52:55], a[164:167], a[108:111]
    ds_read_b64_tr_b16 a[40:41], v2 offset:24832
    v_max3_f32 v255, v219, v220, v221
    v_mfma_f32_16x16x32_bf16 a[112:115], a[56:59], a[160:163], a[112:115]
    ds_read_b64_tr_b16 a[42:43], v2 offset:26880
    v_max3_f32 v10, v222, v223, v10
    v_mfma_f32_16x16x32_bf16 a[116:119], a[56:59], a[164:167], a[116:119]
    ds_read_b128 a[44:47], v3 offset:2048
    v_max_f32 v10, v10, v255
    v_mfma_f32_16x16x32_bf16 a[120:123], a[0:3], a[160:163], a[120:123]
    ds_read_b64_tr_b16 a[48:49], v1 offset:28672
    buffer_load_dwordx4 v15, s[28:31], s77 offen offset:1024 lds
    v_mfma_f32_16x16x32_bf16 a[124:127], a[0:3], a[164:167], a[124:127]
    ds_read_b64_tr_b16 a[50:51], v1 offset:30720
    s_waitcnt lgkmcnt(6)
    v_mfma_f32_16x16x32_bf16 a[128:131], a[4:7], a[160:163], a[128:131]
    ds_read_b128 a[52:55], v4 offset:2048
    v_cmp_lt_f32 vcc, s98, v10
    v_mfma_f32_16x16x32_bf16 a[132:135], a[4:7], a[164:167], a[132:135]
    ds_read_b64_tr_b16 a[56:57], v2 offset:28672
    v_mfma_f32_16x16x32_bf16 a[136:139], a[8:11], a[160:163], a[136:139]
    s_cbranch_vccnz L_RARE12
L_BACK12:
    v_mfma_f32_16x16x32_bf16 a[140:143], a[8:11], a[164:167], a[140:143]
    v_exp_f32 v216, v216
    v_mfma_f32_16x16x32_bf16 v[208:211], a[12:15], v[128:131], v[240:243]
    v_exp_f32 v217, v217
    v_mfma_f32_16x16x32_bf16 v[212:215], a[12:15], v[132:135], v[244:247]
    v_exp_f32 v218, v218
    v_mfma_f32_16x16x32_bf16 v[80:83], a[16:19], v[232:235], v[80:83]
    v_exp_f32 v219, v219
    v_mfma_f32_16x16x32_bf16 v[84:87], a[16:19], v[236:239], v[84:87]
    v_exp_f32 v220, v220
    v_mfma_f32_16x16x32_bf16 v[208:211], a[20:23], v[136:139], v[208:211]
    ds_read_b64_tr_b16 a[58:59], v2 offset:30720
    ds_read_b128 a[0:3], v3 offset:3072
    v_mfma_f32_16x16x32_bf16 v[212:215], a[20:23], v[140:143], v[212:215]
    v_exp_f32 v221, v221
    v_mfma_f32_16x16x32_bf16 v[88:91], a[24:27], v[232:235], v[88:91]
    ds_read_b64_tr_b16 a[4:5], v1 offset:28928
    ds_read_b64_tr_b16 a[6:7], v1 offset:30976
    v_mfma_f32_16x16x32_bf16 v[92:95], a[24:27], v[236:239], v[92:95]
    v_exp_f32 v222, v222
    v_mfma_f32_16x16x32_bf16 v[208:211], a[28:31], v[144:147], v[208:211]
    ds_read_b128 a[8:11], v4 offset:3072
    buffer_load_dwordx4 v15, s[28:31], s78 offen offset:2048 lds
    v_mfma_f32_16x16x32_bf16 v[212:215], a[28:31], v[148:151], v[212:215]
    ds_read_b64_tr_b16 a[12:13], v2 offset:28928
    ds_read_b64_tr_b16 a[14:15], v2 offset:30976
    v_mfma_f32_16x16x32_bf16 v[96:99], a[32:35], v[232:235], v[96:99]
    v_exp_f32 v223, v223
    v_mfma_f32_16x16x32_bf16 v[100:103], a[32:35], v[236:239], v[100:103]
    ds_read_b128 a[16:19], v3 offset:8192
    s_waitcnt lgkmcnt(6)
    v_mfma_f32_16x16x32_bf16 v[208:211], a[36:39], v[152:155], v[208:211]
    ds_read_b64_tr_b16 a[20:21], v1 offset:16384
    v_cvt_pk_bf16_f32 v226, v216, v217
    v_mfma_f32_16x16x32_bf16 v[212:215], a[36:39], v[156:159], v[212:215]
    ds_read_b64_tr_b16 a[22:23], v1 offset:18432
    v_cvt_pk_bf16_f32 v227, v218, v219
    v_mfma_f32_16x16x32_bf16 v[104:107], a[40:43], v[232:235], v[104:107]
    ds_read_b128 a[24:27], v4 offset:8192
    v_cvt_pk_bf16_f32 v230, v220, v221
    v_mfma_f32_16x16x32_bf16 v[108:111], a[40:43], v[236:239], v[108:111]
    ds_read_b64_tr_b16 a[28:29], v2 offset:16384
    buffer_load_dwordx4 v15, s[28:31], s79 offen offset:3072 lds
    v_mfma_f32_16x16x32_bf16 v[208:211], a[44:47], v[160:163], v[208:211]
    ds_read_b64_tr_b16 a[30:31], v2 offset:18432
    v_cvt_pk_bf16_f32 v231, v222, v223
    v_mfma_f32_16x16x32_bf16 v[212:215], a[44:47], v[164:167], v[212:215]
    ds_read_b128 a[32:35], v3 offset:9216
    v_add_u32 v15, 57344, v15
    v_mfma_f32_16x16x32_bf16 v[112:115], a[48:51], v[232:235], v[112:115]
    ds_read_b64_tr_b16 a[36:37], v1 offset:16640
    s_add_u32 m0, s47, 114688
    v_mfma_f32_16x16x32_bf16 v[116:119], a[48:51], v[236:239], v[116:119]
    ds_read_b64_tr_b16 a[38:39], v1 offset:18688
    v_mfma_f32_16x16x32_bf16 v[208:211], a[52:55], v[168:171], v[208:211]
    ds_read_b128 a[40:43], v4 offset:9216
    v_mfma_f32_16x16x32_bf16 v[212:215], a[52:55], v[172:175], v[212:215]
    ds_read_b64_tr_b16 a[44:45], v2 offset:16640
    v_mfma_f32_16x16x32_bf16 v[120:123], a[56:59], v[232:235], v[120:123]
    ds_read_b64_tr_b16 a[46:47], v2 offset:18688
    v_mfma_f32_16x16x32_bf16 v[124:127], a[56:59], v[236:239], v[124:127]
    ds_read_b128 a[48:51], v3 offset:10240
    v_mfma_f32_16x16x32_bf16 v[208:211], a[0:3], v[176:179], v[208:211]
    ds_read_b64_tr_b16 a[52:53], v1 offset:20480
    v_mfma_f32_16x16x32_bf16 v[212:215], a[0:3], v[180:183], v[212:215]
    ds_read_b64_tr_b16 a[54:55], v1 offset:22528
    s_waitcnt lgkmcnt(6)
    v_mfma_f32_16x16x32_bf16 v[192:195], a[4:7], v[232:235], v[192:195]
    ds_read_b128 a[56:59], v4 offset:10240
    buffer_load_dwordx4 v15, s[28:31], 0 offen offset:0 lds
    v_mfma_f32_16x16x32_bf16 v[196:199], a[4:7], v[236:239], v[196:199]
    v_mfma_f32_16x16x32_bf16 v[208:211], a[8:11], v[184:187], v[208:211]
    ds_read_b64_tr_b16 a[0:1], v2 offset:20480
    v_mfma_f32_16x16x32_bf16 v[212:215], a[8:11], v[188:191], v[212:215]
    ds_read_b64_tr_b16 a[2:3], v2 offset:22528
    v_mfma_f32_16x16x32_bf16 v[200:203], a[12:15], v[232:235], v[200:203]
    ds_read_b128 a[4:7], v3 offset:11264
    v_subrev_u32 v11, 131072, v11
    v_mfma_f32_16x16x32_bf16 v[204:207], a[12:15], v[236:239], v[204:207]
    v_mfma_f32_16x16x32_bf16 v[216:219], a[16:19], v[128:131], v[240:243]
    ds_read_b64_tr_b16 a[8:9], v1 offset:20736
    v_subrev_u32 v12, 131072, v12
    v_mfma_f32_16x16x32_bf16 v[220:223], a[16:19], v[132:135], v[244:247]
    ds_read_b64_tr_b16 a[10:11], v1 offset:22784
    v_max3_f32 v10, v208, v209, v210
    v_mfma_f32_16x16x32_bf16 a[64:67], a[60:63], v[224:227], a[64:67]
    ds_read_b128 a[12:15], v4 offset:11264
    s_waitcnt vmcnt(14)
    v_mfma_f32_16x16x32_bf16 a[68:71], a[60:63], v[228:231], a[68:71]
    s_barrier
    v_max3_f32 v255, v211, v212, v213
    v_mfma_f32_16x16x32_bf16 v[16:19], a[20:23], v[224:227], v[16:19]
    ds_read_b64_tr_b16 a[16:17], v2 offset:20736
    buffer_load_dwordx4 v15, s[28:31], s77 offen offset:1024 lds
    v_mfma_f32_16x16x32_bf16 v[20:23], a[20:23], v[228:231], v[20:23]
    ds_read_b64_tr_b16 a[18:19], v2 offset:22784
    v_add_u32 v15, 28672, v15
    v_mfma_f32_16x16x32_bf16 v[216:219], a[24:27], v[136:139], v[216:219]
    ds_read_b64_tr_b16 a[20:21], v11 offset:33792
    s_add_u32 m0, s47, 131072
    v_mfma_f32_16x16x32_bf16 v[220:223], a[24:27], v[140:143], v[220:223]
    ds_read_b64_tr_b16 a[22:23], v11 offset:34816
    v_max3_f32 v10, v214, v215, v10
    v_mfma_f32_16x16x32_bf16 v[24:27], a[28:31], v[224:227], v[24:27]
    ds_read_b64_tr_b16 a[24:25], v12 offset:33792
    v_max_f32 v10, v10, v255
    v_mfma_f32_16x16x32_bf16 v[28:31], a[28:31], v[228:231], v[28:31]
    ds_read_b64_tr_b16 a[26:27], v12 offset:34816
    v_cmp_lt_f32 vcc, s98, v10
    v_mfma_f32_16x16x32_bf16 v[216:219], a[32:35], v[144:147], v[216:219]
    ds_read_b64_tr_b16 a[28:29], v11 offset:34048
    v_mfma_f32_16x16x32_bf16 v[220:223], a[32:35], v[148:151], v[220:223]
    s_cbranch_vccnz L_RARE13
L_BACK13:
    v_mfma_f32_16x16x32_bf16 v[32:35], a[36:39], v[224:227], v[32:35]
    v_exp_f32 v208, v208
    v_mfma_f32_16x16x32_bf16 v[36:39], a[36:39], v[228:231], v[36:39]
    ds_read_b64_tr_b16 a[30:31], v11 offset:35072
    s_waitcnt lgkmcnt(4)
    v_mfma_f32_16x16x32_bf16 v[216:219], a[40:43], v[152:155], v[216:219]
    v_exp_f32 v209, v209
    v_mfma_f32_16x16x32_bf16 v[220:223], a[40:43], v[156:159], v[220:223]
    v_exp_f32 v210, v210
    v_mfma_f32_16x16x32_bf16 v[40:43], a[44:47], v[224:227], v[40:43]
    v_exp_f32 v211, v211
    v_mfma_f32_16x16x32_bf16 v[44:47], a[44:47], v[228:231], v[44:47]
    v_exp_f32 v212, v212
    v_mfma_f32_16x16x32_bf16 v[216:219], a[48:51], v[160:163], v[216:219]
    ds_read_b64_tr_b16 a[32:33], v12 offset:34048
    buffer_load_dwordx4 v6, s[8:11], s88 offen offset:0 lds
    v_mfma_f32_16x16x32_bf16 v[220:223], a[48:51], v[164:167], v[220:223]
    v_exp_f32 v213, v213
    v_mfma_f32_16x16x32_bf16 v[48:51], a[52:55], v[224:227], v[48:51]
    ds_read_b64_tr_b16 a[34:35], v12 offset:35072
    v_cvt_pk_bf16_f32 v232, v208, v209
    v_mfma_f32_16x16x32_bf16 v[52:55], a[52:55], v[228:231], v[52:55]
    v_exp_f32 v214, v214
    v_mfma_f32_16x16x32_bf16 v[216:219], a[56:59], v[168:171], v[216:219]
    ds_read_b64_tr_b16 a[36:37], v11 offset:34304
    ds_read_b64_tr_b16 a[38:39], v11 offset:35328
    v_mfma_f32_16x16x32_bf16 v[220:223], a[56:59], v[172:175], v[220:223]
    v_exp_f32 v215, v215
    v_mfma_f32_16x16x32_bf16 v[56:59], a[0:3], v[224:227], v[56:59]
    ds_read_b64_tr_b16 a[40:41], v12 offset:34304
    buffer_load_dwordx4 v6, s[8:11], s89 offen offset:1024 lds
    v_mfma_f32_16x16x32_bf16 v[60:63], a[0:3], v[228:231], v[60:63]
    ds_read_b64_tr_b16 a[42:43], v12 offset:35328
    v_cvt_pk_bf16_f32 v233, v210, v211
    v_mfma_f32_16x16x32_bf16 v[216:219], a[4:7], v[176:179], v[216:219]
    ds_read_b64_tr_b16 a[44:45], v11 offset:34560
    v_cvt_pk_bf16_f32 v236, v212, v213
    v_mfma_f32_16x16x32_bf16 v[220:223], a[4:7], v[180:183], v[220:223]
    ds_read_b64_tr_b16 a[46:47], v11 offset:35584
    v_cvt_pk_bf16_f32 v237, v214, v215
    v_mfma_f32_16x16x32_bf16 v[64:67], a[8:11], v[224:227], v[64:67]
    ds_read_b64_tr_b16 a[48:49], v11 offset:35840
    v_mfma_f32_16x16x32_bf16 v[68:71], a[8:11], v[228:231], v[68:71]
    ds_read_b64_tr_b16 a[50:51], v11 offset:49152
    v_mfma_f32_16x16x32_bf16 v[216:219], a[12:15], v[184:187], v[216:219]
    ds_read_b64_tr_b16 a[52:53], v12 offset:35840
    v_mfma_f32_16x16x32_bf16 v[220:223], a[12:15], v[188:191], v[220:223]
    ds_read_b64_tr_b16 a[54:55], v12 offset:49152
    buffer_load_dwordx4 v6, s[8:11], s90 offen offset:2048 lds
    v_mfma_f32_16x16x32_bf16 v[72:75], a[16:19], v[224:227], v[72:75]
    ds_read_b64_tr_b16 a[56:57], v11 offset:36096
    v_mfma_f32_16x16x32_bf16 v[76:79], a[16:19], v[228:231], v[76:79]
    ds_read_b64_tr_b16 a[58:59], v11 offset:49408
    v_mfma_f32_16x16x32_bf16 a[88:91], a[20:23], a[168:171], a[88:91]
    ds_read_b64_tr_b16 a[0:1], v12 offset:36096
    v_mfma_f32_16x16x32_bf16 a[92:95], a[20:23], a[172:175], a[92:95]
    ds_read_b64_tr_b16 a[2:3], v12 offset:49408
    s_waitcnt lgkmcnt(6)
    v_mfma_f32_16x16x32_bf16 a[96:99], a[24:27], a[168:171], a[96:99]
    ds_read_b64_tr_b16 a[4:5], v11 offset:36352
    v_max3_f32 v10, v216, v217, v218
    v_mfma_f32_16x16x32_bf16 a[100:103], a[24:27], a[172:175], a[100:103]
    ds_read_b64_tr_b16 a[6:7], v11 offset:49664
    buffer_load_dwordx4 v6, s[8:11], s91 offen offset:3072 lds
    v_mfma_f32_16x16x32_bf16 a[104:107], a[28:31], a[168:171], a[104:107]
    ds_read_b64_tr_b16 a[8:9], v12 offset:36352
    v_add_u32 v6, 16384, v6
    v_mfma_f32_16x16x32_bf16 a[108:111], a[28:31], a[172:175], a[108:111]
    ds_read_b64_tr_b16 a[10:11], v12 offset:49664
    v_and_b32 v6, 0x3ffff, v6
    v_mfma_f32_16x16x32_bf16 a[112:115], a[32:35], a[168:171], a[112:115]
    ds_read_b64_tr_b16 a[12:13], v11 offset:36608
    s_add_u32 m0, s47, 147456
    v_mfma_f32_16x16x32_bf16 a[116:119], a[32:35], a[172:175], a[116:119]
    ds_read_b64_tr_b16 a[14:15], v11 offset:49920
    v_max3_f32 v255, v219, v220, v221
    v_mfma_f32_16x16x32_bf16 a[120:123], a[36:39], a[168:171], a[120:123]
    ds_read_b64_tr_b16 a[16:17], v11 offset:50176
    v_max3_f32 v10, v222, v223, v10
    v_mfma_f32_16x16x32_bf16 a[124:127], a[36:39], a[172:175], a[124:127]
    ds_read_b64_tr_b16 a[18:19], v11 offset:51200
    v_max_f32 v10, v10, v255
    v_mfma_f32_16x16x32_bf16 a[128:131], a[40:43], a[168:171], a[128:131]
    ds_read_b64_tr_b16 a[20:21], v12 offset:50176
    buffer_load_dwordx4 v5, s[12:15], 0 offen offset:0 lds
    v_mfma_f32_16x16x32_bf16 a[132:135], a[40:43], a[172:175], a[132:135]
    ds_read_b64_tr_b16 a[22:23], v12 offset:51200
    v_cmp_lt_f32 vcc, s98, v10
    v_mfma_f32_16x16x32_bf16 a[136:139], a[44:47], a[168:171], a[136:139]
    ds_read_b64_tr_b16 a[24:25], v11 offset:50432
    v_mfma_f32_16x16x32_bf16 a[140:143], a[44:47], a[172:175], a[140:143]
    s_cbranch_vccnz L_RARE14
L_BACK14:
    v_mfma_f32_16x16x32_bf16 a[88:91], a[48:51], a[176:179], a[88:91]
    ds_read_b64_tr_b16 a[26:27], v11 offset:51456
    v_mfma_f32_16x16x32_bf16 a[92:95], a[48:51], a[180:183], a[92:95]
    ds_read_b64_tr_b16 a[28:29], v12 offset:50432
    s_waitcnt lgkmcnt(5)
    v_mfma_f32_16x16x32_bf16 a[96:99], a[52:55], a[176:179], a[96:99]
    ds_read_b64_tr_b16 a[30:31], v12 offset:51456
    ds_read_b64_tr_b16 a[32:33], v11 offset:50688
    v_mfma_f32_16x16x32_bf16 a[100:103], a[52:55], a[180:183], a[100:103]
    v_exp_f32 v216, v216
    v_mfma_f32_16x16x32_bf16 a[104:107], a[56:59], a[176:179], a[104:107]
    ds_read_b64_tr_b16 a[34:35], v11 offset:51712
    ds_read_b64_tr_b16 a[36:37], v12 offset:50688
    v_mfma_f32_16x16x32_bf16 a[108:111], a[56:59], a[180:183], a[108:111]
    v_exp_f32 v217, v217
    v_mfma_f32_16x16x32_bf16 a[112:115], a[0:3], a[176:179], a[112:115]
    ds_read_b64_tr_b16 a[38:39], v12 offset:51712
    ds_read_b64_tr_b16 a[40:41], v11 offset:50944
    v_mfma_f32_16x16x32_bf16 a[116:119], a[0:3], a[180:183], a[116:119]
    v_exp_f32 v218, v218
    v_mfma_f32_16x16x32_bf16 a[120:123], a[4:7], a[176:179], a[120:123]
    ds_read_b64_tr_b16 a[42:43], v11 offset:51968
    v_add_u32 v3, 65536, v3
    v_mfma_f32_16x16x32_bf16 a[124:127], a[4:7], a[180:183], a[124:127]
    buffer_load_dword a87, v0, s[20:23], s69 offen offset:3584
    ds_read_b64_tr_b16 a[44:45], v11 offset:32768
    v_mfma_f32_16x16x32_bf16 a[128:131], a[8:11], a[176:179], a[128:131]
    ds_read_b64_tr_b16 a[46:47], v11 offset:52224
    v_add_u32 v1, 65536, v1
    v_mfma_f32_16x16x32_bf16 a[132:135], a[8:11], a[180:183], a[132:135]
    buffer_load_dwordx4 v5, s[12:15], s85 offen offset:1024 lds
    ds_read_b64_tr_b16 a[48:49], v12 offset:32768
    v_mfma_f32_16x16x32_bf16 a[136:139], a[12:15], a[176:179], a[136:139]
    ds_read_b64_tr_b16 a[50:51], v12 offset:52224
    v_add_u32 v4, 65536, v4
    v_mfma_f32_16x16x32_bf16 a[140:143], a[12:15], a[180:183], a[140:143]
    ds_read_b64_tr_b16 a[52:53], v11 offset:33024
    ds_read_b64_tr_b16 a[54:55], v11 offset:52480
    v_mfma_f32_16x16x32_bf16 a[88:91], a[16:19], a[184:187], a[88:91]
    v_exp_f32 v219, v219
    v_mfma_f32_16x16x32_bf16 a[92:95], a[16:19], a[188:191], a[92:95]
    ds_read_b64_tr_b16 a[56:57], v12 offset:33024
    v_add_u32 v2, 65536, v2
    s_waitcnt lgkmcnt(6)
    v_mfma_f32_16x16x32_bf16 a[96:99], a[20:23], a[184:187], a[96:99]
    s_waitcnt vmcnt(14)
    s_barrier
    ds_read_b64_tr_b16 a[58:59], v12 offset:52480
    v_mfma_f32_16x16x32_bf16 a[100:103], a[20:23], a[188:191], a[100:103]
    ds_read_b64_tr_b16 a[0:1], v11 offset:33280
    buffer_load_dwordx4 v5, s[12:15], s86 offen offset:2048 lds
    v_mfma_f32_16x16x32_bf16 a[104:107], a[24:27], a[184:187], a[104:107]
    ds_read_b64_tr_b16 a[2:3], v11 offset:52736
    ds_read_b64_tr_b16 a[4:5], v12 offset:33280
    v_mfma_f32_16x16x32_bf16 a[108:111], a[24:27], a[188:191], a[108:111]
    v_exp_f32 v220, v220
    v_mfma_f32_16x16x32_bf16 a[112:115], a[28:31], a[184:187], a[112:115]
    ds_read_b64_tr_b16 a[6:7], v12 offset:52736
    ds_read_b64_tr_b16 a[8:9], v11 offset:33536
    v_mfma_f32_16x16x32_bf16 a[116:119], a[28:31], a[188:191], a[116:119]
    v_exp_f32 v221, v221
    v_mfma_f32_16x16x32_bf16 a[120:123], a[32:35], a[184:187], a[120:123]
    ds_read_b64_tr_b16 a[10:11], v11 offset:52992
    ds_read_b128 a[12:15], v3 offset:0
    v_mfma_f32_16x16x32_bf16 a[124:127], a[32:35], a[188:191], a[124:127]
    v_exp_f32 v222, v222
    v_mfma_f32_16x16x32_bf16 a[128:131], a[36:39], a[184:187], a[128:131]
    ds_read_b64_tr_b16 a[16:17], v1 offset:24576
    buffer_load_dwordx4 v5, s[12:15], s87 offen offset:3072 lds
    v_mfma_f32_16x16x32_bf16 a[132:135], a[36:39], a[188:191], a[132:135]
    ds_read_b64_tr_b16 a[18:19], v1 offset:26624
    ds_read_b128 a[20:23], v4 offset:0
    v_mfma_f32_16x16x32_bf16 a[136:139], a[40:43], a[184:187], a[136:139]
    v_exp_f32 v223, v223
    v_mfma_f32_16x16x32_bf16 a[140:143], a[40:43], a[188:191], a[140:143]
    ds_read_b64_tr_b16 a[24:25], v2 offset:24576
    s_waitcnt lgkmcnt(6)
    v_mfma_f32_16x16x32_bf16 a[88:91], a[44:47], a[192:195], a[88:91]
    ds_read_b64_tr_b16 a[26:27], v2 offset:26624
    v_add_u32 v5, 16384, v5
    v_mfma_f32_16x16x32_bf16 a[92:95], a[44:47], a[196:199], a[92:95]
    ds_read_b128 a[28:31], v3 offset:1024
    v_and_b32 v5, 0x3ffff, v5
    v_mfma_f32_16x16x32_bf16 a[96:99], a[48:51], a[192:195], a[96:99]
    ds_read_b64_tr_b16 a[32:33], v1 offset:24832
    s_add_u32 m0, s47, 0
    v_mfma_f32_16x16x32_bf16 a[100:103], a[48:51], a[196:199], a[100:103]
    ds_read_b64_tr_b16 a[34:35], v1 offset:26880
    buffer_load_dwordx4 v15, s[28:31], 0 offen offset:0 lds
    v_mfma_f32_16x16x32_bf16 a[104:107], a[52:55], a[192:195], a[104:107]
    ds_read_b128 a[36:39], v4 offset:1024
    v_cvt_pk_bf16_f32 v234, v216, v217
    v_mfma_f32_16x16x32_bf16 a[108:111], a[52:55], a[196:199], a[108:111]
    ds_read_b64_tr_b16 a[40:41], v2 offset:24832
    buffer_load_dwordx4 v15, s[28:31], s77 offen offset:1024 lds
    v_mfma_f32_16x16x32_bf16 a[112:115], a[56:59], a[192:195], a[112:115]
    ds_read_b64_tr_b16 a[42:43], v2 offset:26880
    v_cvt_pk_bf16_f32 v235, v218, v219
    v_mfma_f32_16x16x32_bf16 a[116:119], a[56:59], a[196:199], a[116:119]
    ds_read_b128 a[44:47], v3 offset:2048
    v_cvt_pk_bf16_f32 v238, v220, v221
    v_mfma_f32_16x16x32_bf16 a[120:123], a[0:3], a[192:195], a[120:123]
    ds_read_b64_tr_b16 a[48:49], v1 offset:28672
    v_cvt_pk_bf16_f32 v239, v222, v223
    v_mfma_f32_16x16x32_bf16 a[124:127], a[0:3], a[196:199], a[124:127]
    ds_read_b64_tr_b16 a[50:51], v1 offset:30720
    v_mfma_f32_16x16x32_bf16 a[128:131], a[4:7], a[192:195], a[128:131]
    ds_read_b128 a[52:55], v4 offset:2048
    v_mfma_f32_16x16x32_bf16 a[132:135], a[4:7], a[196:199], a[132:135]
    ds_read_b64_tr_b16 a[56:57], v2 offset:28672
    s_waitcnt lgkmcnt(6)
    v_mfma_f32_16x16x32_bf16 a[136:139], a[8:11], a[192:195], a[136:139]
    ds_read_b64_tr_b16 a[58:59], v2 offset:30720
    v_mfma_f32_16x16x32_bf16 a[140:143], a[8:11], a[196:199], a[140:143]
    ds_read_b128 a[0:3], v3 offset:3072
    buffer_load_dwordx4 v15, s[28:31], s78 offen offset:2048 lds
    v_mfma_f32_16x16x32_bf16 v[208:211], a[12:15], v[128:131], v[240:243]
    ds_read_b64_tr_b16 a[4:5], v1 offset:28928
    v_mfma_f32_16x16x32_bf16 v[212:215], a[12:15], v[132:135], v[244:247]
    ds_read_b64_tr_b16 a[6:7], v1 offset:30976
    v_mfma_f32_16x16x32_bf16 v[80:83], a[16:19], v[224:227], v[80:83]
    ds_read_b128 a[8:11], v4 offset:3072
    v_mfma_f32_16x16x32_bf16 v[84:87], a[16:19], v[228:231], v[84:87]
    ds_read_b64_tr_b16 a[12:13], v2 offset:28928
    v_mfma_f32_16x16x32_bf16 v[208:211], a[20:23], v[136:139], v[208:211]
    ds_read_b64_tr_b16 a[14:15], v2 offset:30976
    v_mfma_f32_16x16x32_bf16 v[212:215], a[20:23], v[140:143], v[212:215]
    ds_read_b128 a[16:19], v3 offset:8192
    v_mfma_f32_16x16x32_bf16 v[88:91], a[24:27], v[224:227], v[88:91]
    v_mfma_f32_16x16x32_bf16 v[92:95], a[24:27], v[228:231], v[92:95]
    buffer_load_dwordx4 v15, s[28:31], s79 offen offset:3072 lds
    v_add_u32 v15, 57344, v15
    v_mfma_f32_16x16x32_bf16 v[208:211], a[28:31], v[144:147], v[208:211]
    ds_read_b64_tr_b16 a[20:21], v1 offset:16384
    s_add_u32 m0, s47, 16384
    v_mfma_f32_16x16x32_bf16 v[212:215], a[28:31], v[148:151], v[212:215]
    ds_read_b64_tr_b16 a[22:23], v1 offset:18432
    v_mfma_f32_16x16x32_bf16 v[96:99], a[32:35], v[224:227], v[96:99]
    ds_read_b128 a[24:27], v4 offset:8192
    v_mfma_f32_16x16x32_bf16 v[100:103], a[32:35], v[228:231], v[100:103]
    v_mfma_f32_16x16x32_bf16 v[208:211], a[36:39], v[152:155], v[208:211]
    ds_read_b64_tr_b16 a[28:29], v2 offset:16384
    v_mfma_f32_16x16x32_bf16 v[212:215], a[36:39], v[156:159], v[212:215]
    ds_read_b64_tr_b16 a[30:31], v2 offset:18432
    s_waitcnt lgkmcnt(5)
    v_mfma_f32_16x16x32_bf16 v[104:107], a[40:43], v[224:227], v[104:107]
    ds_read_b128 a[32:35], v3 offset:9216
    v_mfma_f32_16x16x32_bf16 v[108:111], a[40:43], v[228:231], v[108:111]
    buffer_load_dwordx4 v15, s[28:31], 0 offen offset:0 lds
    v_mfma_f32_16x16x32_bf16 v[208:211], a[44:47], v[160:163], v[208:211]
    ds_read_b64_tr_b16 a[36:37], v1 offset:16640
    v_mfma_f32_16x16x32_bf16 v[212:215], a[44:47], v[164:167], v[212:215]
    ds_read_b64_tr_b16 a[38:39], v1 offset:18688
    v_mfma_f32_16x16x32_bf16 v[112:115], a[48:51], v[224:227], v[112:115]
    ds_read_b128 a[40:43], v4 offset:9216
    v_mfma_f32_16x16x32_bf16 v[116:119], a[48:51], v[228:231], v[116:119]
    v_mfma_f32_16x16x32_bf16 v[208:211], a[52:55], v[168:171], v[208:211]
    ds_read_b64_tr_b16 a[44:45], v2 offset:16640
    v_mfma_f32_16x16x32_bf16 v[212:215], a[52:55], v[172:175], v[212:215]
    ds_read_b64_tr_b16 a[46:47], v2 offset:18688
    v_mfma_f32_16x16x32_bf16 v[120:123], a[56:59], v[224:227], v[120:123]
    ds_read_b128 a[48:51], v3 offset:10240
    v_mfma_f32_16x16x32_bf16 v[124:127], a[56:59], v[228:231], v[124:127]
    buffer_load_dwordx4 v15, s[28:31], s77 offen offset:1024 lds
    v_mfma_f32_16x16x32_bf16 v[208:211], a[0:3], v[176:179], v[208:211]
    ds_read_b64_tr_b16 a[52:53], v1 offset:20480
    v_mfma_f32_16x16x32_bf16 v[212:215], a[0:3], v[180:183], v[212:215]
    ds_read_b64_tr_b16 a[54:55], v1 offset:22528
    v_mfma_f32_16x16x32_bf16 v[192:195], a[4:7], v[224:227], v[192:195]
    ds_read_b128 a[56:59], v4 offset:10240
    v_mfma_f32_16x16x32_bf16 v[196:199], a[4:7], v[228:231], v[196:199]
    v_mfma_f32_16x16x32_bf16 v[208:211], a[8:11], v[184:187], v[208:211]
    ds_read_b64_tr_b16 a[0:1], v2 offset:20480
    v_mfma_f32_16x16x32_bf16 v[212:215], a[8:11], v[188:191], v[212:215]
    ds_read_b64_tr_b16 a[2:3], v2 offset:22528
    v_mfma_f32_16x16x32_bf16 v[200:203], a[12:15], v[224:227], v[200:203]
    ds_read_b128 a[4:7], v3 offset:11264
    v_add_u32 v11, 65536, v11
    v_mfma_f32_16x16x32_bf16 v[204:207], a[12:15], v[228:231], v[204:207]
    buffer_load_dwordx4 v15, s[28:31], s78 offen offset:2048 lds
    v_mfma_f32_16x16x32_bf16 v[216:219], a[16:19], v[128:131], v[240:243]
    ds_read_b64_tr_b16 a[8:9], v1 offset:20736
    v_add_u32 v12, 65536, v12
    v_mfma_f32_16x16x32_bf16 v[220:223], a[16:19], v[132:135], v[244:247]
    ds_read_b64_tr_b16 a[10:11], v1 offset:22784
    v_max3_f32 v10, v208, v209, v210
    v_mfma_f32_16x16x32_bf16 a[64:67], a[60:63], v[232:235], a[64:67]
    ds_read_b128 a[12:15], v4 offset:11264
    s_waitcnt vmcnt(16)
    v_mfma_f32_16x16x32_bf16 a[68:71], a[60:63], v[236:239], a[68:71]
    s_barrier
    s_waitcnt lgkmcnt(4)
    v_mfma_f32_16x16x32_bf16 v[16:19], a[20:23], v[232:235], v[16:19]
    ds_read_b64_tr_b16 a[16:17], v2 offset:20736
    v_max3_f32 v255, v211, v212, v213
    v_mfma_f32_16x16x32_bf16 v[20:23], a[20:23], v[236:239], v[20:23]
    ds_read_b64_tr_b16 a[18:19], v2 offset:22784
    v_max3_f32 v10, v214, v215, v10
    v_mfma_f32_16x16x32_bf16 v[216:219], a[24:27], v[136:139], v[216:219]
    ds_read_b64_tr_b16 a[20:21], v11 offset:32768
    v_max_f32 v10, v10, v255
    v_mfma_f32_16x16x32_bf16 v[220:223], a[24:27], v[140:143], v[220:223]
L_PAD7:
    s_cbranch_execz L_PAD11
    ds_read_b64_tr_b16 a[22:23], v11 offset:33792
    buffer_load_dwordx4 v15, s[28:31], s79 offen offset:3072 lds
    v_mfma_f32_16x16x32_bf16 v[24:27], a[28:31], v[232:235], v[24:27]
    ds_read_b64_tr_b16 a[24:25], v12 offset:32768
    s_add_u32 m0, s47, 32768
    v_mfma_f32_16x16x32_bf16 v[28:31], a[28:31], v[236:239], v[28:31]
    ds_read_b64_tr_b16 a[26:27], v12 offset:33792
    v_cmp_lt_f32 vcc, s98, v10
    v_mfma_f32_16x16x32_bf16 v[216:219], a[32:35], v[144:147], v[216:219]
    ds_read_b64_tr_b16 a[28:29], v11 offset:33024
    v_mfma_f32_16x16x32_bf16 v[220:223], a[32:35], v[148:151], v[220:223]
    s_cbranch_vccnz L_RARE15
L_BACK15:
    v_mfma_f32_16x16x32_bf16 v[32:35], a[36:39], v[232:235], v[32:35]
    v_exp_f32 v208, v208
    v_mfma_f32_16x16x32_bf16 v[36:39], a[36:39], v[236:239], v[36:39]
    v_exp_f32 v209, v209
    v_mfma_f32_16x16x32_bf16 v[216:219], a[40:43], v[152:155], v[216:219]
    v_exp_f32 v210, v210
    v_mfma_f32_16x16x32_bf16 v[220:223], a[40:43], v[156:159], v[220:223]
    v_exp_f32 v211, v211
    v_mfma_f32_16x16x32_bf16 v[40:43], a[44:47], v[232:235], v[40:43]
    v_exp_f32 v212, v212
    v_mfma_f32_16x16x32_bf16 v[44:47], a[44:47], v[236:239], v[44:47]
    v_exp_f32 v213, v213
    v_mfma_f32_16x16x32_bf16 v[216:219], a[48:51], v[160:163], v[216:219]
    ds_read_b64_tr_b16 a[30:31], v11 offset:34048
    buffer_load_dwordx4 v6, s[8:11], s88 offen offset:0 lds
    v_mfma_f32_16x16x32_bf16 v[220:223], a[48:51], v[164:167], v[220:223]
    ds_read_b64_tr_b16 a[32:33], v12 offset:33024
    ds_read_b64_tr_b16 a[34:35], v12 offset:34048
    v_mfma_f32_16x16x32_bf16 v[48:51], a[52:55], v[232:235], v[48:51]
    v_exp_f32 v214, v214
    v_mfma_f32_16x16x32_bf16 v[52:55], a[52:55], v[236:239], v[52:55]
    ds_read_b64_tr_b16 a[36:37], v11 offset:33280
    ds_read_b64_tr_b16 a[38:39], v11 offset:34304
    v_mfma_f32_16x16x32_bf16 v[216:219], a[56:59], v[168:171], v[216:219]
    v_exp_f32 v215, v215
    v_mfma_f32_16x16x32_bf16 v[220:223], a[56:59], v[172:175], v[220:223]
    ds_read_b64_tr_b16 a[40:41], v12 offset:33280
    buffer_load_dwordx4 v6, s[8:11], s89 offen offset:1024 lds
    v_mfma_f32_16x16x32_bf16 v[56:59], a[0:3], v[232:235], v[56:59]
    ds_read_b64_tr_b16 a[42:43], v12 offset:34304
    v_cvt_pk_bf16_f32 v224, v208, v209
    v_mfma_f32_16x16x32_bf16 v[60:63], a[0:3], v[236:239], v[60:63]
    ds_read_b64_tr_b16 a[44:45], v11 offset:33536
    s_waitcnt lgkmcnt(5)
    v_mfma_f32_16x16x32_bf16 v[216:219], a[4:7], v[176:179], v[216:219]
    ds_read_b64_tr_b16 a[46:47], v11 offset:34560
    v_cvt_pk_bf16_f32 v225, v210, v211
    v_mfma_f32_16x16x32_bf16 v[220:223], a[4:7], v[180:183], v[220:223]
    ds_read_b64_tr_b16 a[48:49], v11 offset:34816
    buffer_load_dwordx4 v6, s[8:11], s90 offen offset:2048 lds
    v_mfma_f32_16x16x32_bf16 v[64:67], a[8:11], v[232:235], v[64:67]
    ds_read_b64_tr_b16 a[50:51], v11 offset:35840
    v_cvt_pk_bf16_f32 v228, v212, v213
    v_mfma_f32_16x16x32_bf16 v[68:71], a[8:11], v[236:239], v[68:71]
    ds_read_b64_tr_b16 a[52:53], v12 offset:34816
    v_cvt_pk_bf16_f32 v229, v214, v215
    v_mfma_f32_16x16x32_bf16 v[216:219], a[12:15], v[184:187], v[216:219]
    ds_read_b64_tr_b16 a[54:55], v12 offset:35840
    v_mfma_f32_16x16x32_bf16 v[220:223], a[12:15], v[188:191], v[220:223]
    ds_read_b64_tr_b16 a[56:57], v11 offset:35072
    v_mfma_f32_16x16x32_bf16 v[72:75], a[16:19], v[232:235], v[72:75]
    ds_read_b64_tr_b16 a[58:59], v11 offset:36096
    buffer_load_dwordx4 v6, s[8:11], s91 offen offset:3072 lds
    v_mfma_f32_16x16x32_bf16 v[76:79], a[16:19], v[236:239], v[76:79]
    ds_read_b64_tr_b16 a[0:1], v12 offset:35072
    v_add_u32 v6, 16384, v6
    v_mfma_f32_16x16x32_bf16 a[88:91], a[20:23], a[200:203], a[88:91]
    ds_read_b64_tr_b16 a[2:3], v12 offset:36096
    v_and_b32 v6, 0x3ffff, v6
    v_mfma_f32_16x16x32_bf16 a[92:95], a[20:23], a[204:207], a[92:95]
    ds_read_b64_tr_b16 a[4:5], v11 offset:35328
    s_add_u32 m0, s47, 49152
    v_mfma_f32_16x16x32_bf16 a[96:99], a[24:27], a[200:203], a[96:99]
    ds_read_b64_tr_b16 a[6:7], v11 offset:36352
    v_max3_f32 v10, v216, v217, v218
    v_mfma_f32_16x16x32_bf16 a[100:103], a[24:27], a[204:207], a[100:103]
    ds_read_b64_tr_b16 a[8:9], v12 offset:35328
    buffer_load_dwordx4 v5, s[12:15], 0 offen offset:0 lds
    v_mfma_f32_16x16x32_bf16 a[104:107], a[28:31], a[200:203], a[104:107]
    ds_read_b64_tr_b16 a[10:11], v12 offset:36352
    v_max3_f32 v255, v219, v220, v221
    v_mfma_f32_16x16x32_bf16 a[108:111], a[28:31], a[204:207], a[108:111]
    ds_read_b64_tr_b16 a[12:13], v11 offset:35584
    v_max3_f32 v10, v222, v223, v10
    v_mfma_f32_16x16x32_bf16 a[112:115], a[32:35], a[200:203], a[112:115]
    ds_read_b64_tr_b16 a[14:15], v11 offset:36608
    v_add_u32 v3, 65536, v3
    v_mfma_f32_16x16x32_bf16 a[116:119], a[32:35], a[204:207], a[116:119]
    ds_read_b64_tr_b16 a[16:17], v11 offset:49152
    s_waitcnt lgkmcnt(6)
    v_mfma_f32_16x16x32_bf16 a[120:123], a[36:39], a[200:203], a[120:123]
    ds_read_b64_tr_b16 a[18:19], v11 offset:50176
    v_add_u32 v1, 65536, v1
    v_mfma_f32_16x16x32_bf16 a[124:127], a[36:39], a[204:207], a[124:127]
    ds_read_b64_tr_b16 a[20:21], v12 offset:49152
    buffer_load_dwordx4 v5, s[12:15], s85 offen offset:1024 lds
    v_mfma_f32_16x16x32_bf16 a[128:131], a[40:43], a[200:203], a[128:131]
    ds_read_b64_tr_b16 a[22:23], v12 offset:50176
    v_add_u32 v4, 65536, v4
    v_mfma_f32_16x16x32_bf16 a[132:135], a[40:43], a[204:207], a[132:135]
    ds_read_b64_tr_b16 a[24:25], v11 offset:49408
    s_waitcnt vmcnt(14)
    v_mfma_f32_16x16x32_bf16 a[136:139], a[44:47], a[200:203], a[136:139]
    ds_read_b64_tr_b16 a[26:27], v11 offset:50432
    v_add_u32 v2, 65536, v2
    v_mfma_f32_16x16x32_bf16 a[140:143], a[44:47], a[204:207], a[140:143]
    ds_read_b64_tr_b16 a[28:29], v12 offset:49408
    s_barrier
    v_mfma_f32_16x16x32_bf16 a[88:91], a[48:51], a[208:211], a[88:91]
    ds_read_b64_tr_b16 a[30:31], v12 offset:50432
    buffer_load_dwordx4 v5, s[12:15], s86 offen offset:2048 lds
    v_mfma_f32_16x16x32_bf16 a[92:95], a[48:51], a[212:215], a[92:95]
    ds_read_b64_tr_b16 a[32:33], v11 offset:49664
    v_max_f32 v10, v10, v255
    v_mfma_f32_16x16x32_bf16 a[96:99], a[52:55], a[208:211], a[96:99]
    ds_read_b64_tr_b16 a[34:35], v11 offset:50688
    v_cmp_lt_f32 vcc, s98, v10
    v_mfma_f32_16x16x32_bf16 a[100:103], a[52:55], a[212:215], a[100:103]
    ds_read_b64_tr_b16 a[36:37], v12 offset:49664
    v_mfma_f32_16x16x32_bf16 a[104:107], a[56:59], a[208:211], a[104:107]
    ds_read_b64_tr_b16 a[38:39], v12 offset:50688
    buffer_load_dwordx4 v5, s[12:15], s87 offen offset:3072 lds
    v_mfma_f32_16x16x32_bf16 a[108:111], a[56:59], a[212:215], a[108:111]
    ds_read_b64_tr_b16 a[40:41], v11 offset:49920
    v_add_u32 v5, 16384, v5
    v_mfma_f32_16x16x32_bf16 a[112:115], a[0:3], a[208:211], a[112:115]
    ds_read_b64_tr_b16 a[42:43], v11 offset:50944
    v_and_b32 v5, 0x3ffff, v5
    v_mfma_f32_16x16x32_bf16 a[116:119], a[0:3], a[212:215], a[116:119]
    ds_read_b128 a[44:47], v3 offset:0
    s_waitcnt lgkmcnt(6)
    v_mfma_f32_16x16x32_bf16 a[120:123], a[4:7], a[208:211], a[120:123]
    ds_read_b64_tr_b16 a[48:49], v1 offset:24576
    s_add_u32 m0, s47, 65536
    v_mfma_f32_16x16x32_bf16 a[124:127], a[4:7], a[212:215], a[124:127]
    s_cbranch_vccnz L_RARE16
L_BACK16:
    v_mfma_f32_16x16x32_bf16 a[128:131], a[8:11], a[208:211], a[128:131]
    v_exp_f32 v216, v216
    v_mfma_f32_16x16x32_bf16 a[132:135], a[8:11], a[212:215], a[132:135]
    v_exp_f32 v217, v217
    v_mfma_f32_16x16x32_bf16 a[136:139], a[12:15], a[208:211], a[136:139]
    ds_read_b64_tr_b16 a[50:51], v1 offset:26624
    ds_read_b128 a[52:55], v4 offset:0
    v_mfma_f32_16x16x32_bf16 a[140:143], a[12:15], a[212:215], a[140:143]
    v_exp_f32 v218, v218
    v_mfma_f32_16x16x32_bf16 a[88:91], a[16:19], a[216:219], a[88:91]
    ds_read_b64_tr_b16 a[56:57], v2 offset:24576
    ds_read_b64_tr_b16 a[58:59], v2 offset:26624
    v_mfma_f32_16x16x32_bf16 a[92:95], a[16:19], a[220:223], a[92:95]
    v_exp_f32 v219, v219
    v_mfma_f32_16x16x32_bf16 a[96:99], a[20:23], a[216:219], a[96:99]
    ds_read_b128 a[0:3], v3 offset:1024
    buffer_load_dwordx4 v6, s[8:11], s88 offen offset:0 lds
    v_mfma_f32_16x16x32_bf16 a[100:103], a[20:23], a[220:223], a[100:103]
    v_exp_f32 v220, v220
    v_mfma_f32_16x16x32_bf16 a[104:107], a[24:27], a[216:219], a[104:107]
    v_exp_f32 v221, v221
    v_mfma_f32_16x16x32_bf16 a[108:111], a[24:27], a[220:223], a[108:111]
    ds_read_b64_tr_b16 a[4:5], v1 offset:24832
    ds_read_b64_tr_b16 a[6:7], v1 offset:26880
    v_mfma_f32_16x16x32_bf16 a[112:115], a[28:31], a[216:219], a[112:115]
    v_exp_f32 v222, v222
    v_mfma_f32_16x16x32_bf16 a[116:119], a[28:31], a[220:223], a[116:119]
    ds_read_b128 a[8:11], v4 offset:1024
    s_waitcnt lgkmcnt(4)
    v_mfma_f32_16x16x32_bf16 a[120:123], a[32:35], a[216:219], a[120:123]
    ds_read_b64_tr_b16 a[12:13], v2 offset:24832
    ds_read_b64_tr_b16 a[14:15], v2 offset:26880
    v_mfma_f32_16x16x32_bf16 a[124:127], a[32:35], a[220:223], a[124:127]
    v_exp_f32 v223, v223
    v_mfma_f32_16x16x32_bf16 a[128:131], a[36:39], a[216:219], a[128:131]
    ds_read_b128 a[16:19], v3 offset:2048
    buffer_load_dwordx4 v6, s[8:11], s89 offen offset:1024 lds
    v_mfma_f32_16x16x32_bf16 a[132:135], a[36:39], a[220:223], a[132:135]
    ds_read_b64_tr_b16 a[20:21], v1 offset:28672
    v_cvt_pk_bf16_f32 v226, v216, v217
    v_mfma_f32_16x16x32_bf16 a[136:139], a[40:43], a[216:219], a[136:139]
    ds_read_b64_tr_b16 a[22:23], v1 offset:30720
    v_cvt_pk_bf16_f32 v227, v218, v219
    v_mfma_f32_16x16x32_bf16 a[140:143], a[40:43], a[220:223], a[140:143]
    ds_read_b128 a[24:27], v4 offset:2048
    buffer_load_dwordx4 v6, s[8:11], s90 offen offset:2048 lds
    v_mfma_f32_16x16x32_bf16 v[208:211], a[44:47], v[128:131], v[240:243]
    ds_read_b64_tr_b16 a[28:29], v2 offset:28672
    v_cvt_pk_bf16_f32 v230, v220, v221
    v_mfma_f32_16x16x32_bf16 v[212:215], a[44:47], v[132:135], v[244:247]
    ds_read_b64_tr_b16 a[30:31], v2 offset:30720
    v_cvt_pk_bf16_f32 v231, v222, v223
    v_mfma_f32_16x16x32_bf16 v[80:83], a[48:51], v[232:235], v[80:83]
    ds_read_b128 a[32:35], v3 offset:3072
    v_mfma_f32_16x16x32_bf16 v[84:87], a[48:51], v[236:239], v[84:87]
    ds_read_b64_tr_b16 a[36:37], v1 offset:28928
    v_mfma_f32_16x16x32_bf16 v[208:211], a[52:55], v[136:139], v[208:211]
    ds_read_b64_tr_b16 a[38:39], v1 offset:30976
    v_mfma_f32_16x16x32_bf16 v[212:215], a[52:55], v[140:143], v[212:215]
    ds_read_b128 a[40:43], v4 offset:3072
    v_mfma_f32_16x16x32_bf16 v[88:91], a[56:59], v[232:235], v[88:91]
    ds_read_b64_tr_b16 a[44:45], v2 offset:28928
    v_mfma_f32_16x16x32_bf16 v[92:95], a[56:59], v[236:239], v[92:95]
    ds_read_b64_tr_b16 a[46:47], v2 offset:30976
    s_waitcnt lgkmcnt(6)
    v_mfma_f32_16x16x32_bf16 v[208:211], a[0:3], v[144:147], v[208:211]
    ds_read_b128 a[48:51], v3 offset:8192
    buffer_load_dwordx4 v6, s[8:11], s91 offen offset:3072 lds
    v_mfma_f32_16x16x32_bf16 v[212:215], a[0:3], v[148:151], v[212:215]
    ds_read_b64_tr_b16 a[52:53], v1 offset:16384
    v_add_u32 v6, 16384, v6
    v_mfma_f32_16x16x32_bf16 v[96:99], a[4:7], v[232:235], v[96:99]
    ds_read_b64_tr_b16 a[54:55], v1 offset:18432
    v_and_b32 v6, 0x3ffff, v6
    v_mfma_f32_16x16x32_bf16 v[100:103], a[4:7], v[236:239], v[100:103]
    ds_read_b128 a[56:59], v4 offset:8192
    s_add_u32 m0, s47, 81920
    v_mfma_f32_16x16x32_bf16 v[208:211], a[8:11], v[152:155], v[208:211]
    ds_read_b64_tr_b16 a[0:1], v2 offset:16384
    v_mfma_f32_16x16x32_bf16 v[212:215], a[8:11], v[156:159], v[212:215]
    ds_read_b64_tr_b16 a[2:3], v2 offset:18432
    v_mfma_f32_16x16x32_bf16 v[104:107], a[12:15], v[232:235], v[104:107]
    ds_read_b128 a[4:7], v3 offset:9216
    v_mfma_f32_16x16x32_bf16 v[108:111], a[12:15], v[236:239], v[108:111]
    buffer_load_dwordx4 v5, s[12:15], 0 offen offset:0 lds
    v_mfma_f32_16x16x32_bf16 v[208:211], a[16:19], v[160:163], v[208:211]
    ds_read_b64_tr_b16 a[8:9], v1 offset:16640
    v_mfma_f32_16x16x32_bf16 v[212:215], a[16:19], v[164:167], v[212:215]
    ds_read_b64_tr_b16 a[10:11], v1 offset:18688
    v_mfma_f32_16x16x32_bf16 v[112:115], a[20:23], v[232:235], v[112:115]
    ds_read_b128 a[12:15], v4 offset:9216
    v_mfma_f32_16x16x32_bf16 v[116:119], a[20:23], v[236:239], v[116:119]
    v_mfma_f32_16x16x32_bf16 v[208:211], a[24:27], v[168:171], v[208:211]
    ds_read_b64_tr_b16 a[16:17], v2 offset:16640
    v_mfma_f32_16x16x32_bf16 v[212:215], a[24:27], v[172:175], v[212:215]
    ds_read_b64_tr_b16 a[18:19], v2 offset:18688
    v_mfma_f32_16x16x32_bf16 v[120:123], a[28:31], v[232:235], v[120:123]
    ds_read_b128 a[20:23], v3 offset:10240
    v_mfma_f32_16x16x32_bf16 v[124:127], a[28:31], v[236:239], v[124:127]
    buffer_load_dwordx4 v5, s[12:15], s85 offen offset:1024 lds
    s_waitcnt lgkmcnt(4)
    v_mfma_f32_16x16x32_bf16 v[208:211], a[32:35], v[176:179], v[208:211]
    ds_read_b64_tr_b16 a[24:25], v1 offset:20480
    v_mfma_f32_16x16x32_bf16 v[212:215], a[32:35], v[180:183], v[212:215]
    ds_read_b64_tr_b16 a[26:27], v1 offset:22528
    v_mfma_f32_16x16x32_bf16 v[192:195], a[36:39], v[232:235], v[192:195]
    ds_read_b128 a[28:31], v4 offset:10240
    v_mfma_f32_16x16x32_bf16 v[196:199], a[36:39], v[236:239], v[196:199]
    v_mfma_f32_16x16x32_bf16 v[208:211], a[40:43], v[184:187], v[208:211]
    ds_read_b64_tr_b16 a[32:33], v2 offset:20480
    v_mfma_f32_16x16x32_bf16 v[212:215], a[40:43], v[188:191], v[212:215]
    ds_read_b64_tr_b16 a[34:35], v2 offset:22528
    v_mfma_f32_16x16x32_bf16 v[200:203], a[44:47], v[232:235], v[200:203]
    ds_read_b128 a[36:39], v3 offset:11264
    v_subrev_u32 v11, 65536, v11
    v_mfma_f32_16x16x32_bf16 v[204:207], a[44:47], v[236:239], v[204:207]
    buffer_load_dwordx4 v5, s[12:15], s86 offen offset:2048 lds
    v_mfma_f32_16x16x32_bf16 v[216:219], a[48:51], v[128:131], v[240:243]
    ds_read_b64_tr_b16 a[40:41], v1 offset:20736
    v_mfma_f32_16x16x32_bf16 v[220:223], a[48:51], v[132:135], v[244:247]
    ds_read_b64_tr_b16 a[42:43], v1 offset:22784
    v_max3_f32 v10, v208, v209, v210
    v_mfma_f32_16x16x32_bf16 a[64:67], a[60:63], v[224:227], a[64:67]
    ds_read_b128 a[44:47], v4 offset:11264
    s_waitcnt vmcnt(15)
    v_mfma_f32_16x16x32_bf16 a[68:71], a[60:63], v[228:231], a[68:71]
    s_barrier
    v_max3_f32 v255, v211, v212, v213
    v_mfma_f32_16x16x32_bf16 v[16:19], a[52:55], v[224:227], v[16:19]
    ds_read_b64_tr_b16 a[48:49], v2 offset:20736
    v_max3_f32 v10, v214, v215, v10
    v_mfma_f32_16x16x32_bf16 v[20:23], a[52:55], v[228:231], v[20:23]
    ds_read_b64_tr_b16 a[50:51], v2 offset:22784
    v_max_f32 v10, v10, v255
    v_mfma_f32_16x16x32_bf16 v[216:219], a[56:59], v[136:139], v[216:219]
    ds_read_b64_tr_b16 a[52:53], v11 offset:1024
    v_subrev_u32 v12, 65536, v12
    v_mfma_f32_16x16x32_bf16 v[220:223], a[56:59], v[140:143], v[220:223]
    ds_read_b64_tr_b16 a[54:55], v11 offset:2048
    buffer_load_dwordx4 v5, s[12:15], s87 offen offset:3072 lds
    v_mfma_f32_16x16x32_bf16 v[24:27], a[0:3], v[224:227], v[24:27]
    ds_read_b64_tr_b16 a[56:57], v11 offset:3072
    v_add_u32 v5, 16384, v5
    v_mfma_f32_16x16x32_bf16 v[28:31], a[0:3], v[228:231], v[28:31]
    ds_read_b64_tr_b16 a[58:59], v11 offset:16384
    v_and_b32 v5, 0x3ffff, v5
    v_mfma_f32_16x16x32_bf16 v[216:219], a[4:7], v[144:147], v[216:219]
    ds_read_b64_tr_b16 a[0:1], v11 offset:17408
    s_add_u32 m0, s47, 98304
    v_mfma_f32_16x16x32_bf16 v[220:223], a[4:7], v[148:151], v[220:223]
    ds_read_b64_tr_b16 a[2:3], v11 offset:18432
    v_cmp_lt_f32 vcc, s98, v10
    v_mfma_f32_16x16x32_bf16 v[32:35], a[8:11], v[224:227], v[32:35]
    ds_read_b64_tr_b16 a[4:5], v11 offset:0
    v_mfma_f32_16x16x32_bf16 v[36:39], a[8:11], v[228:231], v[36:39]
    ds_read_b64_tr_b16 a[6:7], v11 offset:19456
    s_waitcnt lgkmcnt(6)
    v_mfma_f32_16x16x32_bf16 v[216:219], a[12:15], v[152:155], v[216:219]
    s_cbranch_vccnz L_RARE17
L_BACK17:
    v_mfma_f32_16x16x32_bf16 v[220:223], a[12:15], v[156:159], v[220:223]
    v_exp_f32 v208, v208
    v_mfma_f32_16x16x32_bf16 v[40:43], a[16:19], v[224:227], v[40:43]
    v_exp_f32 v209, v209
    v_mfma_f32_16x16x32_bf16 v[44:47], a[16:19], v[228:231], v[44:47]
    v_exp_f32 v210, v210
    v_mfma_f32_16x16x32_bf16 v[216:219], a[20:23], v[160:163], v[216:219]
    ds_read_b64_tr_b16 a[8:9], v12 offset:1024
    buffer_load_dwordx4 v6, s[8:11], s88 offen offset:0 lds
    v_mfma_f32_16x16x32_bf16 v[220:223], a[20:23], v[164:167], v[220:223]
    v_exp_f32 v211, v211
    v_mfma_f32_16x16x32_bf16 v[48:51], a[24:27], v[224:227], v[48:51]
    v_exp_f32 v212, v212
    v_mfma_f32_16x16x32_bf16 v[52:55], a[24:27], v[228:231], v[52:55]
    v_exp_f32 v213, v213
    v_mfma_f32_16x16x32_bf16 v[216:219], a[28:31], v[168:171], v[216:219]
    ds_read_b64_tr_b16 a[10:11], v12 offset:2048
    v_cvt_pk_bf16_f32 v232, v208, v209
    v_mfma_f32_16x16x32_bf16 v[220:223], a[28:31], v[172:175], v[220:223]
    v_exp_f32 v214, v214
    v_mfma_f32_16x16x32_bf16 v[56:59], a[32:35], v[224:227], v[56:59]
    ds_read_b64_tr_b16 a[12:13], v12 offset:3072
    ds_read_b64_tr_b16 a[14:15], v12 offset:16384
    v_mfma_f32_16x16x32_bf16 v[60:63], a[32:35], v[228:231], v[60:63]
    v_exp_f32 v215, v215
    v_mfma_f32_16x16x32_bf16 v[216:219], a[36:39], v[176:179], v[216:219]
    ds_read_b64_tr_b16 a[16:17], v12 offset:17408
    buffer_load_dwordx4 v6, s[8:11], s89 offen offset:1024 lds
    v_mfma_f32_16x16x32_bf16 v[220:223], a[36:39], v[180:183], v[220:223]
    ds_read_b64_tr_b16 a[18:19], v12 offset:18432
    v_cvt_pk_bf16_f32 v233, v210, v211
    v_mfma_f32_16x16x32_bf16 v[64:67], a[40:43], v[224:227], v[64:67]
    ds_read_b64_tr_b16 a[20:21], v12 offset:0
    v_cvt_pk_bf16_f32 v236, v212, v213
    v_mfma_f32_16x16x32_bf16 v[68:71], a[40:43], v[228:231], v[68:71]
    ds_read_b64_tr_b16 a[22:23], v12 offset:19456
    v_cvt_pk_bf16_f32 v237, v214, v215
    v_mfma_f32_16x16x32_bf16 v[216:219], a[44:47], v[184:187], v[216:219]
    ds_read_b64_tr_b16 a[24:25], v11 offset:1280
    v_mfma_f32_16x16x32_bf16 v[220:223], a[44:47], v[188:191], v[220:223]
    ds_read_b64_tr_b16 a[26:27], v11 offset:2304
    buffer_load_dwordx4 v6, s[8:11], s90 offen offset:2048 lds
    v_mfma_f32_16x16x32_bf16 v[72:75], a[48:51], v[224:227], v[72:75]
    ds_read_b64_tr_b16 a[28:29], v11 offset:3328
    v_mfma_f32_16x16x32_bf16 v[76:79], a[48:51], v[228:231], v[76:79]
    ds_read_b64_tr_b16 a[30:31], v11 offset:16640
    v_mfma_f32_16x16x32_bf16 a[88:91], a[52:55], a[224:227], a[88:91]
    ds_read_b64_tr_b16 a[32:33], v11 offset:17664
    v_mfma_f32_16x16x32_bf16 a[92:95], a[52:55], a[228:231], a[92:95]
    ds_read_b64_tr_b16 a[34:35], v11 offset:18688
    s_waitcnt lgkmcnt(6)
    v_mfma_f32_16x16x32_bf16 a[88:91], a[56:59], a[232:235], a[88:91]
    ds_read_b64_tr_b16 a[36:37], v11 offset:256
    v_max3_f32 v10, v216, v217, v218
    v_mfma_f32_16x16x32_bf16 a[92:95], a[56:59], a[236:239], a[92:95]
    ds_read_b64_tr_b16 a[38:39], v11 offset:19712
    buffer_load_dwordx4 v6, s[8:11], s91 offen offset:3072 lds
    v_mfma_f32_16x16x32_bf16 a[88:91], a[0:3], a[240:243], a[88:91]
    ds_read_b64_tr_b16 a[40:41], v12 offset:1280
    v_add_u32 v6, 16384, v6
    v_mfma_f32_16x16x32_bf16 a[92:95], a[0:3], a[244:247], a[92:95]
    ds_read_b64_tr_b16 a[42:43], v12 offset:2304
    v_and_b32 v6, 0x3ffff, v6
    v_mfma_f32_16x16x32_bf16 a[88:91], a[4:7], a[248:251], a[88:91]
    ds_read_b64_tr_b16 a[44:45], v12 offset:3328
    s_add_u32 m0, s47, 114688
    v_mfma_f32_16x16x32_bf16 a[92:95], a[4:7], a[252:255], a[92:95]
    ds_read_b64_tr_b16 a[46:47], v12 offset:16640
    v_max3_f32 v255, v219, v220, v221
    v_mfma_f32_16x16x32_bf16 a[96:99], a[8:11], a[224:227], a[96:99]
    ds_read_b64_tr_b16 a[48:49], v12 offset:17664
    v_max3_f32 v10, v222, v223, v10
    v_mfma_f32_16x16x32_bf16 a[100:103], a[8:11], a[228:231], a[100:103]
    ds_read_b64_tr_b16 a[50:51], v12 offset:18688
    v_max_f32 v10, v10, v255
    v_mfma_f32_16x16x32_bf16 a[96:99], a[12:15], a[232:235], a[96:99]
    ds_read_b64_tr_b16 a[52:53], v12 offset:256
    buffer_load_dwordx4 v5, s[12:15], 0 offen offset:0 lds
    v_mfma_f32_16x16x32_bf16 a[100:103], a[12:15], a[236:239], a[100:103]
    ds_read_b64_tr_b16 a[54:55], v12 offset:19712
    v_accvgpr_read_b32 v252, a88
    v_mfma_f32_16x16x32_bf16 a[96:99], a[16:19], a[240:243], a[96:99]
    ds_read_b64_tr_b16 a[56:57], v11 offset:1536
    v_accvgpr_read_b32 v253, a89
    v_mfma_f32_16x16x32_bf16 a[100:103], a[16:19], a[244:247], a[100:103]
    ds_read_b64_tr_b16 a[58:59], v11 offset:2560
    v_cvt_pk_bf16_f32 v248, v252, v253
    v_mfma_f32_16x16x32_bf16 a[96:99], a[20:23], a[248:251], a[96:99]
    ds_read_b64_tr_b16 a[0:1], v11 offset:3584
    v_cmp_lt_f32 vcc, s98, v10
    v_mfma_f32_16x16x32_bf16 a[100:103], a[20:23], a[252:255], a[100:103]
    ds_read_b64_tr_b16 a[2:3], v11 offset:16896
    s_waitcnt lgkmcnt(6)
    v_mfma_f32_16x16x32_bf16 a[104:107], a[24:27], a[224:227], a[104:107]
    ds_read_b64_tr_b16 a[4:5], v11 offset:17920
    v_accvgpr_read_b32 v252, a90
    v_mfma_f32_16x16x32_bf16 a[108:111], a[24:27], a[228:231], a[108:111]
    ds_read_b64_tr_b16 a[6:7], v11 offset:18944
    buffer_load_dwordx4 v5, s[12:15], s85 offen offset:1024 lds
    v_mfma_f32_16x16x32_bf16 a[104:107], a[28:31], a[232:235], a[104:107]
    s_cbranch_vccnz L_RARE18
L_BACK18:
    v_accvgpr_read_b32 v253, a91
    v_mfma_f32_16x16x32_bf16 a[108:111], a[28:31], a[236:239], a[108:111]
    ds_read_b64_tr_b16 a[8:9], v11 offset:512
    ds_read_b64_tr_b16 a[10:11], v11 offset:19968
    v_mfma_f32_16x16x32_bf16 a[104:107], a[32:35], a[240:243], a[104:107]
    v_exp_f32 v216, v216
    v_mfma_f32_16x16x32_bf16 a[108:111], a[32:35], a[244:247], a[108:111]
    ds_read_b64_tr_b16 a[12:13], v12 offset:1536
    ds_read_b64_tr_b16 a[14:15], v12 offset:2560
    v_mfma_f32_16x16x32_bf16 a[104:107], a[36:39], a[248:251], a[104:107]
    v_exp_f32 v217, v217
    v_mfma_f32_16x16x32_bf16 a[108:111], a[36:39], a[252:255], a[108:111]
    ds_read_b64_tr_b16 a[16:17], v12 offset:3584
    v_subrev_u32 v3, 131072, v3
    v_mfma_f32_16x16x32_bf16 a[112:115], a[40:43], a[224:227], a[112:115]
    ds_read_b64_tr_b16 a[18:19], v12 offset:16896
    v_subrev_u32 v1, 131072, v1
    v_mfma_f32_16x16x32_bf16 a[116:119], a[40:43], a[228:231], a[116:119]
    ds_read_b64_tr_b16 a[20:21], v12 offset:17920
    ds_read_b64_tr_b16 a[22:23], v12 offset:18944
    v_mfma_f32_16x16x32_bf16 a[112:115], a[44:47], a[232:235], a[112:115]
    v_exp_f32 v218, v218
    v_mfma_f32_16x16x32_bf16 a[116:119], a[44:47], a[236:239], a[116:119]
    ds_read_b64_tr_b16 a[24:25], v12 offset:512
    v_subrev_u32 v4, 131072, v4
    v_mfma_f32_16x16x32_bf16 a[112:115], a[48:51], a[240:243], a[112:115]
    ds_read_b64_tr_b16 a[26:27], v12 offset:19968
    v_subrev_u32 v2, 131072, v2
    v_mfma_f32_16x16x32_bf16 a[116:119], a[48:51], a[244:247], a[116:119]
    ds_read_b64_tr_b16 a[28:29], v11 offset:1792
    s_waitcnt lgkmcnt(6)
    v_mfma_f32_16x16x32_bf16 a[112:115], a[52:55], a[248:251], a[112:115]
    s_waitcnt vmcnt(14)
    s_barrier
    ds_read_b64_tr_b16 a[30:31], v11 offset:2816
    v_mfma_f32_16x16x32_bf16 a[116:119], a[52:55], a[252:255], a[116:119]
    ds_read_b64_tr_b16 a[32:33], v11 offset:3840
    buffer_load_dwordx4 v5, s[12:15], s86 offen offset:2048 lds
    v_mfma_f32_16x16x32_bf16 a[120:123], a[56:59], a[224:227], a[120:123]
    ds_read_b64_tr_b16 a[34:35], v11 offset:17152
    ds_read_b64_tr_b16 a[36:37], v11 offset:18176
    v_mfma_f32_16x16x32_bf16 a[124:127], a[56:59], a[228:231], a[124:127]
    v_exp_f32 v219, v219
    v_mfma_f32_16x16x32_bf16 a[120:123], a[0:3], a[232:235], a[120:123]
    ds_read_b64_tr_b16 a[38:39], v11 offset:19200
    ds_read_b64_tr_b16 a[40:41], v11 offset:768
    v_mfma_f32_16x16x32_bf16 a[124:127], a[0:3], a[236:239], a[124:127]
    v_exp_f32 v220, v220
    v_mfma_f32_16x16x32_bf16 a[120:123], a[4:7], a[240:243], a[120:123]
    ds_read_b64_tr_b16 a[42:43], v11 offset:20224
    ds_read_b128 a[44:47], v3 offset:32768
    v_mfma_f32_16x16x32_bf16 a[124:127], a[4:7], a[244:247], a[124:127]
    v_exp_f32 v221, v221
    v_mfma_f32_16x16x32_bf16 a[120:123], a[8:11], a[248:251], a[120:123]
    ds_read_b64_tr_b16 a[48:49], v1 offset:57344
    buffer_load_dwordx4 v5, s[12:15], s87 offen offset:3072 lds
    v_mfma_f32_16x16x32_bf16 a[124:127], a[8:11], a[252:255], a[124:127]
    ds_read_b64_tr_b16 a[50:51], v1 offset:59392
    ds_read_b128 a[52:55], v4 offset:32768
    v_mfma_f32_16x16x32_bf16 a[128:131], a[12:15], a[224:227], a[128:131]
    v_exp_f32 v222, v222
    v_mfma_f32_16x16x32_bf16 a[132:135], a[12:15], a[228:231], a[132:135]
    ds_read_b64_tr_b16 a[56:57], v2 offset:57344
    s_waitcnt lgkmcnt(6)
    v_mfma_f32_16x16x32_bf16 a[128:131], a[16:19], a[232:235], a[128:131]
    ds_read_b64_tr_b16 a[58:59], v2 offset:59392
    v_add_u32 v5, 16384, v5
    v_mfma_f32_16x16x32_bf16 a[132:135], a[16:19], a[236:239], a[132:135]
    ds_read_b128 a[0:3], v3 offset:33792
    v_and_b32 v5, 0x3ffff, v5
    v_mfma_f32_16x16x32_bf16 a[128:131], a[20:23], a[240:243], a[128:131]
    ds_read_b64_tr_b16 a[4:5], v1 offset:57600
    s_add_u32 m0, s47, 131072
    v_mfma_f32_16x16x32_bf16 a[132:135], a[20:23], a[244:247], a[132:135]
    ds_read_b64_tr_b16 a[6:7], v1 offset:59648
    buffer_load_dwordx4 v6, s[8:11], s88 offen offset:0 lds
    v_mfma_f32_16x16x32_bf16 a[128:131], a[24:27], a[248:251], a[128:131]
    ds_read_b128 a[8:11], v4 offset:33792
    v_cvt_pk_bf16_f32 v249, v252, v253
    v_mfma_f32_16x16x32_bf16 a[132:135], a[24:27], a[252:255], a[132:135]
    ds_read_b64_tr_b16 a[12:13], v2 offset:57600
    buffer_load_dwordx4 v6, s[8:11], s89 offen offset:1024 lds
    v_mfma_f32_16x16x32_bf16 a[136:139], a[28:31], a[224:227], a[136:139]
    ds_read_b64_tr_b16 a[14:15], v2 offset:59648
    v_accvgpr_read_b32 v252, a92
    v_mfma_f32_16x16x32_bf16 a[140:143], a[28:31], a[228:231], a[140:143]
    ds_read_b128 a[16:19], v3 offset:34816
    v_accvgpr_read_b32 v253, a93
    v_mfma_f32_16x16x32_bf16 a[136:139], a[32:35], a[232:235], a[136:139]
    ds_read_b64_tr_b16 a[20:21], v1 offset:61440
    v_cvt_pk_bf16_f32 v250, v252, v253
    v_mfma_f32_16x16x32_bf16 a[140:143], a[32:35], a[236:239], a[140:143]
    ds_read_b64_tr_b16 a[22:23], v1 offset:63488
    v_accvgpr_read_b32 v252, a94
    v_mfma_f32_16x16x32_bf16 a[136:139], a[36:39], a[240:243], a[136:139]
    ds_read_b128 a[24:27], v4 offset:34816
    v_accvgpr_read_b32 v253, a95
    v_mfma_f32_16x16x32_bf16 a[140:143], a[36:39], a[244:247], a[140:143]
    ds_read_b64_tr_b16 a[28:29], v2 offset:61440
    s_waitcnt lgkmcnt(6)
    v_mfma_f32_16x16x32_bf16 a[136:139], a[40:43], a[248:251], a[136:139]
    ds_read_b64_tr_b16 a[30:31], v2 offset:63488
    v_cvt_pk_bf16_f32 v251, v252, v253
    v_mfma_f32_16x16x32_bf16 a[140:143], a[40:43], a[252:255], a[140:143]
    buffer_store_dwordx4 v[248:251], v7, s[40:43], s24 offen sc1
    ds_read_b128 a[32:35], v3 offset:35840
    v_mfma_f32_16x16x32_bf16 v[208:211], a[44:47], v[128:131], v[240:243]
    ds_read_b64_tr_b16 a[36:37], v1 offset:61696
    s_add_u32 s24, s24, 16384
    v_mfma_f32_16x16x32_bf16 v[212:215], a[44:47], v[132:135], v[244:247]
    ds_read_b64_tr_b16 a[38:39], v1 offset:63744
    buffer_load_dwordx4 v6, s[8:11], s90 offen offset:2048 lds
    v_mfma_f32_16x16x32_bf16 v[80:83], a[48:51], v[224:227], v[80:83]
    ds_read_b128 a[40:43], v4 offset:35840
    v_accvgpr_read_b32 v252, a96
    v_mfma_f32_16x16x32_bf16 v[84:87], a[48:51], v[228:231], v[84:87]
    ds_read_b64_tr_b16 a[44:45], v2 offset:61696
    v_accvgpr_read_b32 v253, a97
    v_mfma_f32_16x16x32_bf16 v[208:211], a[52:55], v[136:139], v[208:211]
    ds_read_b64_tr_b16 a[46:47], v2 offset:63744
    v_cvt_pk_bf16_f32 v248, v252, v253
    v_mfma_f32_16x16x32_bf16 v[212:215], a[52:55], v[140:143], v[212:215]
    ds_read_b128 a[48:51], v3 offset:40960
    v_accvgpr_read_b32 v252, a98
    v_mfma_f32_16x16x32_bf16 v[88:91], a[56:59], v[224:227], v[88:91]
    v_accvgpr_read_b32 v253, a99
    v_cvt_pk_bf16_f32 v234, v216, v217
    v_mfma_f32_16x16x32_bf16 v[92:95], a[56:59], v[228:231], v[92:95]
    buffer_load_dwordx4 v6, s[8:11], s91 offen offset:3072 lds
    v_add_u32 v6, 16384, v6
    v_mfma_f32_16x16x32_bf16 v[208:211], a[0:3], v[144:147], v[208:211]
    ds_read_b64_tr_b16 a[52:53], v1 offset:49152
    v_and_b32 v6, 0x3ffff, v6
    v_mfma_f32_16x16x32_bf16 v[212:215], a[0:3], v[148:151], v[212:215]
    ds_read_b64_tr_b16 a[54:55], v1 offset:51200
    s_add_u32 m0, s47, 147456
    v_mfma_f32_16x16x32_bf16 v[96:99], a[4:7], v[224:227], v[96:99]
    ds_read_b128 a[56:59], v4 offset:40960
    v_cvt_pk_bf16_f32 v249, v252, v253
    v_mfma_f32_16x16x32_bf16 v[100:103], a[4:7], v[228:231], v[100:103]
    v_accvgpr_read_b32 v252, a100
    v_cvt_pk_bf16_f32 v235, v218, v219
    v_mfma_f32_16x16x32_bf16 v[208:211], a[8:11], v[152:155], v[208:211]
L_PAD8:
    s_cbranch_execz L_PAD12
    ds_read_b64_tr_b16 a[0:1], v2 offset:49152
    v_accvgpr_read_b32 v253, a101
    v_mfma_f32_16x16x32_bf16 v[212:215], a[8:11], v[156:159], v[212:215]
    ds_read_b64_tr_b16 a[2:3], v2 offset:51200
    s_waitcnt lgkmcnt(5)
    v_mfma_f32_16x16x32_bf16 v[104:107], a[12:15], v[224:227], v[104:107]
    ds_read_b128 a[4:7], v3 offset:41984
    v_cvt_pk_bf16_f32 v238, v220, v221
    v_mfma_f32_16x16x32_bf16 v[108:111], a[12:15], v[228:231], v[108:111]
    buffer_load_dwordx4 v5, s[12:15], 0 offen offset:0 lds
    v_cvt_pk_bf16_f32 v250, v252, v253
    v_mfma_f32_16x16x32_bf16 v[208:211], a[16:19], v[160:163], v[208:211]
    v_exp_f32 v223, v223
    v_mfma_f32_16x16x32_bf16 v[212:215], a[16:19], v[164:167], v[212:215]
    ds_read_b64_tr_b16 a[8:9], v1 offset:49408
    v_accvgpr_read_b32 v252, a102
    v_mfma_f32_16x16x32_bf16 v[112:115], a[20:23], v[224:227], v[112:115]
    ds_read_b64_tr_b16 a[10:11], v1 offset:51456
    v_cvt_pk_bf16_f32 v239, v222, v223
    v_mfma_f32_16x16x32_bf16 v[116:119], a[20:23], v[228:231], v[116:119]
    ds_read_b128 a[12:15], v4 offset:41984
    v_accvgpr_read_b32 v253, a103
    v_mfma_f32_16x16x32_bf16 v[208:211], a[24:27], v[168:171], v[208:211]
    ds_read_b64_tr_b16 a[16:17], v2 offset:49408
    v_cvt_pk_bf16_f32 v251, v252, v253
    v_mfma_f32_16x16x32_bf16 v[212:215], a[24:27], v[172:175], v[212:215]
    buffer_store_dwordx4 v[248:251], v7, s[40:43], s24 offen sc1
    ds_read_b64_tr_b16 a[18:19], v2 offset:51456
    v_mfma_f32_16x16x32_bf16 v[120:123], a[28:31], v[224:227], v[120:123]
    ds_read_b128 a[20:23], v3 offset:43008
    s_add_u32 s24, s24, 16384
    v_mfma_f32_16x16x32_bf16 v[124:127], a[28:31], v[228:231], v[124:127]
    buffer_load_dwordx4 v5, s[12:15], s85 offen offset:1024 lds
    v_accvgpr_read_b32 v252, a104
    v_mfma_f32_16x16x32_bf16 v[208:211], a[32:35], v[176:179], v[208:211]
    ds_read_b64_tr_b16 a[24:25], v1 offset:53248
    v_accvgpr_read_b32 v253, a105
    v_mfma_f32_16x16x32_bf16 v[212:215], a[32:35], v[180:183], v[212:215]
    ds_read_b64_tr_b16 a[26:27], v1 offset:55296
    v_cvt_pk_bf16_f32 v248, v252, v253
    v_mfma_f32_16x16x32_bf16 v[192:195], a[36:39], v[224:227], v[192:195]
    ds_read_b128 a[28:31], v4 offset:43008
    v_accvgpr_read_b32 v252, a106
    v_mfma_f32_16x16x32_bf16 v[196:199], a[36:39], v[228:231], v[196:199]
    v_accvgpr_read_b32 v253, a107
    v_cvt_pk_bf16_f32 v249, v252, v253
    v_mfma_f32_16x16x32_bf16 v[208:211], a[40:43], v[184:187], v[208:211]
    ds_read_b64_tr_b16 a[32:33], v2 offset:53248
    v_accvgpr_read_b32 v252, a108
    v_mfma_f32_16x16x32_bf16 v[212:215], a[40:43], v[188:191], v[212:215]
    ds_read_b64_tr_b16 a[34:35], v2 offset:55296
    v_accvgpr_read_b32 v253, a109
    v_mfma_f32_16x16x32_bf16 v[200:203], a[44:47], v[224:227], v[200:203]
    ds_read_b128 a[36:39], v3 offset:44032
    v_add_u32 v3, 65536, v3
    v_mfma_f32_16x16x32_bf16 v[204:207], a[44:47], v[228:231], v[204:207]
    buffer_load_dwordx4 v5, s[12:15], s86 offen offset:2048 lds
    v_cvt_pk_bf16_f32 v250, v252, v253
    v_mfma_f32_16x16x32_bf16 v[216:219], a[48:51], v[128:131], v[240:243]
    ds_read_b64_tr_b16 a[40:41], v1 offset:53504
    v_accvgpr_read_b32 v252, a110
    v_mfma_f32_16x16x32_bf16 v[220:223], a[48:51], v[132:135], v[244:247]
    ds_read_b64_tr_b16 a[42:43], v1 offset:55552
    v_add_u32 v1, 65536, v1
    v_mfma_f32_16x16x32_bf16 a[64:67], a[60:63], v[232:235], a[64:67]
    ds_read_b128 a[44:47], v4 offset:44032
    v_add_u32 v4, 65536, v4
    v_mfma_f32_16x16x32_bf16 a[68:71], a[60:63], v[236:239], a[68:71]
    v_max3_f32 v10, v208, v209, v210
    s_waitcnt lgkmcnt(4)
    v_mfma_f32_16x16x32_bf16 v[16:19], a[52:55], v[232:235], v[16:19]
    ds_read_b64_tr_b16 a[48:49], v2 offset:53504
    s_waitcnt vmcnt(17)
    v_mfma_f32_16x16x32_bf16 v[20:23], a[52:55], v[236:239], v[20:23]
    ds_read_b64_tr_b16 a[50:51], v2 offset:55552
    v_add_u32 v2, 65536, v2
    v_mfma_f32_16x16x32_bf16 v[216:219], a[56:59], v[136:139], v[216:219]
    s_barrier
    ds_read_b128 a[52:55], v3 offset:0
    v_mfma_f32_16x16x32_bf16 v[220:223], a[56:59], v[140:143], v[220:223]
    v_max3_f32 v255, v211, v212, v213
    v_max3_f32 v10, v214, v215, v10
    v_mfma_f32_16x16x32_bf16 v[24:27], a[0:3], v[232:235], v[24:27]
    ds_read_b64_tr_b16 a[56:57], v1 offset:24576
    v_max_f32 v10, v10, v255
    v_mfma_f32_16x16x32_bf16 v[28:31], a[0:3], v[236:239], v[28:31]
    ds_read_b64_tr_b16 a[58:59], v1 offset:26624
    v_cmp_lt_f32 vcc, s98, v10
    v_mfma_f32_16x16x32_bf16 v[216:219], a[4:7], v[144:147], v[216:219]
    ds_read_b128 a[0:3], v4 offset:0
    v_accvgpr_read_b32 v253, a111
    v_mfma_f32_16x16x32_bf16 v[220:223], a[4:7], v[148:151], v[220:223]
    s_cbranch_vccnz L_RARE19
L_BACK19:
    v_cvt_pk_bf16_f32 v251, v252, v253
    v_mfma_f32_16x16x32_bf16 v[32:35], a[8:11], v[232:235], v[32:35]
    buffer_store_dwordx4 v[248:251], v7, s[40:43], s24 offen sc1
    ds_read_b64_tr_b16 a[4:5], v2 offset:24576
    v_mfma_f32_16x16x32_bf16 v[36:39], a[8:11], v[236:239], v[36:39]
    ds_read_b64_tr_b16 a[6:7], v2 offset:26624
    s_add_u32 s24, s24, 16384
    v_mfma_f32_16x16x32_bf16 v[216:219], a[12:15], v[152:155], v[216:219]
    v_exp_f32 v208, v208
    v_mfma_f32_16x16x32_bf16 v[220:223], a[12:15], v[156:159], v[220:223]
    ds_read_b128 a[8:11], v3 offset:1024
    buffer_load_dwordx4 v5, s[12:15], s87 offen offset:3072 lds
    v_mfma_f32_16x16x32_bf16 v[40:43], a[16:19], v[232:235], v[40:43]
    ds_read_b64_tr_b16 a[12:13], v1 offset:24832
    v_accvgpr_read_b32 v252, a112
    v_mfma_f32_16x16x32_bf16 v[44:47], a[16:19], v[236:239], v[44:47]
    v_exp_f32 v209, v209
    v_mfma_f32_16x16x32_bf16 v[216:219], a[20:23], v[160:163], v[216:219]
    ds_read_b64_tr_b16 a[14:15], v1 offset:26880
    v_accvgpr_read_b32 v253, a113
    v_mfma_f32_16x16x32_bf16 v[220:223], a[20:23], v[164:167], v[220:223]
    ds_read_b128 a[16:19], v4 offset:1024
    v_cvt_pk_bf16_f32 v248, v252, v253
    v_mfma_f32_16x16x32_bf16 v[48:51], a[24:27], v[232:235], v[48:51]
    v_exp_f32 v210, v210
    v_mfma_f32_16x16x32_bf16 v[52:55], a[24:27], v[236:239], v[52:55]
    ds_read_b64_tr_b16 a[20:21], v2 offset:24832
    v_accvgpr_read_b32 v252, a114
    v_mfma_f32_16x16x32_bf16 v[216:219], a[28:31], v[168:171], v[216:219]
    ds_read_b64_tr_b16 a[22:23], v2 offset:26880
    v_accvgpr_read_b32 v253, a115
    v_mfma_f32_16x16x32_bf16 v[220:223], a[28:31], v[172:175], v[220:223]
    ds_read_b128 a[24:27], v3 offset:2048
    v_add_u32 v5, 16384, v5
    v_mfma_f32_16x16x32_bf16 v[56:59], a[32:35], v[232:235], v[56:59]
    ds_read_b64_tr_b16 a[28:29], v1 offset:28672
    v_and_b32 v5, 0x3ffff, v5
    v_mfma_f32_16x16x32_bf16 v[60:63], a[32:35], v[236:239], v[60:63]
    s_add_u32 m0, s47, 0
    s_waitcnt lgkmcnt(4)
    v_mfma_f32_16x16x32_bf16 v[216:219], a[36:39], v[176:179], v[216:219]
    v_exp_f32 v211, v211
    v_mfma_f32_16x16x32_bf16 v[220:223], a[36:39], v[180:183], v[220:223]
    buffer_load_dwordx4 v6, s[8:11], s88 offen offset:0 lds
    ds_read_b64_tr_b16 a[30:31], v1 offset:30720
    v_mfma_f32_16x16x32_bf16 v[64:67], a[40:43], v[232:235], v[64:67]
    ds_read_b128 a[32:35], v4 offset:2048
    v_cvt_pk_bf16_f32 v249, v252, v253
    v_mfma_f32_16x16x32_bf16 v[68:71], a[40:43], v[236:239], v[68:71]
    v_accvgpr_read_b32 v252, a116
    v_accvgpr_read_b32 v253, a117
    v_cvt_pk_bf16_f32 v250, v252, v253
    v_accvgpr_read_b32 v252, a118
    v_accvgpr_read_b32 v253, a119
    v_cvt_pk_bf16_f32 v251, v252, v253
    v_mfma_f32_16x16x32_bf16 v[216:219], a[44:47], v[184:187], v[216:219]
    buffer_store_dwordx4 v[248:251], v7, s[40:43], s24 offen sc1
    ds_read_b64_tr_b16 a[36:37], v2 offset:28672
    v_mfma_f32_16x16x32_bf16 v[220:223], a[44:47], v[188:191], v[220:223]
    v_exp_f32 v212, v212
    v_mfma_f32_16x16x32_bf16 v[72:75], a[48:51], v[232:235], v[72:75]
    v_exp_f32 v213, v213
    v_mfma_f32_16x16x32_bf16 v[76:79], a[48:51], v[236:239], v[76:79]
    v_cvt_pk_bf16_f32 v224, v208, v209
    v_exp_f32 v214, v214
    s_add_u32 s24, s24, 16384
    v_cvt_pk_bf16_f32 v225, v210, v211
    v_cvt_pk_bf16_f32 v228, v212, v213
    v_exp_f32 v215, v215
    s_nop 0
    v_cvt_pk_bf16_f32 v229, v214, v215
    v_mfma_f32_16x16x32_bf16 v[208:211], a[52:55], v[128:131], v[240:243]
    ds_read_b64_tr_b16 a[38:39], v2 offset:30720
    v_accvgpr_read_b32 v252, a120
    v_mfma_f32_16x16x32_bf16 v[212:215], a[52:55], v[132:135], v[244:247]
    buffer_load_dwordx4 v6, s[8:11], s89 offen offset:1024 lds
    ds_read_b128 a[40:43], v3 offset:3072
    v_mfma_f32_16x16x32_bf16 v[80:83], a[56:59], v[232:235], v[80:83]
    ds_read_b64_tr_b16 a[44:45], v1 offset:28928
    v_accvgpr_read_b32 v253, a121
    v_mfma_f32_16x16x32_bf16 v[84:87], a[56:59], v[236:239], v[84:87]
    ds_read_b64_tr_b16 a[46:47], v1 offset:30976
    v_cvt_pk_bf16_f32 v248, v252, v253
    v_mfma_f32_16x16x32_bf16 v[208:211], a[0:3], v[136:139], v[208:211]
    ds_read_b128 a[48:51], v4 offset:3072
    v_accvgpr_read_b32 v252, a122
    v_mfma_f32_16x16x32_bf16 v[212:215], a[0:3], v[140:143], v[212:215]
    ds_read_b64_tr_b16 a[52:53], v2 offset:28928
    v_accvgpr_read_b32 v253, a123
    v_mfma_f32_16x16x32_bf16 v[88:91], a[4:7], v[232:235], v[88:91]
    ds_read_b64_tr_b16 a[54:55], v2 offset:30976
    v_cvt_pk_bf16_f32 v249, v252, v253
    v_mfma_f32_16x16x32_bf16 v[92:95], a[4:7], v[236:239], v[92:95]
    ds_read_b128 a[56:59], v3 offset:8192
    v_accvgpr_read_b32 v252, a124
    v_mfma_f32_16x16x32_bf16 v[208:211], a[8:11], v[144:147], v[208:211]
    ds_read_b64_tr_b16 a[0:1], v1 offset:16384
    v_max3_f32 v10, v216, v217, v218
    v_mfma_f32_16x16x32_bf16 v[212:215], a[8:11], v[148:151], v[212:215]
    buffer_load_dwordx4 v6, s[8:11], s90 offen offset:2048 lds
    v_accvgpr_read_b32 v253, a125
    v_cvt_pk_bf16_f32 v250, v252, v253
    v_accvgpr_read_b32 v252, a126
    v_accvgpr_read_b32 v253, a127
    v_cvt_pk_bf16_f32 v251, v252, v253
    v_mfma_f32_16x16x32_bf16 v[96:99], a[12:15], v[232:235], v[96:99]
    buffer_store_dwordx4 v[248:251], v7, s[40:43], s24 offen sc1
    ds_read_b64_tr_b16 a[2:3], v1 offset:18432
    v_mfma_f32_16x16x32_bf16 v[100:103], a[12:15], v[236:239], v[100:103]
    ds_read_b128 a[4:7], v4 offset:8192
    v_max3_f32 v255, v219, v220, v221
    v_mfma_f32_16x16x32_bf16 v[208:211], a[16:19], v[152:155], v[208:211]
    ds_read_b64_tr_b16 a[8:9], v2 offset:16384
    v_max3_f32 v10, v222, v223, v10
    v_mfma_f32_16x16x32_bf16 v[212:215], a[16:19], v[156:159], v[212:215]
    s_add_u32 s24, s24, 16384
    s_waitcnt lgkmcnt(4)
    v_mfma_f32_16x16x32_bf16 v[104:107], a[20:23], v[232:235], v[104:107]
    ds_read_b64_tr_b16 a[10:11], v2 offset:18432
    v_max_f32 v10, v10, v255
    v_mfma_f32_16x16x32_bf16 v[108:111], a[20:23], v[236:239], v[108:111]
    ds_read_b128 a[12:15], v3 offset:9216
    v_cmp_lt_f32 vcc, s98, v10
    v_mfma_f32_16x16x32_bf16 v[208:211], a[24:27], v[160:163], v[208:211]
    ds_read_b64_tr_b16 a[16:17], v1 offset:16640
    v_accvgpr_read_b32 v252, a128
    v_mfma_f32_16x16x32_bf16 v[212:215], a[24:27], v[164:167], v[212:215]
    buffer_load_dwordx4 v6, s[8:11], s91 offen offset:3072 lds
    ds_read_b64_tr_b16 a[18:19], v1 offset:18688
    v_mfma_f32_16x16x32_bf16 v[112:115], a[28:31], v[232:235], v[112:115]
    s_cbranch_vccnz L_RARE20
L_BACK20:
    v_accvgpr_read_b32 v253, a129
    v_mfma_f32_16x16x32_bf16 v[116:119], a[28:31], v[236:239], v[116:119]
    ds_read_b128 a[20:23], v4 offset:9216
    v_cvt_pk_bf16_f32 v248, v252, v253
    v_mfma_f32_16x16x32_bf16 v[208:211], a[32:35], v[168:171], v[208:211]
    v_exp_f32 v216, v216
    v_mfma_f32_16x16x32_bf16 v[212:215], a[32:35], v[172:175], v[212:215]
    ds_read_b64_tr_b16 a[24:25], v2 offset:16640
    v_add_u32 v6, 16384, v6
    v_mfma_f32_16x16x32_bf16 v[120:123], a[36:39], v[232:235], v[120:123]
    ds_read_b64_tr_b16 a[26:27], v2 offset:18688
    v_and_b32 v6, 0x3ffff, v6
    v_mfma_f32_16x16x32_bf16 v[124:127], a[36:39], v[236:239], v[124:127]
    v_accvgpr_read_b32 v252, a130
    v_accvgpr_read_b32 v253, a131
    v_cvt_pk_bf16_f32 v249, v252, v253
    v_accvgpr_read_b32 v252, a132
    v_accvgpr_read_b32 v253, a133
    v_cvt_pk_bf16_f32 v250, v252, v253
    v_accvgpr_read_b32 v252, a134
    v_accvgpr_read_b32 v253, a135
    v_cvt_pk_bf16_f32 v251, v252, v253
    s_add_u32 m0, s47, 16384
    v_mfma_f32_16x16x32_bf16 v[208:211], a[40:43], v[176:179], v[208:211]
    buffer_store_dwordx4 v[248:251], v7, s[40:43], s24 offen sc1
    ds_read_b128 a[28:31], v3 offset:10240
    v_mfma_f32_16x16x32_bf16 v[212:215], a[40:43], v[180:183], v[212:215]
    buffer_load_dwordx4 v5, s[12:15], 0 offen offset:0 lds
    ds_read_b64_tr_b16 a[32:33], v1 offset:20480
    v_mfma_f32_16x16x32_bf16 v[192:195], a[44:47], v[232:235], v[192:195]
    v_exp_f32 v217, v217
    v_mfma_f32_16x16x32_bf16 v[196:199], a[44:47], v[236:239], v[196:199]
    s_add_u32 s24, s24, 16384
    ds_read_b64_tr_b16 a[34:35], v1 offset:22528
    v_mfma_f32_16x16x32_bf16 v[208:211], a[48:51], v[184:187], v[208:211]
    v_exp_f32 v218, v218
    v_mfma_f32_16x16x32_bf16 v[212:215], a[48:51], v[188:191], v[212:215]
    v_exp_f32 v219, v219
    v_mfma_f32_16x16x32_bf16 v[200:203], a[52:55], v[232:235], v[200:203]
    v_exp_f32 v220, v220
    v_mfma_f32_16x16x32_bf16 v[204:207], a[52:55], v[236:239], v[204:207]
    v_exp_f32 v221, v221
    v_cvt_pk_bf16_f32 v226, v216, v217
    v_exp_f32 v222, v222
    v_cvt_pk_bf16_f32 v227, v218, v219
    v_cvt_pk_bf16_f32 v230, v220, v221
    v_exp_f32 v223, v223
    s_nop 0
    v_cvt_pk_bf16_f32 v231, v222, v223
    v_mfma_f32_16x16x32_bf16 v[216:219], a[56:59], v[128:131], v[240:243]
    ds_read_b128 a[36:39], v4 offset:10240
    v_accvgpr_read_b32 v252, a136
    v_mfma_f32_16x16x32_bf16 v[220:223], a[56:59], v[132:135], v[244:247]
    buffer_load_dwordx4 v5, s[12:15], s85 offen offset:1024 lds
    ds_read_b64_tr_b16 a[40:41], v2 offset:20480
    v_mfma_f32_16x16x32_bf16 a[64:67], a[60:63], v[224:227], a[64:67]
    ds_read_b64_tr_b16 a[42:43], v2 offset:22528
    v_accvgpr_read_b32 v253, a137
    v_mfma_f32_16x16x32_bf16 a[68:71], a[60:63], v[228:231], a[68:71]
    ds_read_b128 a[44:47], v3 offset:11264
    s_waitcnt lgkmcnt(4)
    v_mfma_f32_16x16x32_bf16 v[16:19], a[0:3], v[224:227], v[16:19]
    ds_read_b64_tr_b16 a[48:49], v1 offset:20736
    v_cvt_pk_bf16_f32 v248, v252, v253
    v_mfma_f32_16x16x32_bf16 v[20:23], a[0:3], v[228:231], v[20:23]
    v_accvgpr_read_b32 v252, a138
    v_accvgpr_read_b32 v253, a139
    v_cvt_pk_bf16_f32 v249, v252, v253
    v_accvgpr_read_b32 v252, a140
    v_accvgpr_read_b32 v253, a141
    v_cvt_pk_bf16_f32 v250, v252, v253
    v_accvgpr_read_b32 v252, a142
    v_accvgpr_read_b32 v253, a143
    v_cvt_pk_bf16_f32 v251, v252, v253
    v_mfma_f32_16x16x32_bf16 v[216:219], a[4:7], v[136:139], v[216:219]
    buffer_store_dwordx4 v[248:251], v7, s[40:43], s24 offen sc1
    ds_read_b64_tr_b16 a[50:51], v1 offset:22784
    v_mfma_f32_16x16x32_bf16 v[220:223], a[4:7], v[140:143], v[220:223]
    ds_read_b128 a[52:55], v4 offset:11264
    v_max3_f32 v10, v208, v209, v210
    v_mfma_f32_16x16x32_bf16 v[24:27], a[8:11], v[224:227], v[24:27]
    s_waitcnt vmcnt(21)
    s_barrier
    v_mfma_f32_16x16x32_bf16 v[28:31], a[8:11], v[228:231], v[28:31]
    buffer_load_dwordx4 v5, s[12:15], s86 offen offset:2048 lds
    ds_read_b64_tr_b16 a[56:57], v2 offset:20736
    v_mfma_f32_16x16x32_bf16 v[216:219], a[12:15], v[144:147], v[216:219]
    ds_read_b64_tr_b16 a[58:59], v2 offset:22784
    v_max3_f32 v255, v211, v212, v213
    v_mfma_f32_16x16x32_bf16 v[220:223], a[12:15], v[148:151], v[220:223]
    ds_read_b128 a[0:3], v3 offset:32768
    v_max3_f32 v10, v214, v215, v10
    v_mfma_f32_16x16x32_bf16 v[32:35], a[16:19], v[224:227], v[32:35]
    ds_read_b64_tr_b16 a[4:5], v1 offset:57344
    v_max_f32 v10, v10, v255
    v_mfma_f32_16x16x32_bf16 v[36:39], a[16:19], v[228:231], v[36:39]
    ds_read_b64_tr_b16 a[6:7], v1 offset:59392
    v_cmp_lt_f32 vcc, s98, v10
    v_mfma_f32_16x16x32_bf16 v[216:219], a[20:23], v[152:155], v[216:219]
    ds_read_b128 a[8:11], v4 offset:32768
    buffer_load_dwordx4 v5, s[12:15], s87 offen offset:3072 lds
    v_mfma_f32_16x16x32_bf16 v[220:223], a[20:23], v[156:159], v[220:223]
    s_cbranch_vccnz L_RARE21
L_BACK21:
    v_add_u32 v5, 16384, v5
    v_mfma_f32_16x16x32_bf16 v[40:43], a[24:27], v[224:227], v[40:43]
    v_exp_f32 v208, v208
    v_mfma_f32_16x16x32_bf16 v[44:47], a[24:27], v[228:231], v[44:47]
    v_exp_f32 v209, v209
    v_mfma_f32_16x16x32_bf16 v[216:219], a[28:31], v[160:163], v[216:219]
    v_exp_f32 v210, v210
    v_mfma_f32_16x16x32_bf16 v[220:223], a[28:31], v[164:167], v[220:223]
    v_exp_f32 v211, v211
    v_mfma_f32_16x16x32_bf16 v[48:51], a[32:35], v[224:227], v[48:51]
    ds_read_b64_tr_b16 a[12:13], v2 offset:57344
    v_and_b32 v5, 0x3ffff, v5
    v_mfma_f32_16x16x32_bf16 v[52:55], a[32:35], v[228:231], v[52:55]
    ds_read_b64_tr_b16 a[14:15], v2 offset:59392
    s_waitcnt lgkmcnt(2)
    v_mfma_f32_16x16x32_bf16 v[216:219], a[36:39], v[168:171], v[216:219]
    v_exp_f32 v212, v212
    v_mfma_f32_16x16x32_bf16 v[220:223], a[36:39], v[172:175], v[220:223]
    ds_read_b128 a[16:19], v3 offset:33792
    ds_read_b64_tr_b16 a[20:21], v1 offset:57600
    v_mfma_f32_16x16x32_bf16 v[56:59], a[40:43], v[224:227], v[56:59]
    v_exp_f32 v213, v213
    v_mfma_f32_16x16x32_bf16 v[60:63], a[40:43], v[228:231], v[60:63]
    s_add_u32 m0, s47, 32768
    ds_read_b64_tr_b16 a[22:23], v1 offset:59648
    v_mfma_f32_16x16x32_bf16 v[216:219], a[44:47], v[176:179], v[216:219]
    ds_read_b128 a[24:27], v4 offset:33792
    buffer_load_dwordx4 v6, s[8:11], s88 offen offset:0 lds
    v_mfma_f32_16x16x32_bf16 v[220:223], a[44:47], v[180:183], v[220:223]
    ds_read_b64_tr_b16 a[28:29], v2 offset:57600
    ds_read_b64_tr_b16 a[30:31], v2 offset:59648
    v_mfma_f32_16x16x32_bf16 v[64:67], a[48:51], v[224:227], v[64:67]
    v_exp_f32 v214, v214
    v_mfma_f32_16x16x32_bf16 v[68:71], a[48:51], v[228:231], v[68:71]
    ds_read_b128 a[32:35], v3 offset:34816
    v_cvt_pk_bf16_f32 v232, v208, v209
    v_mfma_f32_16x16x32_bf16 v[216:219], a[52:55], v[184:187], v[216:219]
    ds_read_b64_tr_b16 a[36:37], v1 offset:61440
    v_cvt_pk_bf16_f32 v233, v210, v211
    v_mfma_f32_16x16x32_bf16 v[220:223], a[52:55], v[188:191], v[220:223]
    ds_read_b64_tr_b16 a[38:39], v1 offset:63488
    ds_read_b128 a[40:43], v4 offset:34816
    v_mfma_f32_16x16x32_bf16 v[72:75], a[56:59], v[224:227], v[72:75]
    v_exp_f32 v215, v215
    v_mfma_f32_16x16x32_bf16 v[76:79], a[56:59], v[228:231], v[76:79]
    v_cvt_pk_bf16_f32 v236, v212, v213
    v_cvt_pk_bf16_f32 v237, v214, v215
    v_mfma_f32_16x16x32_bf16 v[208:211], a[0:3], v[128:131], v[240:243]
    ds_read_b64_tr_b16 a[44:45], v2 offset:61440
    buffer_load_dwordx4 v6, s[8:11], s89 offen offset:1024 lds
    v_mfma_f32_16x16x32_bf16 v[212:215], a[0:3], v[132:135], v[244:247]
    ds_read_b64_tr_b16 a[46:47], v2 offset:63488
    v_max3_f32 v10, v216, v217, v218
    v_mfma_f32_16x16x32_bf16 v[80:83], a[4:7], v[224:227], v[80:83]
    ds_read_b128 a[48:51], v3 offset:35840
    v_max3_f32 v255, v219, v220, v221
    v_mfma_f32_16x16x32_bf16 v[84:87], a[4:7], v[228:231], v[84:87]
    ds_read_b64_tr_b16 a[52:53], v1 offset:61696
    v_max3_f32 v10, v222, v223, v10
    v_mfma_f32_16x16x32_bf16 v[208:211], a[8:11], v[136:139], v[208:211]
    ds_read_b64_tr_b16 a[54:55], v1 offset:63744
    v_max_f32 v10, v10, v255
    v_mfma_f32_16x16x32_bf16 v[212:215], a[8:11], v[140:143], v[212:215]
    ds_read_b128 a[56:59], v4 offset:35840
    s_waitcnt lgkmcnt(6)
    v_mfma_f32_16x16x32_bf16 v[88:91], a[12:15], v[224:227], v[88:91]
    ds_read_b64_tr_b16 a[0:1], v2 offset:61696
    buffer_load_dwordx4 v6, s[8:11], s90 offen offset:2048 lds
    v_mfma_f32_16x16x32_bf16 v[92:95], a[12:15], v[228:231], v[92:95]
    ds_read_b64_tr_b16 a[2:3], v2 offset:63744
    v_cmp_lt_f32 vcc, s98, v10
    v_mfma_f32_16x16x32_bf16 v[208:211], a[16:19], v[144:147], v[208:211]
    ds_read_b128 a[4:7], v3 offset:40960
    buffer_load_dwordx4 v6, s[8:11], s91 offen offset:3072 lds
    v_mfma_f32_16x16x32_bf16 v[212:215], a[16:19], v[148:151], v[212:215]
    s_cbranch_vccnz L_RARE22
L_BACK22:
    s_add_u32 m0, s47, 49152
    v_mfma_f32_16x16x32_bf16 v[96:99], a[20:23], v[224:227], v[96:99]
    v_exp_f32 v216, v216
    v_mfma_f32_16x16x32_bf16 v[100:103], a[20:23], v[228:231], v[100:103]
    v_exp_f32 v217, v217
    v_mfma_f32_16x16x32_bf16 v[208:211], a[24:27], v[152:155], v[208:211]
    v_exp_f32 v218, v218
    v_mfma_f32_16x16x32_bf16 v[212:215], a[24:27], v[156:159], v[212:215]
    v_exp_f32 v219, v219
    v_mfma_f32_16x16x32_bf16 v[104:107], a[28:31], v[224:227], v[104:107]
    v_exp_f32 v220, v220
    v_mfma_f32_16x16x32_bf16 v[108:111], a[28:31], v[228:231], v[108:111]
    ds_read_b64_tr_b16 a[8:9], v1 offset:49152
    ds_read_b64_tr_b16 a[10:11], v1 offset:51200
    v_mfma_f32_16x16x32_bf16 v[208:211], a[32:35], v[160:163], v[208:211]
    v_exp_f32 v221, v221
    v_mfma_f32_16x16x32_bf16 v[212:215], a[32:35], v[164:167], v[212:215]
    ds_read_b128 a[12:15], v4 offset:40960
    buffer_load_dwordx4 v5, s[12:15], 0 offen offset:0 lds
    v_mfma_f32_16x16x32_bf16 v[112:115], a[36:39], v[224:227], v[112:115]
    ds_read_b64_tr_b16 a[16:17], v2 offset:49152
    v_cvt_pk_bf16_f32 v234, v216, v217
    v_mfma_f32_16x16x32_bf16 v[116:119], a[36:39], v[228:231], v[116:119]
    v_exp_f32 v222, v222
    v_mfma_f32_16x16x32_bf16 v[208:211], a[40:43], v[168:171], v[208:211]
    ds_read_b64_tr_b16 a[18:19], v2 offset:51200
    v_cvt_pk_bf16_f32 v235, v218, v219
    v_mfma_f32_16x16x32_bf16 v[212:215], a[40:43], v[172:175], v[212:215]
    ds_read_b128 a[20:23], v3 offset:41984
    s_waitcnt lgkmcnt(4)
    v_mfma_f32_16x16x32_bf16 v[120:123], a[44:47], v[224:227], v[120:123]
    ds_read_b64_tr_b16 a[24:25], v1 offset:49408
    ds_read_b64_tr_b16 a[26:27], v1 offset:51456
    v_mfma_f32_16x16x32_bf16 v[124:127], a[44:47], v[228:231], v[124:127]
    v_exp_f32 v223, v223
    v_mfma_f32_16x16x32_bf16 v[208:211], a[48:51], v[176:179], v[208:211]
    ds_read_b128 a[28:31], v4 offset:41984
    v_cvt_pk_bf16_f32 v238, v220, v221
    v_mfma_f32_16x16x32_bf16 v[212:215], a[48:51], v[180:183], v[212:215]
    ds_read_b64_tr_b16 a[32:33], v2 offset:49408
    v_cvt_pk_bf16_f32 v239, v222, v223
    v_mfma_f32_16x16x32_bf16 v[192:195], a[52:55], v[224:227], v[192:195]
    ds_read_b64_tr_b16 a[34:35], v2 offset:51456
    buffer_load_dwordx4 v5, s[12:15], s85 offen offset:1024 lds
    v_mfma_f32_16x16x32_bf16 v[196:199], a[52:55], v[228:231], v[196:199]
    ds_read_b128 a[36:39], v3 offset:43008
    v_mfma_f32_16x16x32_bf16 v[208:211], a[56:59], v[184:187], v[208:211]
    ds_read_b64_tr_b16 a[40:41], v1 offset:53248
    v_mfma_f32_16x16x32_bf16 v[212:215], a[56:59], v[188:191], v[212:215]
    ds_read_b64_tr_b16 a[42:43], v1 offset:55296
    v_mfma_f32_16x16x32_bf16 v[200:203], a[0:3], v[224:227], v[200:203]
    ds_read_b128 a[44:47], v4 offset:43008
    v_mfma_f32_16x16x32_bf16 v[204:207], a[0:3], v[228:231], v[204:207]
    ds_read_b64_tr_b16 a[48:49], v2 offset:53248
    buffer_load_dwordx4 v5, s[12:15], s86 offen offset:2048 lds
    v_mfma_f32_16x16x32_bf16 v[216:219], a[4:7], v[128:131], v[240:243]
    ds_read_b64_tr_b16 a[50:51], v2 offset:55296
    s_waitcnt vmcnt(9)
    v_mfma_f32_16x16x32_bf16 v[220:223], a[4:7], v[132:135], v[244:247]
    ds_read_b128 a[52:55], v3 offset:44032
    v_mov_b32 v9, 2
    v_mfma_f32_16x16x32_bf16 a[64:67], a[60:63], v[232:235], a[64:67]
    ds_read_b64_tr_b16 a[56:57], v1 offset:53504
    v_add_u32 v3, 65536, v3
    v_mfma_f32_16x16x32_bf16 a[68:71], a[60:63], v[236:239], a[68:71]
    ds_read_b64_tr_b16 a[58:59], v1 offset:55552
    buffer_store_dword v9, v8, s[40:43], 0 offen sc1
    v_mfma_f32_16x16x32_bf16 v[16:19], a[8:11], v[232:235], v[16:19]
    ds_read_b128 a[0:3], v4 offset:44032
    v_add_u32 v1, 65536, v1
    v_mfma_f32_16x16x32_bf16 v[20:23], a[8:11], v[236:239], v[20:23]
    ds_read_b64_tr_b16 a[4:5], v2 offset:53504
    s_waitcnt lgkmcnt(6)
    v_mfma_f32_16x16x32_bf16 v[216:219], a[12:15], v[136:139], v[216:219]
    ds_read_b64_tr_b16 a[6:7], v2 offset:55552
    v_add_u32 v4, 65536, v4
    v_mfma_f32_16x16x32_bf16 v[220:223], a[12:15], v[140:143], v[220:223]
    v_add_u32 v2, 65536, v2
    v_max3_f32 v10, v208, v209, v210
    v_mfma_f32_16x16x32_bf16 v[24:27], a[16:19], v[232:235], v[24:27]
    s_barrier
    v_mfma_f32_16x16x32_bf16 v[28:31], a[16:19], v[236:239], v[28:31]
    ds_read_b128 a[8:11], v3 offset:0
    v_max3_f32 v255, v211, v212, v213
    v_mfma_f32_16x16x32_bf16 v[216:219], a[20:23], v[144:147], v[216:219]
    ds_read_b64_tr_b16 a[12:13], v1 offset:24576
    v_max3_f32 v10, v214, v215, v10
    v_mfma_f32_16x16x32_bf16 v[220:223], a[20:23], v[148:151], v[220:223]
    ds_read_b64_tr_b16 a[14:15], v1 offset:26624
    v_max_f32 v10, v10, v255
    v_mfma_f32_16x16x32_bf16 v[32:35], a[24:27], v[232:235], v[32:35]
    ds_read_b128 a[16:19], v4 offset:0
    v_cmp_lt_f32 vcc, s98, v10
    v_mfma_f32_16x16x32_bf16 v[36:39], a[24:27], v[236:239], v[36:39]
    ds_read_b64_tr_b16 a[20:21], v2 offset:24576
    buffer_load_dwordx4 v5, s[12:15], s87 offen offset:3072 lds
    v_mfma_f32_16x16x32_bf16 v[216:219], a[28:31], v[152:155], v[216:219]
    s_cbranch_vccnz L_RARE23
L_BACK23:
    v_add_u32 v5, 16384, v5
    v_mfma_f32_16x16x32_bf16 v[220:223], a[28:31], v[156:159], v[220:223]
    v_exp_f32 v208, v208
    v_mfma_f32_16x16x32_bf16 v[40:43], a[32:35], v[232:235], v[40:43]
    v_exp_f32 v209, v209
    v_mfma_f32_16x16x32_bf16 v[44:47], a[32:35], v[236:239], v[44:47]
    v_exp_f32 v210, v210
    v_mfma_f32_16x16x32_bf16 v[216:219], a[36:39], v[160:163], v[216:219]
    v_exp_f32 v211, v211
    v_mfma_f32_16x16x32_bf16 v[220:223], a[36:39], v[164:167], v[220:223]
    ds_read_b64_tr_b16 a[22:23], v2 offset:26624
    v_and_b32 v5, 0x3ffff, v5
    v_mfma_f32_16x16x32_bf16 v[48:51], a[40:43], v[232:235], v[48:51]
    v_exp_f32 v212, v212
    v_mfma_f32_16x16x32_bf16 v[52:55], a[40:43], v[236:239], v[52:55]
    ds_read_b128 a[24:27], v3 offset:1024
    s_add_u32 m0, s47, 65536
    v_mfma_f32_16x16x32_bf16 v[216:219], a[44:47], v[168:171], v[216:219]
    ds_read_b64_tr_b16 a[28:29], v1 offset:24832
    buffer_load_dwordx4 v5, s[12:15], 0 offen offset:0 lds
    v_mfma_f32_16x16x32_bf16 v[220:223], a[44:47], v[172:175], v[220:223]
    ds_read_b64_tr_b16 a[30:31], v1 offset:26880
    s_waitcnt lgkmcnt(4)
    v_mfma_f32_16x16x32_bf16 v[56:59], a[48:51], v[232:235], v[56:59]
    v_exp_f32 v213, v213
    v_mfma_f32_16x16x32_bf16 v[60:63], a[48:51], v[236:239], v[60:63]
    ds_read_b128 a[32:35], v4 offset:1024
    v_cvt_pk_bf16_f32 v224, v208, v209
    v_mfma_f32_16x16x32_bf16 v[216:219], a[52:55], v[176:179], v[216:219]
    v_exp_f32 v214, v214
    v_mfma_f32_16x16x32_bf16 v[220:223], a[52:55], v[180:183], v[220:223]
    ds_read_b64_tr_b16 a[36:37], v2 offset:24832
    ds_read_b64_tr_b16 a[38:39], v2 offset:26880
    v_mfma_f32_16x16x32_bf16 v[64:67], a[56:59], v[232:235], v[64:67]
    v_exp_f32 v215, v215
    v_mfma_f32_16x16x32_bf16 v[68:71], a[56:59], v[236:239], v[68:71]
    ds_read_b128 a[40:43], v3 offset:2048
    v_cvt_pk_bf16_f32 v225, v210, v211
    v_mfma_f32_16x16x32_bf16 v[216:219], a[0:3], v[184:187], v[216:219]
    ds_read_b64_tr_b16 a[44:45], v1 offset:28672
    v_cvt_pk_bf16_f32 v228, v212, v213
    v_mfma_f32_16x16x32_bf16 v[220:223], a[0:3], v[188:191], v[220:223]
    ds_read_b64_tr_b16 a[46:47], v1 offset:30720
    v_cvt_pk_bf16_f32 v229, v214, v215
    v_mfma_f32_16x16x32_bf16 v[72:75], a[4:7], v[232:235], v[72:75]
    ds_read_b128 a[48:51], v4 offset:2048
    buffer_load_dwordx4 v5, s[12:15], s85 offen offset:1024 lds
    v_mfma_f32_16x16x32_bf16 v[76:79], a[4:7], v[236:239], v[76:79]
L_PAD9:
    s_cbranch_execz L_PAD13
    ds_read_b64_tr_b16 a[52:53], v2 offset:28672
    buffer_load_dwordx4 v5, s[12:15], s86 offen offset:2048 lds
    v_mfma_f32_16x16x32_bf16 v[208:211], a[8:11], v[128:131], v[240:243]
    ds_read_b64_tr_b16 a[54:55], v2 offset:30720
    v_mfma_f32_16x16x32_bf16 v[212:215], a[8:11], v[132:135], v[244:247]
    ds_read_b128 a[56:59], v3 offset:3072
    v_max3_f32 v10, v216, v217, v218
    v_mfma_f32_16x16x32_bf16 v[80:83], a[12:15], v[232:235], v[80:83]
    ds_read_b64_tr_b16 a[0:1], v1 offset:28928
    v_max3_f32 v255, v219, v220, v221
    v_mfma_f32_16x16x32_bf16 v[84:87], a[12:15], v[236:239], v[84:87]
    ds_read_b64_tr_b16 a[2:3], v1 offset:30976
    v_max3_f32 v10, v222, v223, v10
    v_mfma_f32_16x16x32_bf16 v[208:211], a[16:19], v[136:139], v[208:211]
    ds_read_b128 a[4:7], v4 offset:3072
    v_max_f32 v10, v10, v255
    v_mfma_f32_16x16x32_bf16 v[212:215], a[16:19], v[140:143], v[212:215]
    ds_read_b64_tr_b16 a[8:9], v2 offset:28928
    s_waitcnt lgkmcnt(6)
    v_mfma_f32_16x16x32_bf16 v[88:91], a[20:23], v[232:235], v[88:91]
    ds_read_b64_tr_b16 a[10:11], v2 offset:30976
    v_cmp_lt_f32 vcc, s98, v10
    v_mfma_f32_16x16x32_bf16 v[92:95], a[20:23], v[236:239], v[92:95]
    ds_read_b128 a[12:15], v3 offset:8192
    buffer_load_dwordx4 v5, s[12:15], s87 offen offset:3072 lds
    v_mfma_f32_16x16x32_bf16 v[208:211], a[24:27], v[144:147], v[208:211]
    s_cbranch_vccnz L_RARE24
L_BACK24:
    v_add_u32 v5, 16384, v5
    v_mfma_f32_16x16x32_bf16 v[212:215], a[24:27], v[148:151], v[212:215]
    v_exp_f32 v216, v216
    v_mfma_f32_16x16x32_bf16 v[96:99], a[28:31], v[232:235], v[96:99]
    v_exp_f32 v217, v217
    v_mfma_f32_16x16x32_bf16 v[100:103], a[28:31], v[236:239], v[100:103]
    v_exp_f32 v218, v218
    v_mfma_f32_16x16x32_bf16 v[208:211], a[32:35], v[152:155], v[208:211]
    v_exp_f32 v219, v219
    v_mfma_f32_16x16x32_bf16 v[212:215], a[32:35], v[156:159], v[212:215]
    ds_read_b64_tr_b16 a[16:17], v1 offset:16384
    v_and_b32 v5, 0x3ffff, v5
    v_mfma_f32_16x16x32_bf16 v[104:107], a[36:39], v[232:235], v[104:107]
    v_exp_f32 v220, v220
    v_mfma_f32_16x16x32_bf16 v[108:111], a[36:39], v[236:239], v[108:111]
    ds_read_b64_tr_b16 a[18:19], v1 offset:18432
    s_add_u32 m0, s47, 81920
    v_mfma_f32_16x16x32_bf16 v[208:211], a[40:43], v[160:163], v[208:211]
    ds_read_b128 a[20:23], v4 offset:8192
    buffer_load_dwordx4 v5, s[12:15], 0 offen offset:0 lds
    v_mfma_f32_16x16x32_bf16 v[212:215], a[40:43], v[164:167], v[212:215]
    v_exp_f32 v221, v221
    v_mfma_f32_16x16x32_bf16 v[112:115], a[44:47], v[232:235], v[112:115]
    ds_read_b64_tr_b16 a[24:25], v2 offset:16384
    v_cvt_pk_bf16_f32 v226, v216, v217
    v_mfma_f32_16x16x32_bf16 v[116:119], a[44:47], v[236:239], v[116:119]
    v_exp_f32 v222, v222
    v_mfma_f32_16x16x32_bf16 v[208:211], a[48:51], v[168:171], v[208:211]
    ds_read_b64_tr_b16 a[26:27], v2 offset:18432
    v_cvt_pk_bf16_f32 v227, v218, v219
    v_mfma_f32_16x16x32_bf16 v[212:215], a[48:51], v[172:175], v[212:215]
    ds_read_b128 a[28:31], v3 offset:9216
    s_waitcnt lgkmcnt(4)
    v_mfma_f32_16x16x32_bf16 v[120:123], a[52:55], v[232:235], v[120:123]
    ds_read_b64_tr_b16 a[32:33], v1 offset:16640
    ds_read_b64_tr_b16 a[34:35], v1 offset:18688
    v_mfma_f32_16x16x32_bf16 v[124:127], a[52:55], v[236:239], v[124:127]
    v_exp_f32 v223, v223
    v_mfma_f32_16x16x32_bf16 v[208:211], a[56:59], v[176:179], v[208:211]
    ds_read_b128 a[36:39], v4 offset:9216
    v_cvt_pk_bf16_f32 v230, v220, v221
    v_mfma_f32_16x16x32_bf16 v[212:215], a[56:59], v[180:183], v[212:215]
    ds_read_b64_tr_b16 a[40:41], v2 offset:16640
    v_cvt_pk_bf16_f32 v231, v222, v223
    v_mfma_f32_16x16x32_bf16 v[192:195], a[0:3], v[232:235], v[192:195]
    ds_read_b64_tr_b16 a[42:43], v2 offset:18688
    buffer_load_dwordx4 v5, s[12:15], s85 offen offset:1024 lds
    v_mfma_f32_16x16x32_bf16 v[196:199], a[0:3], v[236:239], v[196:199]
    ds_read_b128 a[44:47], v3 offset:10240
    v_mfma_f32_16x16x32_bf16 v[208:211], a[4:7], v[184:187], v[208:211]
    ds_read_b64_tr_b16 a[48:49], v1 offset:20480
    v_mfma_f32_16x16x32_bf16 v[212:215], a[4:7], v[188:191], v[212:215]
    ds_read_b64_tr_b16 a[50:51], v1 offset:22528
    v_mfma_f32_16x16x32_bf16 v[200:203], a[8:11], v[232:235], v[200:203]
    ds_read_b128 a[52:55], v4 offset:10240
    v_mfma_f32_16x16x32_bf16 v[204:207], a[8:11], v[236:239], v[204:207]
    ds_read_b64_tr_b16 a[56:57], v2 offset:20480
    buffer_load_dwordx4 v5, s[12:15], s86 offen offset:2048 lds
    v_mfma_f32_16x16x32_bf16 v[216:219], a[12:15], v[128:131], v[240:243]
    ds_read_b64_tr_b16 a[58:59], v2 offset:22528
    v_mfma_f32_16x16x32_bf16 v[220:223], a[12:15], v[132:135], v[244:247]
    ds_read_b128 a[0:3], v3 offset:11264
    v_subrev_u32 v3, 131072, v3
    v_mfma_f32_16x16x32_bf16 a[64:67], a[60:63], v[224:227], a[64:67]
    ds_read_b64_tr_b16 a[4:5], v1 offset:20736
    v_max3_f32 v10, v208, v209, v210
    v_mfma_f32_16x16x32_bf16 a[68:71], a[60:63], v[228:231], a[68:71]
    ds_read_b64_tr_b16 a[6:7], v1 offset:22784
    v_subrev_u32 v1, 131072, v1
    v_mfma_f32_16x16x32_bf16 v[16:19], a[16:19], v[224:227], v[16:19]
    ds_read_b128 a[8:11], v4 offset:11264
    v_subrev_u32 v4, 131072, v4
    v_mfma_f32_16x16x32_bf16 v[20:23], a[16:19], v[228:231], v[20:23]
    ds_read_b64_tr_b16 a[12:13], v2 offset:20736
    s_waitcnt lgkmcnt(6)
    v_mfma_f32_16x16x32_bf16 v[216:219], a[20:23], v[136:139], v[216:219]
    ds_read_b64_tr_b16 a[14:15], v2 offset:22784
    v_subrev_u32 v2, 131072, v2
    v_mfma_f32_16x16x32_bf16 v[220:223], a[20:23], v[140:143], v[220:223]
    s_waitcnt vmcnt(16)
    s_barrier
    v_mfma_f32_16x16x32_bf16 v[24:27], a[24:27], v[224:227], v[24:27]
    ds_read_b128 a[16:19], v3 offset:0
    v_max3_f32 v255, v211, v212, v213
    v_mfma_f32_16x16x32_bf16 v[28:31], a[24:27], v[228:231], v[28:31]
    ds_read_b64_tr_b16 a[20:21], v1 offset:24576
    v_max3_f32 v10, v214, v215, v10
    v_mfma_f32_16x16x32_bf16 v[216:219], a[28:31], v[144:147], v[216:219]
    ds_read_b64_tr_b16 a[22:23], v1 offset:26624
    v_max_f32 v10, v10, v255
    v_mfma_f32_16x16x32_bf16 v[220:223], a[28:31], v[148:151], v[220:223]
    ds_read_b128 a[24:27], v4 offset:0
    v_cmp_lt_f32 vcc, s98, v10
    v_mfma_f32_16x16x32_bf16 v[32:35], a[32:35], v[224:227], v[32:35]
    ds_read_b64_tr_b16 a[28:29], v2 offset:24576
    buffer_load_dwordx4 v5, s[12:15], s87 offen offset:3072 lds
    v_mfma_f32_16x16x32_bf16 v[36:39], a[32:35], v[228:231], v[36:39]
    s_cbranch_vccnz L_RARE25
L_BACK25:
    v_accvgpr_read_b32 v5, a82
    v_mfma_f32_16x16x32_bf16 v[216:219], a[36:39], v[152:155], v[216:219]
    v_exp_f32 v208, v208
    v_mfma_f32_16x16x32_bf16 v[220:223], a[36:39], v[156:159], v[220:223]
    v_exp_f32 v209, v209
    v_mfma_f32_16x16x32_bf16 v[40:43], a[40:43], v[224:227], v[40:43]
    v_exp_f32 v210, v210
    v_mfma_f32_16x16x32_bf16 v[44:47], a[40:43], v[228:231], v[44:47]
    v_exp_f32 v211, v211
    v_mfma_f32_16x16x32_bf16 v[216:219], a[44:47], v[160:163], v[216:219]
    ds_read_b64_tr_b16 a[30:31], v2 offset:26624
    s_bfe_u32 s95, s99, 0x40000
    v_mfma_f32_16x16x32_bf16 v[220:223], a[44:47], v[164:167], v[220:223]
    ds_read_b128 a[32:35], v3 offset:1024
    v_lshl_add_u32 v6, s95, 7, v5
    v_mfma_f32_16x16x32_bf16 v[48:51], a[48:51], v[224:227], v[48:51]
    v_exp_f32 v212, v212
    v_mfma_f32_16x16x32_bf16 v[52:55], a[48:51], v[228:231], v[52:55]
    ds_read_b64_tr_b16 a[36:37], v1 offset:24832
    s_add_u32 m0, s47, 98304
    v_mfma_f32_16x16x32_bf16 v[216:219], a[52:55], v[168:171], v[216:219]
    ds_read_b64_tr_b16 a[38:39], v1 offset:26880
    buffer_load_dwordx4 v6, s[20:23], 0 offen offset:0 lds
    v_mfma_f32_16x16x32_bf16 v[220:223], a[52:55], v[172:175], v[220:223]
    ds_read_b128 a[40:43], v4 offset:1024
    s_waitcnt lgkmcnt(5)
    v_mfma_f32_16x16x32_bf16 v[56:59], a[56:59], v[224:227], v[56:59]
    v_exp_f32 v213, v213
    v_mfma_f32_16x16x32_bf16 v[60:63], a[56:59], v[228:231], v[60:63]
    ds_read_b64_tr_b16 a[44:45], v2 offset:24832
    v_cvt_pk_bf16_f32 v232, v208, v209
    v_mfma_f32_16x16x32_bf16 v[216:219], a[0:3], v[176:179], v[216:219]
    v_exp_f32 v214, v214
    v_mfma_f32_16x16x32_bf16 v[220:223], a[0:3], v[180:183], v[220:223]
    ds_read_b64_tr_b16 a[46:47], v2 offset:26880
    buffer_load_dword v14, v13, s[40:43], s76 offen sc1
    v_mfma_f32_16x16x32_bf16 v[64:67], a[4:7], v[224:227], v[64:67]
    ds_read_b128 a[48:51], v3 offset:2048
    v_cvt_pk_bf16_f32 v233, v210, v211
    v_mfma_f32_16x16x32_bf16 v[68:71], a[4:7], v[228:231], v[68:71]
    ds_read_b64_tr_b16 a[52:53], v1 offset:28672
    ds_read_b64_tr_b16 a[54:55], v1 offset:30720
    v_mfma_f32_16x16x32_bf16 v[216:219], a[8:11], v[184:187], v[216:219]
    v_exp_f32 v215, v215
    v_mfma_f32_16x16x32_bf16 v[220:223], a[8:11], v[188:191], v[220:223]
    ds_read_b128 a[56:59], v4 offset:2048
    v_cvt_pk_bf16_f32 v236, v212, v213
    v_mfma_f32_16x16x32_bf16 v[72:75], a[12:15], v[224:227], v[72:75]
    ds_read_b64_tr_b16 a[0:1], v2 offset:28672
    v_cvt_pk_bf16_f32 v237, v214, v215
    v_mfma_f32_16x16x32_bf16 v[76:79], a[12:15], v[228:231], v[76:79]
    ds_read_b64_tr_b16 a[2:3], v2 offset:30720
    buffer_load_dwordx4 v6, s[20:23], s81 offen offset:1024 lds
    v_mfma_f32_16x16x32_bf16 v[208:211], a[16:19], v[128:131], v[240:243]
    ds_read_b128 a[4:7], v3 offset:3072
    buffer_load_dwordx4 v6, s[20:23], s82 offen offset:2048 lds
    v_mfma_f32_16x16x32_bf16 v[212:215], a[16:19], v[132:135], v[244:247]
    ds_read_b64_tr_b16 a[8:9], v1 offset:28928
    v_max3_f32 v10, v216, v217, v218
    v_mfma_f32_16x16x32_bf16 v[80:83], a[20:23], v[224:227], v[80:83]
    ds_read_b64_tr_b16 a[10:11], v1 offset:30976
    v_max3_f32 v255, v219, v220, v221
    v_mfma_f32_16x16x32_bf16 v[84:87], a[20:23], v[228:231], v[84:87]
    ds_read_b128 a[12:15], v4 offset:3072
    v_max3_f32 v10, v222, v223, v10
    v_mfma_f32_16x16x32_bf16 v[208:211], a[24:27], v[136:139], v[208:211]
    ds_read_b64_tr_b16 a[16:17], v2 offset:28928
    v_max_f32 v10, v10, v255
    v_mfma_f32_16x16x32_bf16 v[212:215], a[24:27], v[140:143], v[212:215]
    ds_read_b64_tr_b16 a[18:19], v2 offset:30976
    s_waitcnt lgkmcnt(6)
    v_mfma_f32_16x16x32_bf16 v[88:91], a[28:31], v[224:227], v[88:91]
    ds_read_b128 a[20:23], v3 offset:8192
    v_cmp_lt_f32 vcc, s98, v10
    v_mfma_f32_16x16x32_bf16 v[92:95], a[28:31], v[228:231], v[92:95]
    buffer_load_dwordx4 v6, s[20:23], s83 offen offset:3072 lds
    v_add_u32 v6, 114688, v6
    v_mfma_f32_16x16x32_bf16 v[208:211], a[32:35], v[144:147], v[208:211]
    s_cbranch_vccnz L_RARE26
L_BACK26:
    s_add_u32 m0, s47, 114688
    v_mfma_f32_16x16x32_bf16 v[212:215], a[32:35], v[148:151], v[212:215]
    v_exp_f32 v216, v216
    v_mfma_f32_16x16x32_bf16 v[96:99], a[36:39], v[224:227], v[96:99]
    v_exp_f32 v217, v217
    v_mfma_f32_16x16x32_bf16 v[100:103], a[36:39], v[228:231], v[100:103]
    v_exp_f32 v218, v218
    v_mfma_f32_16x16x32_bf16 v[208:211], a[40:43], v[152:155], v[208:211]
    v_exp_f32 v219, v219
    v_mfma_f32_16x16x32_bf16 v[212:215], a[40:43], v[156:159], v[212:215]
    v_exp_f32 v220, v220
    v_mfma_f32_16x16x32_bf16 v[104:107], a[44:47], v[224:227], v[104:107]
    v_exp_f32 v221, v221
    v_mfma_f32_16x16x32_bf16 v[108:111], a[44:47], v[228:231], v[108:111]
    ds_read_b64_tr_b16 a[24:25], v1 offset:16384
    ds_read_b64_tr_b16 a[26:27], v1 offset:18432
    v_mfma_f32_16x16x32_bf16 v[208:211], a[48:51], v[160:163], v[208:211]
    v_exp_f32 v222, v222
    v_mfma_f32_16x16x32_bf16 v[212:215], a[48:51], v[164:167], v[212:215]
    ds_read_b128 a[28:31], v4 offset:8192
    buffer_load_dwordx4 v6, s[20:23], 0 offen offset:0 lds
    v_mfma_f32_16x16x32_bf16 v[112:115], a[52:55], v[224:227], v[112:115]
    ds_read_b64_tr_b16 a[32:33], v2 offset:16384
    v_cvt_pk_bf16_f32 v234, v216, v217
    v_mfma_f32_16x16x32_bf16 v[116:119], a[52:55], v[228:231], v[116:119]
    ds_read_b64_tr_b16 a[34:35], v2 offset:18432
    v_cvt_pk_bf16_f32 v235, v218, v219
    v_mfma_f32_16x16x32_bf16 v[208:211], a[56:59], v[168:171], v[208:211]
    ds_read_b128 a[36:39], v3 offset:9216
    ds_read_b64_tr_b16 a[40:41], v1 offset:16640
    v_mfma_f32_16x16x32_bf16 v[212:215], a[56:59], v[172:175], v[212:215]
    v_exp_f32 v223, v223
    v_mfma_f32_16x16x32_bf16 v[120:123], a[0:3], v[224:227], v[120:123]
    ds_read_b64_tr_b16 a[42:43], v1 offset:18688
    v_cvt_pk_bf16_f32 v238, v220, v221
    v_mfma_f32_16x16x32_bf16 v[124:127], a[0:3], v[228:231], v[124:127]
    ds_read_b128 a[44:47], v4 offset:9216
    s_waitcnt lgkmcnt(6)
    v_mfma_f32_16x16x32_bf16 v[208:211], a[4:7], v[176:179], v[208:211]
    ds_read_b64_tr_b16 a[48:49], v2 offset:16640
    v_cvt_pk_bf16_f32 v239, v222, v223
    v_mfma_f32_16x16x32_bf16 v[212:215], a[4:7], v[180:183], v[212:215]
    ds_read_b64_tr_b16 a[50:51], v2 offset:18688
    buffer_load_dwordx4 v6, s[20:23], s81 offen offset:1024 lds
    v_mfma_f32_16x16x32_bf16 v[192:195], a[8:11], v[224:227], v[192:195]
    ds_read_b128 a[52:55], v3 offset:10240
    v_mfma_f32_16x16x32_bf16 v[196:199], a[8:11], v[228:231], v[196:199]
    ds_read_b64_tr_b16 a[56:57], v1 offset:20480
    v_mfma_f32_16x16x32_bf16 v[208:211], a[12:15], v[184:187], v[208:211]
    ds_read_b64_tr_b16 a[58:59], v1 offset:22528
    v_mfma_f32_16x16x32_bf16 v[212:215], a[12:15], v[188:191], v[212:215]
    ds_read_b128 a[0:3], v4 offset:10240
    v_mfma_f32_16x16x32_bf16 v[200:203], a[16:19], v[224:227], v[200:203]
    ds_read_b64_tr_b16 a[4:5], v2 offset:20480
    v_mfma_f32_16x16x32_bf16 v[204:207], a[16:19], v[228:231], v[204:207]
    ds_read_b64_tr_b16 a[6:7], v2 offset:22528
    buffer_load_dwordx4 v6, s[20:23], s82 offen offset:2048 lds
    v_mfma_f32_16x16x32_bf16 v[216:219], a[20:23], v[128:131], v[240:243]
    ds_read_b128 a[8:11], v3 offset:11264
    v_mfma_f32_16x16x32_bf16 v[220:223], a[20:23], v[132:135], v[244:247]
    ds_read_b64_tr_b16 a[12:13], v1 offset:20736
    v_max3_f32 v10, v208, v209, v210
    v_mfma_f32_16x16x32_bf16 a[64:67], a[60:63], v[232:235], a[64:67]
    ds_read_b64_tr_b16 a[14:15], v1 offset:22784
    s_waitcnt vmcnt(16)
    v_mfma_f32_16x16x32_bf16 a[68:71], a[60:63], v[236:239], a[68:71]
    ds_read_b128 a[16:19], v4 offset:11264
    s_barrier
    v_mfma_f32_16x16x32_bf16 v[16:19], a[24:27], v[232:235], v[16:19]
    ds_read_b64_tr_b16 a[20:21], v2 offset:20736
    v_max3_f32 v255, v211, v212, v213
    v_mfma_f32_16x16x32_bf16 v[20:23], a[24:27], v[236:239], v[20:23]
    ds_read_b64_tr_b16 a[22:23], v2 offset:22784
    v_max3_f32 v10, v214, v215, v10
    v_mfma_f32_16x16x32_bf16 v[216:219], a[28:31], v[136:139], v[216:219]
    ds_read_b128 a[24:27], v3 offset:32768
    v_max_f32 v10, v10, v255
    v_mfma_f32_16x16x32_bf16 v[220:223], a[28:31], v[140:143], v[220:223]
    v_cmp_lt_f32 vcc, s98, v10
    s_waitcnt lgkmcnt(5)
    v_mfma_f32_16x16x32_bf16 v[24:27], a[32:35], v[232:235], v[24:27]
    ds_read_b64_tr_b16 a[28:29], v1 offset:57344
    buffer_load_dwordx4 v6, s[20:23], s83 offen offset:3072 lds
    v_mfma_f32_16x16x32_bf16 v[28:31], a[32:35], v[236:239], v[28:31]
    s_cbranch_vccnz L_RARE27
L_BACK27:
    s_bfe_u32 s95, s99, 0x40004
    v_mfma_f32_16x16x32_bf16 v[216:219], a[36:39], v[144:147], v[216:219]
    v_exp_f32 v208, v208
    v_mfma_f32_16x16x32_bf16 v[220:223], a[36:39], v[148:151], v[220:223]
    v_exp_f32 v209, v209
    v_mfma_f32_16x16x32_bf16 v[32:35], a[40:43], v[232:235], v[32:35]
    v_exp_f32 v210, v210
    v_mfma_f32_16x16x32_bf16 v[36:39], a[40:43], v[236:239], v[36:39]
    ds_read_b64_tr_b16 a[30:31], v1 offset:59392
    v_lshl_add_u32 v6, s95, 7, v5
    v_mfma_f32_16x16x32_bf16 v[216:219], a[44:47], v[152:155], v[216:219]
    ds_read_b128 a[32:35], v4 offset:32768
    s_add_u32 m0, s47, 131072
    v_mfma_f32_16x16x32_bf16 v[220:223], a[44:47], v[156:159], v[220:223]
    v_exp_f32 v211, v211
    v_mfma_f32_16x16x32_bf16 v[40:43], a[48:51], v[232:235], v[40:43]
    v_exp_f32 v212, v212
    v_mfma_f32_16x16x32_bf16 v[44:47], a[48:51], v[236:239], v[44:47]
    v_exp_f32 v213, v213
    v_mfma_f32_16x16x32_bf16 v[216:219], a[52:55], v[160:163], v[216:219]
    ds_read_b64_tr_b16 a[36:37], v2 offset:57344
    buffer_load_dwordx4 v6, s[20:23], 0 offen offset:0 lds
    v_mfma_f32_16x16x32_bf16 v[220:223], a[52:55], v[164:167], v[220:223]
    ds_read_b64_tr_b16 a[38:39], v2 offset:59392
    v_cvt_pk_bf16_f32 v224, v208, v209
    v_mfma_f32_16x16x32_bf16 v[48:51], a[56:59], v[232:235], v[48:51]
    v_exp_f32 v214, v214
    v_mfma_f32_16x16x32_bf16 v[52:55], a[56:59], v[236:239], v[52:55]
    ds_read_b128 a[40:43], v3 offset:33792
    v_cvt_pk_bf16_f32 v225, v210, v211
    v_mfma_f32_16x16x32_bf16 v[216:219], a[0:3], v[168:171], v[216:219]
    ds_read_b64_tr_b16 a[44:45], v1 offset:57600
    buffer_load_dwordx4 v6, s[20:23], s81 offen offset:1024 lds
    v_mfma_f32_16x16x32_bf16 v[220:223], a[0:3], v[172:175], v[220:223]
    ds_read_b64_tr_b16 a[46:47], v1 offset:59648
    ds_read_b128 a[48:51], v4 offset:33792
    v_mfma_f32_16x16x32_bf16 v[56:59], a[4:7], v[232:235], v[56:59]
    v_exp_f32 v215, v215
    v_mfma_f32_16x16x32_bf16 v[60:63], a[4:7], v[236:239], v[60:63]
    ds_read_b64_tr_b16 a[52:53], v2 offset:57600
    v_cvt_pk_bf16_f32 v228, v212, v213
    v_mfma_f32_16x16x32_bf16 v[216:219], a[8:11], v[176:179], v[216:219]
    ds_read_b64_tr_b16 a[54:55], v2 offset:59648
    v_cvt_pk_bf16_f32 v229, v214, v215
    v_mfma_f32_16x16x32_bf16 v[220:223], a[8:11], v[180:183], v[220:223]
    ds_read_b128 a[56:59], v3 offset:34816
    s_waitcnt lgkmcnt(6)
    v_mfma_f32_16x16x32_bf16 v[64:67], a[12:15], v[232:235], v[64:67]
    ds_read_b64_tr_b16 a[0:1], v1 offset:61440
    buffer_load_dwordx4 v6, s[20:23], s82 offen offset:2048 lds
    v_mfma_f32_16x16x32_bf16 v[68:71], a[12:15], v[236:239], v[68:71]
    ds_read_b64_tr_b16 a[2:3], v1 offset:63488
    v_mfma_f32_16x16x32_bf16 v[216:219], a[16:19], v[184:187], v[216:219]
    ds_read_b128 a[4:7], v4 offset:34816
    ds_read_b64_tr_b16 a[8:9], v2 offset:61440
    v_mfma_f32_16x16x32_bf16 v[220:223], a[16:19], v[188:191], v[220:223]
    s_waitcnt vmcnt(10)
    v_cmp_gt_u32 s[26:27], 2, v14
    v_mfma_f32_16x16x32_bf16 v[72:75], a[20:23], v[232:235], v[72:75]
    ds_read_b64_tr_b16 a[10:11], v2 offset:63488
    buffer_load_dwordx4 v6, s[20:23], s83 offen offset:3072 lds
    v_mfma_f32_16x16x32_bf16 v[76:79], a[20:23], v[236:239], v[76:79]
    ds_read_b128 a[12:15], v3 offset:35840
    s_cmp_lg_u64 s[26:27], 0
    s_cbranch_scc1 L_SPIN2
L_OK2:
    v_mfma_f32_16x16x32_bf16 v[208:211], a[24:27], v[128:131], v[240:243]
    ds_read_b64_tr_b16 a[16:17], v1 offset:61696
    buffer_load_dwordx4 a[144:147], v7, s[40:43], s25 offen offset:0 sc1
    v_mfma_f32_16x16x32_bf16 v[212:215], a[24:27], v[132:135], v[244:247]
    ds_read_b64_tr_b16 a[18:19], v1 offset:63744
    buffer_load_dwordx4 a[148:151], v7, s[40:43], s25 offen offset:1024 sc1
    v_mfma_f32_16x16x32_bf16 v[80:83], a[28:31], v[232:235], v[80:83]
    ds_read_b128 a[20:23], v4 offset:35840
    buffer_load_dwordx4 a[152:155], v7, s[40:43], s25 offen offset:2048 sc1
    v_mfma_f32_16x16x32_bf16 v[84:87], a[28:31], v[236:239], v[84:87]
    ds_read_b64_tr_b16 a[24:25], v2 offset:61696
    buffer_load_dwordx4 a[156:159], v7, s[40:43], s25 offen offset:3072 sc1
    v_mfma_f32_16x16x32_bf16 v[208:211], a[32:35], v[136:139], v[208:211]
    ds_read_b64_tr_b16 a[26:27], v2 offset:63744
    s_add_u32 s25, s25, 16384
    v_mfma_f32_16x16x32_bf16 v[212:215], a[32:35], v[140:143], v[212:215]
    ds_read_b128 a[28:31], v3 offset:40960
    v_max3_f32 v10, v216, v217, v218
    v_mfma_f32_16x16x32_bf16 v[88:91], a[36:39], v[232:235], v[88:91]
    buffer_load_dwordx4 a[160:163], v7, s[40:43], s25 offen offset:0 sc1
    v_add_u32 v6, 114688, v6
    v_mfma_f32_16x16x32_bf16 v[92:95], a[36:39], v[236:239], v[92:95]
    s_add_u32 m0, s47, 147456
    v_max3_f32 v255, v219, v220, v221
    v_mfma_f32_16x16x32_bf16 v[208:211], a[40:43], v[144:147], v[208:211]
    buffer_load_dwordx4 a[164:167], v7, s[40:43], s25 offen offset:1024 sc1
    ds_read_b64_tr_b16 a[32:33], v1 offset:49152
    v_mfma_f32_16x16x32_bf16 v[212:215], a[40:43], v[148:151], v[212:215]
    buffer_load_dwordx4 v6, s[20:23], 0 offen offset:0 lds
    s_waitcnt lgkmcnt(3)
    v_mfma_f32_16x16x32_bf16 v[96:99], a[44:47], v[232:235], v[96:99]
    buffer_load_dwordx4 a[168:171], v7, s[40:43], s25 offen offset:2048 sc1
    ds_read_b64_tr_b16 a[34:35], v1 offset:51200
    v_mfma_f32_16x16x32_bf16 v[100:103], a[44:47], v[236:239], v[100:103]
    ds_read_b128 a[36:39], v4 offset:40960
    v_max3_f32 v10, v222, v223, v10
    v_mfma_f32_16x16x32_bf16 v[208:211], a[48:51], v[152:155], v[208:211]
    buffer_load_dwordx4 a[172:175], v7, s[40:43], s25 offen offset:3072 sc1
    ds_read_b64_tr_b16 a[40:41], v2 offset:49152
    v_mfma_f32_16x16x32_bf16 v[212:215], a[48:51], v[156:159], v[212:215]
    buffer_load_dwordx4 v6, s[20:23], s81 offen offset:1024 lds
    ds_read_b64_tr_b16 a[42:43], v2 offset:51200
    v_mfma_f32_16x16x32_bf16 v[104:107], a[52:55], v[232:235], v[104:107]
    ds_read_b128 a[44:47], v3 offset:41984
    v_max_f32 v10, v10, v255
    v_mfma_f32_16x16x32_bf16 v[108:111], a[52:55], v[236:239], v[108:111]
    v_accvgpr_read_b32 v14, a85
    v_cmp_lt_f32 vcc, s98, v10
    v_mfma_f32_16x16x32_bf16 v[208:211], a[56:59], v[160:163], v[208:211]
    ds_read_b64_tr_b16 a[48:49], v1 offset:49408
    s_lshl_b32 s92, s71, 6
    v_mfma_f32_16x16x32_bf16 v[212:215], a[56:59], v[164:167], v[212:215]
    s_cbranch_vccnz L_RARE28
L_BACK28:
    s_add_u32 s25, s92, 14336
    v_mfma_f32_16x16x32_bf16 v[112:115], a[0:3], v[232:235], v[112:115]
    buffer_load_dwordx4 v6, s[20:23], s82 offen offset:2048 lds
    ds_read_b64_tr_b16 a[50:51], v1 offset:51456
    v_mfma_f32_16x16x32_bf16 v[116:119], a[0:3], v[236:239], v[116:119]
    v_exp_f32 v216, v216
    v_mfma_f32_16x16x32_bf16 v[208:211], a[4:7], v[168:171], v[208:211]
    v_exp_f32 v217, v217
    v_mfma_f32_16x16x32_bf16 v[212:215], a[4:7], v[172:175], v[212:215]
    buffer_load_dwordx4 a[176:179], v14, s[4:7], s92 offen
    ds_read_b128 a[52:55], v4 offset:41984
    v_mfma_f32_16x16x32_bf16 v[120:123], a[8:11], v[232:235], v[120:123]
    v_exp_f32 v218, v218
    v_mfma_f32_16x16x32_bf16 v[124:127], a[8:11], v[236:239], v[124:127]
    buffer_load_dwordx4 v6, s[20:23], s83 offen offset:3072 lds
    ds_read_b64_tr_b16 a[56:57], v2 offset:49408
    v_mfma_f32_16x16x32_bf16 v[208:211], a[12:15], v[176:179], v[208:211]
    v_exp_f32 v219, v219
    v_mfma_f32_16x16x32_bf16 v[212:215], a[12:15], v[180:183], v[212:215]
    buffer_load_dwordx4 a[180:183], v14, s[4:7], s25 offen
    ds_read_b64_tr_b16 a[58:59], v2 offset:51456
    v_mfma_f32_16x16x32_bf16 v[192:195], a[16:19], v[232:235], v[192:195]
    v_exp_f32 v220, v220
    v_mfma_f32_16x16x32_bf16 v[196:199], a[16:19], v[236:239], v[196:199]
    v_exp_f32 v221, v221
    v_mfma_f32_16x16x32_bf16 v[208:211], a[20:23], v[184:187], v[208:211]
    ds_read_b128 a[0:3], v3 offset:43008
    v_cvt_pk_bf16_f32 v226, v216, v217
    v_mfma_f32_16x16x32_bf16 v[212:215], a[20:23], v[188:191], v[212:215]
    ds_read_b64_tr_b16 a[4:5], v1 offset:53248
    s_waitcnt lgkmcnt(3)
    v_mfma_f32_16x16x32_bf16 v[200:203], a[24:27], v[232:235], v[200:203]
    v_exp_f32 v222, v222
    v_mfma_f32_16x16x32_bf16 v[204:207], a[24:27], v[236:239], v[204:207]
    v_cvt_pk_bf16_f32 v227, v218, v219
    v_cvt_pk_bf16_f32 v230, v220, v221
    v_exp_f32 v223, v223
    s_nop 0
    v_cvt_pk_bf16_f32 v231, v222, v223
    v_mfma_f32_16x16x32_bf16 v[216:219], a[28:31], v[128:131], v[240:243]
    ds_read_b64_tr_b16 a[6:7], v1 offset:55296
    s_bfe_u32 s95, s99, 0x40008
    v_mfma_f32_16x16x32_bf16 v[220:223], a[28:31], v[132:135], v[244:247]
    ds_read_b128 a[8:11], v4 offset:43008
    v_max3_f32 v10, v208, v209, v210
    v_mfma_f32_16x16x32_bf16 a[64:67], a[60:63], v[224:227], a[64:67]
    ds_read_b64_tr_b16 a[12:13], v2 offset:53248
    v_max3_f32 v255, v211, v212, v213
    v_mfma_f32_16x16x32_bf16 a[68:71], a[60:63], v[228:231], a[68:71]
    ds_read_b64_tr_b16 a[14:15], v2 offset:55296
    v_max3_f32 v10, v214, v215, v10
    v_mfma_f32_16x16x32_bf16 v[16:19], a[32:35], v[224:227], v[16:19]
    ds_read_b128 a[16:19], v3 offset:44032
    v_max_f32 v10, v10, v255
    v_mfma_f32_16x16x32_bf16 v[20:23], a[32:35], v[228:231], v[20:23]
    ds_read_b64_tr_b16 a[20:21], v1 offset:53504
    v_cmp_lt_f32 vcc, s98, v10
    v_mfma_f32_16x16x32_bf16 v[216:219], a[36:39], v[136:139], v[216:219]
    ds_read_b64_tr_b16 a[22:23], v1 offset:55552
    v_add_u32 v1, 65536, v1
    v_mfma_f32_16x16x32_bf16 v[220:223], a[36:39], v[140:143], v[220:223]
    s_cbranch_vccnz L_RARE29
L_BACK29:
    v_mfma_f32_16x16x32_bf16 v[24:27], a[40:43], v[224:227], v[24:27]
    s_barrier
    ds_read_b128 a[24:27], v4 offset:44032
    v_mfma_f32_16x16x32_bf16 v[28:31], a[40:43], v[228:231], v[28:31]
    v_exp_f32 v208, v208
    v_mfma_f32_16x16x32_bf16 v[216:219], a[44:47], v[144:147], v[216:219]
    v_exp_f32 v209, v209
    v_mfma_f32_16x16x32_bf16 v[220:223], a[44:47], v[148:151], v[220:223]
    v_exp_f32 v210, v210
    v_mfma_f32_16x16x32_bf16 v[32:35], a[48:51], v[224:227], v[32:35]
    v_exp_f32 v211, v211
    v_mfma_f32_16x16x32_bf16 v[36:39], a[48:51], v[228:231], v[36:39]
    v_exp_f32 v212, v212
    v_mfma_f32_16x16x32_bf16 v[216:219], a[52:55], v[152:155], v[216:219]
    ds_read_b64_tr_b16 a[28:29], v2 offset:53504
    ds_read_b64_tr_b16 a[30:31], v2 offset:55552
    v_mfma_f32_16x16x32_bf16 v[220:223], a[52:55], v[156:159], v[220:223]
    ds_read_b64_tr_b16 a[32:33], v1 offset:8192
    s_waitcnt lgkmcnt(3)
    v_mfma_f32_16x16x32_bf16 v[40:43], a[56:59], v[224:227], v[40:43]
    ds_read_b64_tr_b16 a[34:35], v1 offset:10240
    v_add_u32 v2, 65536, v2
    v_mfma_f32_16x16x32_bf16 v[44:47], a[56:59], v[228:231], v[44:47]
    v_exp_f32 v213, v213
    v_mfma_f32_16x16x32_bf16 v[216:219], a[0:3], v[160:163], v[216:219]
    ds_read_b64_tr_b16 a[36:37], v2 offset:8192
    ds_read_b64_tr_b16 a[38:39], v2 offset:10240
    v_mfma_f32_16x16x32_bf16 v[220:223], a[0:3], v[164:167], v[220:223]
    v_lshl_add_u32 v6, s95, 7, v5
    v_cvt_pk_bf16_f32 v232, v208, v209
    v_mfma_f32_16x16x32_bf16 v[48:51], a[4:7], v[224:227], v[48:51]
    ds_read_b64_tr_b16 a[40:41], v1 offset:8448
    s_add_u32 m0, s47, 0
    ds_read_b64_tr_b16 a[42:43], v1 offset:10496
    v_mfma_f32_16x16x32_bf16 v[52:55], a[4:7], v[228:231], v[52:55]
    v_exp_f32 v214, v214
    v_mfma_f32_16x16x32_bf16 v[216:219], a[8:11], v[168:171], v[216:219]
    ds_read_b64_tr_b16 a[44:45], v2 offset:8448
    buffer_load_dwordx4 v6, s[20:23], 0 offen offset:0 lds
    ds_read_b64_tr_b16 a[46:47], v2 offset:10496
    v_mfma_f32_16x16x32_bf16 v[220:223], a[8:11], v[172:175], v[220:223]
    v_exp_f32 v215, v215
    v_mfma_f32_16x16x32_bf16 v[56:59], a[12:15], v[224:227], v[56:59]
    ds_read_b64_tr_b16 a[48:49], v1 offset:12288
    ds_read_b64_tr_b16 a[50:51], v1 offset:14336
    v_mfma_f32_16x16x32_bf16 v[60:63], a[12:15], v[228:231], v[60:63]
    v_cvt_pk_bf16_f32 v233, v210, v211
    v_cvt_pk_bf16_f32 v236, v212, v213
    v_mfma_f32_16x16x32_bf16 v[216:219], a[16:19], v[176:179], v[216:219]
    ds_read_b64_tr_b16 a[52:53], v2 offset:12288
    buffer_load_dwordx4 v6, s[20:23], s81 offen offset:1024 lds
    ds_read_b64_tr_b16 a[54:55], v2 offset:14336
    v_mfma_f32_16x16x32_bf16 v[220:223], a[16:19], v[180:183], v[220:223]
    ds_read_b64_tr_b16 a[56:57], v1 offset:12544
    v_cvt_pk_bf16_f32 v237, v214, v215
    v_mfma_f32_16x16x32_bf16 v[64:67], a[20:23], v[224:227], v[64:67]
    ds_read_b64_tr_b16 a[58:59], v1 offset:14592
    buffer_load_dwordx4 v6, s[20:23], s82 offen offset:2048 lds
    v_mfma_f32_16x16x32_bf16 v[68:71], a[20:23], v[228:231], v[68:71]
    ds_read_b64_tr_b16 a[0:1], v2 offset:12544
    buffer_load_dwordx4 v6, s[20:23], s83 offen offset:3072 lds
    v_mfma_f32_16x16x32_bf16 v[216:219], a[24:27], v[184:187], v[216:219]
    ds_read_b64_tr_b16 a[2:3], v2 offset:14592
    v_add_u32 v6, 114688, v6
    v_mfma_f32_16x16x32_bf16 v[220:223], a[24:27], v[188:191], v[220:223]
    ds_read_b64_tr_b16 a[4:5], v1 offset:0
    s_waitcnt lgkmcnt(7)
    v_mfma_f32_16x16x32_bf16 v[72:75], a[28:31], v[224:227], v[72:75]
    ds_read_b64_tr_b16 a[6:7], v1 offset:2048
    s_add_u32 m0, s47, 16384
    v_mfma_f32_16x16x32_bf16 v[76:79], a[28:31], v[228:231], v[76:79]
    ds_read_b64_tr_b16 a[8:9], v2 offset:0
    buffer_load_dwordx4 v6, s[20:23], 0 offen offset:0 lds
    v_mfma_f32_16x16x32_bf16 v[80:83], a[32:35], v[224:227], v[80:83]
    ds_read_b64_tr_b16 a[10:11], v2 offset:2048
    buffer_load_dwordx4 v6, s[20:23], s81 offen offset:1024 lds
    v_mfma_f32_16x16x32_bf16 v[84:87], a[32:35], v[228:231], v[84:87]
    ds_read_b64_tr_b16 a[12:13], v1 offset:256
    v_max3_f32 v10, v216, v217, v218
    v_mfma_f32_16x16x32_bf16 v[88:91], a[36:39], v[224:227], v[88:91]
    ds_read_b64_tr_b16 a[14:15], v1 offset:2304
    v_max3_f32 v255, v219, v220, v221
    v_mfma_f32_16x16x32_bf16 v[92:95], a[36:39], v[228:231], v[92:95]
    s_barrier
    ds_read_b64_tr_b16 a[16:17], v2 offset:256
    v_mfma_f32_16x16x32_bf16 v[96:99], a[40:43], v[224:227], v[96:99]
    ds_read_b64_tr_b16 a[18:19], v2 offset:2304
    v_max3_f32 v10, v222, v223, v10
    v_mfma_f32_16x16x32_bf16 v[100:103], a[40:43], v[228:231], v[100:103]
L_PAD10:
    s_cbranch_execz L_PADBACK
    ds_read_b64_tr_b16 a[20:21], v1 offset:4096
    v_max_f32 v10, v10, v255
    v_mfma_f32_16x16x32_bf16 v[104:107], a[44:47], v[224:227], v[104:107]
    ds_read_b64_tr_b16 a[22:23], v1 offset:6144
    v_cmp_lt_f32 vcc, s98, v10
    v_mfma_f32_16x16x32_bf16 v[108:111], a[44:47], v[228:231], v[108:111]
    ds_read_b64_tr_b16 a[24:25], v2 offset:4096
    buffer_load_dwordx4 v6, s[20:23], s82 offen offset:2048 lds
    v_mfma_f32_16x16x32_bf16 v[112:115], a[48:51], v[224:227], v[112:115]
    s_cbranch_vccnz L_RARE30
L_BACK30:
    v_mfma_f32_16x16x32_bf16 v[116:119], a[48:51], v[228:231], v[116:119]
    ds_read_b64_tr_b16 a[26:27], v2 offset:6144
    s_waitcnt lgkmcnt(5)
    v_mfma_f32_16x16x32_bf16 v[120:123], a[52:55], v[224:227], v[120:123]
    v_exp_f32 v216, v216
    v_mfma_f32_16x16x32_bf16 v[124:127], a[52:55], v[228:231], v[124:127]
    v_exp_f32 v217, v217
    v_mfma_f32_16x16x32_bf16 v[192:195], a[56:59], v[224:227], v[192:195]
    ds_read_b64_tr_b16 a[28:29], v1 offset:4352
    ds_read_b64_tr_b16 a[30:31], v1 offset:6400
    v_mfma_f32_16x16x32_bf16 v[196:199], a[56:59], v[228:231], v[196:199]
    buffer_load_dwordx4 v6, s[20:23], s83 offen offset:3072 lds
    s_bfe_u32 s95, s99, 0x4000c
    v_mfma_f32_16x16x32_bf16 v[200:203], a[0:3], v[224:227], v[200:203]
    ds_read_b64_tr_b16 a[32:33], v2 offset:4352
    ds_read_b64_tr_b16 a[34:35], v2 offset:6400
    v_exp_f32 v218, v218
    v_exp_f32 v219, v219
    v_exp_f32 v220, v220
    v_exp_f32 v221, v221
    v_cvt_pk_bf16_f32 v234, v216, v217
    v_exp_f32 v222, v222
    v_cvt_pk_bf16_f32 v235, v218, v219
    v_cvt_pk_bf16_f32 v238, v220, v221
    v_exp_f32 v223, v223
    v_lshl_add_u32 v6, s95, 7, v5
    v_cvt_pk_bf16_f32 v239, v222, v223
    v_mfma_f32_16x16x32_bf16 v[204:207], a[0:3], v[228:231], v[204:207]
    s_add_u32 m0, s47, 32768
    ds_read_b64_tr_b16 a[36:37], v1 offset:24576
    v_mfma_f32_16x16x32_bf16 a[64:67], a[60:63], v[232:235], a[64:67]
    ds_read_b64_tr_b16 a[38:39], v1 offset:26624
    buffer_load_dwordx4 v6, s[20:23], 0 offen offset:0 lds
    v_mfma_f32_16x16x32_bf16 a[68:71], a[60:63], v[236:239], a[68:71]
    ds_read_b64_tr_b16 a[40:41], v2 offset:24576
    buffer_load_dwordx4 v6, s[20:23], s81 offen offset:1024 lds
    v_mfma_f32_16x16x32_bf16 v[16:19], a[4:7], v[232:235], v[16:19]
    ds_read_b64_tr_b16 a[42:43], v2 offset:26624
    s_waitcnt vmcnt(28)
    v_mfma_f32_16x16x32_bf16 v[20:23], a[4:7], v[236:239], v[20:23]
    ds_read_b64_tr_b16 a[44:45], v1 offset:24832
    s_barrier
    v_mfma_f32_16x16x32_bf16 v[24:27], a[8:11], v[232:235], v[24:27]
    ds_read_b64_tr_b16 a[46:47], v1 offset:26880
    buffer_load_dwordx4 v6, s[20:23], s82 offen offset:2048 lds
    v_mfma_f32_16x16x32_bf16 v[28:31], a[8:11], v[236:239], v[28:31]
    ds_read_b64_tr_b16 a[48:49], v2 offset:24832
    v_accvgpr_read_b32 v10, a64
    v_mfma_f32_16x16x32_bf16 v[32:35], a[12:15], v[232:235], v[32:35]
    ds_read_b64_tr_b16 a[50:51], v2 offset:26880
    v_accvgpr_read_b32 v0, a68
    v_mfma_f32_16x16x32_bf16 v[36:39], a[12:15], v[236:239], v[36:39]
    ds_read_b64_tr_b16 a[52:53], v1 offset:28672
    s_waitcnt lgkmcnt(6)
    v_mfma_f32_16x16x32_bf16 v[40:43], a[16:19], v[232:235], v[40:43]
    ds_read_b64_tr_b16 a[54:55], v1 offset:30720
    ds_read_b64_tr_b16 a[56:57], v2 offset:28672
    v_mfma_f32_16x16x32_bf16 v[44:47], a[16:19], v[236:239], v[44:47]
    v_rcp_f32 v10, v10
    v_mfma_f32_16x16x32_bf16 v[48:51], a[20:23], v[232:235], v[48:51]
    ds_read_b64_tr_b16 a[58:59], v2 offset:30720
    ds_read_b64_tr_b16 a[0:1], v1 offset:28928
    v_mfma_f32_16x16x32_bf16 v[52:55], a[20:23], v[236:239], v[52:55]
    v_rcp_f32 v0, v0
    v_mfma_f32_16x16x32_bf16 v[56:59], a[24:27], v[232:235], v[56:59]
    ds_read_b64_tr_b16 a[2:3], v1 offset:30976
    v_cvt_pk_bf16_f32 v128, v16, v17
    v_mfma_f32_16x16x32_bf16 v[60:63], a[24:27], v[236:239], v[60:63]
    buffer_load_dwordx4 v6, s[20:23], s83 offen offset:3072 lds
    ds_read_b64_tr_b16 a[4:5], v2 offset:28928
    v_add_u32 v6, 114688, v6
    v_mfma_f32_16x16x32_bf16 v[64:67], a[28:31], v[232:235], v[64:67]
    s_add_u32 m0, s47, 49152
    ds_read_b64_tr_b16 a[6:7], v2 offset:30976
    v_mfma_f32_16x16x32_bf16 v[68:71], a[28:31], v[236:239], v[68:71]
    ds_read_b64_tr_b16 a[8:9], v1 offset:32768
    v_cvt_pk_bf16_f32 v129, v18, v19
    v_mfma_f32_16x16x32_bf16 v[72:75], a[32:35], v[232:235], v[72:75]
    buffer_load_dwordx4 v6, s[20:23], 0 offen offset:0 lds
    ds_read_b64_tr_b16 a[10:11], v1 offset:34816
    v_mfma_f32_16x16x32_bf16 v[76:79], a[32:35], v[236:239], v[76:79]
    ds_read_b64_tr_b16 a[12:13], v2 offset:32768
    v_cvt_pk_bf16_f32 v130, v24, v25
    v_mfma_f32_16x16x32_bf16 v[80:83], a[36:39], v[232:235], v[80:83]
    ds_read_b64_tr_b16 a[14:15], v2 offset:34816
    v_cvt_pk_bf16_f32 v131, v26, v27
    v_mfma_f32_16x16x32_bf16 v[84:87], a[36:39], v[236:239], v[84:87]
    ds_read_b64_tr_b16 a[16:17], v1 offset:33024
    s_waitcnt lgkmcnt(6)
    v_mfma_f32_16x16x32_bf16 v[88:91], a[40:43], v[232:235], v[88:91]
    buffer_load_dwordx4 v6, s[20:23], s81 offen offset:1024 lds
    ds_read_b64_tr_b16 a[18:19], v1 offset:35072
    v_mfma_f32_16x16x32_bf16 v[92:95], a[40:43], v[236:239], v[92:95]
    ds_read_b64_tr_b16 a[20:21], v2 offset:33024
    v_cvt_pk_bf16_f32 v132, v20, v21
    v_mfma_f32_16x16x32_bf16 v[96:99], a[44:47], v[232:235], v[96:99]
    ds_read_b64_tr_b16 a[22:23], v2 offset:35072
    v_cvt_pk_bf16_f32 v133, v22, v23
    v_mfma_f32_16x16x32_bf16 v[100:103], a[44:47], v[236:239], v[100:103]
    ds_read_b64_tr_b16 a[24:25], v1 offset:36864
    v_cvt_pk_bf16_f32 v134, v28, v29
    v_mfma_f32_16x16x32_bf16 v[104:107], a[48:51], v[232:235], v[104:107]
    buffer_load_dwordx4 v6, s[20:23], s82 offen offset:2048 lds
    ds_read_b64_tr_b16 a[26:27], v1 offset:38912
    v_mfma_f32_16x16x32_bf16 v[108:111], a[48:51], v[236:239], v[108:111]
    ds_read_b64_tr_b16 a[28:29], v2 offset:36864
    v_cvt_pk_bf16_f32 v135, v30, v31
    v_mfma_f32_16x16x32_bf16 v[112:115], a[52:55], v[232:235], v[112:115]
    ds_read_b64_tr_b16 a[30:31], v2 offset:38912
    v_cvt_pk_bf16_f32 v136, v32, v33
    v_mfma_f32_16x16x32_bf16 v[116:119], a[52:55], v[236:239], v[116:119]
    ds_read_b64_tr_b16 a[32:33], v1 offset:37120
    v_cvt_pk_bf16_f32 v137, v34, v35
    v_mfma_f32_16x16x32_bf16 v[120:123], a[56:59], v[232:235], v[120:123]
    buffer_load_dwordx4 v6, s[20:23], s83 offen offset:3072 lds
    ds_read_b64_tr_b16 a[34:35], v1 offset:39168
    v_mfma_f32_16x16x32_bf16 v[124:127], a[56:59], v[236:239], v[124:127]
    ds_read_b64_tr_b16 a[36:37], v2 offset:37120
    v_cvt_pk_bf16_f32 v138, v40, v41
    v_mfma_f32_16x16x32_bf16 v[192:195], a[0:3], v[232:235], v[192:195]
    ds_read_b64_tr_b16 a[38:39], v2 offset:39168
    v_cvt_pk_bf16_f32 v139, v42, v43
    v_mfma_f32_16x16x32_bf16 v[196:199], a[0:3], v[236:239], v[196:199]
    ds_read_b64_tr_b16 a[40:41], v1 offset:40960
    s_waitcnt lgkmcnt(6)
    v_mfma_f32_16x16x32_bf16 v[200:203], a[4:7], v[232:235], v[200:203]
    ds_read_b64_tr_b16 a[42:43], v1 offset:43008
    v_cvt_pk_bf16_f32 v140, v36, v37
    v_mfma_f32_16x16x32_bf16 v[204:207], a[4:7], v[236:239], v[204:207]
    ds_read_b64_tr_b16 a[44:45], v2 offset:40960
    v_cvt_pk_bf16_f32 v141, v38, v39
    v_mfma_f32_16x16x32_bf16 v[208:211], a[8:11], v[128:131], 0
    ds_read_b64_tr_b16 a[46:47], v2 offset:43008
    v_cvt_pk_bf16_f32 v142, v44, v45
    v_mfma_f32_16x16x32_bf16 v[212:215], a[8:11], v[132:135], 0
    ds_read_b64_tr_b16 a[48:49], v1 offset:41216
    v_cvt_pk_bf16_f32 v143, v46, v47
    v_mfma_f32_16x16x32_bf16 v[216:219], a[12:15], v[128:131], 0
    ds_read_b64_tr_b16 a[50:51], v1 offset:43264
    v_cvt_pk_bf16_f32 v144, v48, v49
    v_mfma_f32_16x16x32_bf16 v[220:223], a[12:15], v[132:135], 0
    s_barrier
    ds_read_b64_tr_b16 a[52:53], v2 offset:41216
    v_mfma_f32_16x16x32_bf16 v[224:227], a[16:19], v[128:131], 0
    ds_read_b64_tr_b16 a[54:55], v2 offset:43264
    v_cvt_pk_bf16_f32 v145, v50, v51
    v_mfma_f32_16x16x32_bf16 v[228:231], a[16:19], v[132:135], 0
    ds_read_b64_tr_b16 a[56:57], v1 offset:45056
    v_cvt_pk_bf16_f32 v146, v56, v57
    v_mfma_f32_16x16x32_bf16 v[232:235], a[20:23], v[128:131], 0
    s_bfe_u32 s95, s99, 0x40010
    ds_read_b64_tr_b16 a[58:59], v1 offset:47104
    v_mfma_f32_16x16x32_bf16 v[236:239], a[20:23], v[132:135], 0
    ds_read_b64_tr_b16 a[0:1], v1 offset:49152
    v_lshl_add_u32 v6, s95, 7, v5
    v_mfma_f32_16x16x32_bf16 v[208:211], a[24:27], v[136:139], v[208:211]
    s_add_u32 m0, s47, 65536
    ds_read_b64_tr_b16 a[2:3], v1 offset:51200
    v_mfma_f32_16x16x32_bf16 v[212:215], a[24:27], v[140:143], v[212:215]
    ds_read_b64_tr_b16 a[4:5], v1 offset:53248
    s_waitcnt lgkmcnt(6)
    v_mfma_f32_16x16x32_bf16 v[216:219], a[28:31], v[136:139], v[216:219]
    buffer_load_dwordx4 v6, s[20:23], 0 offen offset:0 lds
    ds_read_b64_tr_b16 a[6:7], v1 offset:55296
    v_mfma_f32_16x16x32_bf16 v[220:223], a[28:31], v[140:143], v[220:223]
    ds_read_b64_tr_b16 a[8:9], v1 offset:57344
    v_cvt_pk_bf16_f32 v147, v58, v59
    v_mfma_f32_16x16x32_bf16 v[224:227], a[32:35], v[136:139], v[224:227]
    ds_read_b64_tr_b16 a[10:11], v1 offset:59392
    v_cvt_pk_bf16_f32 v148, v52, v53
    v_mfma_f32_16x16x32_bf16 v[228:231], a[32:35], v[140:143], v[228:231]
    ds_read_b64_tr_b16 a[12:13], v1 offset:61440
    v_cvt_pk_bf16_f32 v149, v54, v55
    v_mfma_f32_16x16x32_bf16 v[232:235], a[36:39], v[136:139], v[232:235]
    ds_read_b64_tr_b16 a[14:15], v1 offset:63488
    v_cvt_pk_bf16_f32 v150, v60, v61
    v_mfma_f32_16x16x32_bf16 v[236:239], a[36:39], v[140:143], v[236:239]
    buffer_load_dwordx4 v6, s[20:23], s81 offen offset:1024 lds
    ds_read_b64_tr_b16 a[16:17], v2 offset:45056
    v_cvt_pk_bf16_f32 v151, v62, v63
    v_mfma_f32_16x16x32_bf16 v[208:211], a[40:43], v[144:147], v[208:211]
    ds_read_b64_tr_b16 a[18:19], v2 offset:47104
    v_cvt_pk_bf16_f32 v152, v64, v65
    v_mfma_f32_16x16x32_bf16 v[212:215], a[40:43], v[148:151], v[212:215]
    ds_read_b64_tr_b16 a[20:21], v2 offset:49152
    v_cvt_pk_bf16_f32 v153, v66, v67
    v_mfma_f32_16x16x32_bf16 v[216:219], a[44:47], v[144:147], v[216:219]
    ds_read_b64_tr_b16 a[22:23], v2 offset:51200
    v_cvt_pk_bf16_f32 v154, v72, v73
    v_mfma_f32_16x16x32_bf16 v[220:223], a[44:47], v[148:151], v[220:223]
    ds_read_b64_tr_b16 a[24:25], v2 offset:53248
    v_cvt_pk_bf16_f32 v155, v74, v75
    v_mfma_f32_16x16x32_bf16 v[224:227], a[48:51], v[144:147], v[224:227]
    buffer_load_dwordx4 v6, s[20:23], s82 offen offset:2048 lds
    ds_read_b64_tr_b16 a[26:27], v2 offset:55296
    v_mfma_f32_16x16x32_bf16 v[228:231], a[48:51], v[148:151], v[228:231]
    ds_read_b64_tr_b16 a[28:29], v2 offset:57344
    s_waitcnt lgkmcnt(6)
    v_mfma_f32_16x16x32_bf16 v[232:235], a[52:55], v[144:147], v[232:235]
    ds_read_b64_tr_b16 a[30:31], v2 offset:59392
    v_cvt_pk_bf16_f32 v156, v68, v69
    v_mfma_f32_16x16x32_bf16 v[236:239], a[52:55], v[148:151], v[236:239]
    ds_read_b64_tr_b16 a[32:33], v2 offset:61440
    v_cvt_pk_bf16_f32 v157, v70, v71
    v_cvt_pk_bf16_f32 v158, v76, v77
    v_cvt_pk_bf16_f32 v159, v78, v79
    v_mfma_f32_16x16x32_bf16 v[208:211], a[56:59], v[152:155], v[208:211]
    ds_read_b64_tr_b16 a[34:35], v2 offset:63488
    v_cvt_pk_bf16_f32 v160, v80, v81
    v_cvt_pk_bf16_f32 v161, v82, v83
    v_cvt_pk_bf16_f32 v162, v88, v89
    v_cvt_pk_bf16_f32 v163, v90, v91
    v_mfma_f32_16x16x32_bf16 v[212:215], a[56:59], v[156:159], v[212:215]
    buffer_load_dwordx4 v6, s[20:23], s83 offen offset:3072 lds
    ds_read_b64_tr_b16 a[36:37], v1 offset:45312
    v_cvt_pk_bf16_f32 v164, v84, v85
    v_cvt_pk_bf16_f32 v165, v86, v87
    v_cvt_pk_bf16_f32 v166, v92, v93
    v_cvt_pk_bf16_f32 v167, v94, v95
    v_mfma_f32_16x16x32_bf16 v[208:211], a[0:3], v[160:163], v[208:211]
    ds_read_b64_tr_b16 a[38:39], v1 offset:47360
    v_cvt_pk_bf16_f32 v168, v96, v97
    v_cvt_pk_bf16_f32 v169, v98, v99
    v_cvt_pk_bf16_f32 v170, v104, v105
    v_cvt_pk_bf16_f32 v171, v106, v107
    v_add_u32 v6, 114688, v6
    v_mfma_f32_16x16x32_bf16 v[212:215], a[0:3], v[164:167], v[212:215]
    ds_read_b64_tr_b16 a[40:41], v1 offset:49408
    v_cvt_pk_bf16_f32 v172, v100, v101
    v_cvt_pk_bf16_f32 v173, v102, v103
    v_cvt_pk_bf16_f32 v174, v108, v109
    v_cvt_pk_bf16_f32 v175, v110, v111
    s_add_u32 m0, s47, 81920
    v_mfma_f32_16x16x32_bf16 v[208:211], a[4:7], v[168:171], v[208:211]
    ds_read_b64_tr_b16 a[42:43], v1 offset:51456
    v_cvt_pk_bf16_f32 v176, v112, v113
    v_cvt_pk_bf16_f32 v177, v114, v115
    v_cvt_pk_bf16_f32 v178, v120, v121
    v_cvt_pk_bf16_f32 v179, v122, v123
    v_mfma_f32_16x16x32_bf16 v[212:215], a[4:7], v[172:175], v[212:215]
    buffer_load_dwordx4 v6, s[20:23], 0 offen offset:0 lds
    ds_read_b64_tr_b16 a[44:45], v1 offset:53504
    v_cvt_pk_bf16_f32 v180, v116, v117
    v_cvt_pk_bf16_f32 v181, v118, v119
    v_cvt_pk_bf16_f32 v182, v124, v125
    v_cvt_pk_bf16_f32 v183, v126, v127
    v_mfma_f32_16x16x32_bf16 v[208:211], a[8:11], v[176:179], v[208:211]
    ds_read_b64_tr_b16 a[46:47], v1 offset:55552
    v_cvt_pk_bf16_f32 v184, v192, v193
    v_cvt_pk_bf16_f32 v185, v194, v195
    v_cvt_pk_bf16_f32 v186, v200, v201
    v_cvt_pk_bf16_f32 v187, v202, v203
    v_mfma_f32_16x16x32_bf16 v[212:215], a[8:11], v[180:183], v[212:215]
    ds_read_b64_tr_b16 a[48:49], v1 offset:57600
    v_cvt_pk_bf16_f32 v188, v196, v197
    v_cvt_pk_bf16_f32 v189, v198, v199
    v_cvt_pk_bf16_f32 v190, v204, v205
    v_cvt_pk_bf16_f32 v191, v206, v207
    v_mfma_f32_16x16x32_bf16 v[208:211], a[12:15], v[184:187], v[208:211]
    ds_read_b64_tr_b16 a[50:51], v1 offset:59648
    s_bfe_u32 s94, s99, 0x40000
    v_mfma_f32_16x16x32_bf16 v[212:215], a[12:15], v[188:191], v[212:215]
    ds_read_b64_tr_b16 a[52:53], v1 offset:61696
    s_waitcnt lgkmcnt(6)
    v_mfma_f32_16x16x32_bf16 v[216:219], a[16:19], v[152:155], v[216:219]
    buffer_load_dwordx4 v6, s[20:23], s81 offen offset:1024 lds
    ds_read_b64_tr_b16 a[54:55], v1 offset:63744
    v_mfma_f32_16x16x32_bf16 v[220:223], a[16:19], v[156:159], v[220:223]
    ds_read_b64_tr_b16 a[56:57], v2 offset:45312
    s_lshl_b32 s94, s94, 18
    v_mfma_f32_16x16x32_bf16 v[216:219], a[20:23], v[160:163], v[216:219]
    ds_read_b64_tr_b16 a[58:59], v2 offset:47360
    s_add_u32 s94, s94, s93
    v_mfma_f32_16x16x32_bf16 v[220:223], a[20:23], v[164:167], v[220:223]
    ds_read_b64_tr_b16 a[0:1], v2 offset:49408
    v_add_u32 v1, 65536, v1
    v_mfma_f32_16x16x32_bf16 v[216:219], a[24:27], v[168:171], v[216:219]
    s_waitcnt vmcnt(23)
    s_barrier
    ds_read_b64_tr_b16 a[2:3], v2 offset:51456
    v_mfma_f32_16x16x32_bf16 v[220:223], a[24:27], v[172:175], v[220:223]
    buffer_load_dwordx4 v6, s[20:23], s82 offen offset:2048 lds
    ds_read_b64_tr_b16 a[4:5], v2 offset:53504
    v_mfma_f32_16x16x32_bf16 v[216:219], a[28:31], v[176:179], v[216:219]
    ds_read_b64_tr_b16 a[6:7], v2 offset:55552
    v_mul_f32 v208, v10, v208
    v_mfma_f32_16x16x32_bf16 v[220:223], a[28:31], v[180:183], v[220:223]
    ds_read_b64_tr_b16 a[8:9], v2 offset:57600
    v_mul_f32 v209, v10, v209
    v_mfma_f32_16x16x32_bf16 v[216:219], a[32:35], v[184:187], v[216:219]
    ds_read_b64_tr_b16 a[10:11], v2 offset:59648
    v_cvt_pk_bf16_f32 v240, v208, v209
    v_mfma_f32_16x16x32_bf16 v[220:223], a[32:35], v[188:191], v[220:223]
    ds_read_b64_tr_b16 a[12:13], v2 offset:61696
    v_mul_f32 v210, v10, v210
    v_mfma_f32_16x16x32_bf16 v[224:227], a[36:39], v[152:155], v[224:227]
    buffer_load_dwordx4 v6, s[20:23], s83 offen offset:3072 lds
    ds_read_b64_tr_b16 a[14:15], v2 offset:63744
    v_mfma_f32_16x16x32_bf16 v[228:231], a[36:39], v[156:159], v[228:231]
    ds_read_b64_tr_b16 a[16:17], v1 offset:0
    s_waitcnt lgkmcnt(6)
    v_mfma_f32_16x16x32_bf16 v[224:227], a[40:43], v[160:163], v[224:227]
    ds_read_b64_tr_b16 a[18:19], v1 offset:2048
    v_mul_f32 v211, v10, v211
    v_mfma_f32_16x16x32_bf16 v[228:231], a[40:43], v[164:167], v[228:231]
    ds_read_b64_tr_b16 a[20:21], v1 offset:4096
    v_add_u32 v2, 65536, v2
    v_mfma_f32_16x16x32_bf16 v[224:227], a[44:47], v[168:171], v[224:227]
    ds_read_b64_tr_b16 a[22:23], v1 offset:6144
    v_cvt_pk_bf16_f32 v241, v210, v211
    v_mfma_f32_16x16x32_bf16 v[228:231], a[44:47], v[172:175], v[228:231]
    ds_read_b64_tr_b16 a[24:25], v1 offset:8192
    v_mul_f32 v212, v0, v212
    v_mfma_f32_16x16x32_bf16 v[224:227], a[48:51], v[176:179], v[224:227]
    ds_read_b64_tr_b16 a[26:27], v1 offset:10240
    v_mul_f32 v213, v0, v213
    v_mfma_f32_16x16x32_bf16 v[228:231], a[48:51], v[180:183], v[228:231]
    ds_read_b64_tr_b16 a[28:29], v1 offset:12288
    v_cvt_pk_bf16_f32 v244, v212, v213
    v_mfma_f32_16x16x32_bf16 v[224:227], a[52:55], v[184:187], v[224:227]
    ds_read_b64_tr_b16 a[30:31], v1 offset:14336
    v_mul_f32 v214, v0, v214
    v_mfma_f32_16x16x32_bf16 v[228:231], a[52:55], v[188:191], v[228:231]
    ds_read_b64_tr_b16 a[32:33], v1 offset:16384
    v_mul_f32 v215, v0, v215
    v_mfma_f32_16x16x32_bf16 v[232:235], a[56:59], v[152:155], v[232:235]
    ds_read_b64_tr_b16 a[34:35], v1 offset:18432
    v_cvt_pk_bf16_f32 v245, v214, v215
    v_mfma_f32_16x16x32_bf16 v[236:239], a[56:59], v[156:159], v[236:239]
    ds_read_b64_tr_b16 a[36:37], v1 offset:20480
    v_mul_f32 v216, v10, v216
    v_mfma_f32_16x16x32_bf16 v[232:235], a[0:3], v[160:163], v[232:235]
    ds_read_b64_tr_b16 a[38:39], v1 offset:22528
    v_mul_f32 v217, v10, v217
    v_mfma_f32_16x16x32_bf16 v[236:239], a[0:3], v[164:167], v[236:239]
    ds_read_b64_tr_b16 a[40:41], v1 offset:24576
    s_waitcnt lgkmcnt(6)
    v_mfma_f32_16x16x32_bf16 v[232:235], a[4:7], v[168:171], v[232:235]
    ds_read_b64_tr_b16 a[42:43], v1 offset:26624
    v_cvt_pk_bf16_f32 v242, v216, v217
    v_mfma_f32_16x16x32_bf16 v[236:239], a[4:7], v[172:175], v[236:239]
    ds_read_b64_tr_b16 a[44:45], v1 offset:28672
    v_mul_f32 v218, v10, v218
    v_mfma_f32_16x16x32_bf16 v[232:235], a[8:11], v[176:179], v[232:235]
    ds_read_b64_tr_b16 a[46:47], v1 offset:30720
    v_mul_f32 v219, v10, v219
    v_mfma_f32_16x16x32_bf16 v[236:239], a[8:11], v[180:183], v[236:239]
    ds_read_b64_tr_b16 a[48:49], v2 offset:0
    v_cvt_pk_bf16_f32 v243, v218, v219
    v_mul_f32 v220, v0, v220
    v_mul_f32 v221, v0, v221
    v_cvt_pk_bf16_f32 v246, v220, v221
    v_mul_f32 v222, v0, v222
    v_mul_f32 v223, v0, v223
    v_cvt_pk_bf16_f32 v247, v222, v223
    v_mfma_f32_16x16x32_bf16 v[232:235], a[12:15], v[184:187], v[232:235]
    buffer_store_dwordx4 v[240:243], v7, s[40:43], s94 offen offset:0 sc1
    buffer_store_dwordx4 v[244:247], v7, s[40:43], s94 offen offset:1024 sc1
    ds_read_b64_tr_b16 a[50:51], v2 offset:2048
    v_mfma_f32_16x16x32_bf16 v[236:239], a[12:15], v[188:191], v[236:239]
    ds_read_b64_tr_b16 a[52:53], v2 offset:4096
    s_add_u32 s94, s94, 131072
    v_mfma_f32_16x16x32_bf16 v[208:211], a[16:19], v[128:131], 0
    ds_read_b64_tr_b16 a[54:55], v2 offset:6144
    v_mul_f32 v224, v10, v224
    v_mfma_f32_16x16x32_bf16 v[212:215], a[16:19], v[132:135], 0
    ds_read_b64_tr_b16 a[56:57], v2 offset:8192
    v_mul_f32 v225, v10, v225
    v_mfma_f32_16x16x32_bf16 v[208:211], a[20:23], v[136:139], v[208:211]
    ds_read_b64_tr_b16 a[58:59], v2 offset:10240
    v_cvt_pk_bf16_f32 v248, v224, v225
    v_mfma_f32_16x16x32_bf16 v[212:215], a[20:23], v[140:143], v[212:215]
    s_barrier
    ds_read_b64_tr_b16 a[0:1], v2 offset:12288
    v_mfma_f32_16x16x32_bf16 v[208:211], a[24:27], v[144:147], v[208:211]
    ds_read_b64_tr_b16 a[2:3], v2 offset:14336
    v_mul_f32 v226, v10, v226
    v_mfma_f32_16x16x32_bf16 v[212:215], a[24:27], v[148:151], v[212:215]
    ds_read_b64_tr_b16 a[4:5], v2 offset:16384
    s_waitcnt lgkmcnt(6)
    v_mfma_f32_16x16x32_bf16 v[208:211], a[28:31], v[152:155], v[208:211]
    s_bfe_u32 s95, s99, 0x40014
    ds_read_b64_tr_b16 a[6:7], v2 offset:18432
    v_mfma_f32_16x16x32_bf16 v[212:215], a[28:31], v[156:159], v[212:215]
    ds_read_b64_tr_b16 a[8:9], v2 offset:20480
    v_lshl_add_u32 v6, s95, 7, v5
    v_mfma_f32_16x16x32_bf16 v[208:211], a[32:35], v[160:163], v[208:211]
    s_add_u32 m0, s47, 98304
    ds_read_b64_tr_b16 a[10:11], v2 offset:22528
    v_mfma_f32_16x16x32_bf16 v[212:215], a[32:35], v[164:167], v[212:215]
    ds_read_b64_tr_b16 a[12:13], v2 offset:24576
    v_mul_f32 v227, v10, v227
    v_mfma_f32_16x16x32_bf16 v[208:211], a[36:39], v[168:171], v[208:211]
    buffer_load_dwordx4 v6, s[20:23], 0 offen offset:0 lds
    ds_read_b64_tr_b16 a[14:15], v2 offset:26624
    v_mfma_f32_16x16x32_bf16 v[212:215], a[36:39], v[172:175], v[212:215]
    ds_read_b64_tr_b16 a[16:17], v2 offset:28672
    v_cvt_pk_bf16_f32 v249, v226, v227
    v_mfma_f32_16x16x32_bf16 v[208:211], a[40:43], v[176:179], v[208:211]
    ds_read_b64_tr_b16 a[18:19], v2 offset:30720
    v_mul_f32 v228, v0, v228
    v_mfma_f32_16x16x32_bf16 v[212:215], a[40:43], v[180:183], v[212:215]
    ds_read_b64_tr_b16 a[20:21], v1 offset:256
    v_mul_f32 v229, v0, v229
    v_mfma_f32_16x16x32_bf16 v[208:211], a[44:47], v[184:187], v[208:211]
    ds_read_b64_tr_b16 a[22:23], v1 offset:2304
    v_cvt_pk_bf16_f32 v252, v228, v229
    v_mfma_f32_16x16x32_bf16 v[212:215], a[44:47], v[188:191], v[212:215]
    buffer_load_dwordx4 v6, s[20:23], s81 offen offset:1024 lds
    ds_read_b64_tr_b16 a[24:25], v1 offset:4352
    v_mfma_f32_16x16x32_bf16 v[216:219], a[48:51], v[128:131], 0
    ds_read_b64_tr_b16 a[26:27], v1 offset:6400
    v_mul_f32 v230, v0, v230
    v_mfma_f32_16x16x32_bf16 v[220:223], a[48:51], v[132:135], 0
    ds_read_b64_tr_b16 a[28:29], v1 offset:8448
    v_mul_f32 v231, v0, v231
    v_cvt_pk_bf16_f32 v253, v230, v231
    v_mul_f32 v232, v10, v232
    v_mul_f32 v233, v10, v233
    v_cvt_pk_bf16_f32 v250, v232, v233
    v_mul_f32 v234, v10, v234
    v_mul_f32 v235, v10, v235
    v_cvt_pk_bf16_f32 v251, v234, v235
    v_mul_f32 v236, v0, v236
    v_mul_f32 v237, v0, v237
    v_cvt_pk_bf16_f32 v254, v236, v237
    v_mul_f32 v238, v0, v238
    v_mul_f32 v239, v0, v239
    v_cvt_pk_bf16_f32 v255, v238, v239
    s_waitcnt lgkmcnt(6)
    v_mfma_f32_16x16x32_bf16 v[216:219], a[52:55], v[136:139], v[216:219]
    ds_read_b64_tr_b16 a[30:31], v1 offset:10496
    buffer_store_dwordx4 v[248:251], v7, s[40:43], s94 offen offset:0 sc1
    buffer_store_dwordx4 v[252:255], v7, s[40:43], s94 offen offset:1024 sc1
    v_mfma_f32_16x16x32_bf16 v[220:223], a[52:55], v[140:143], v[220:223]
    ds_read_b64_tr_b16 a[32:33], v1 offset:12544
    buffer_load_dwordx4 v6, s[20:23], s82 offen offset:2048 lds
    v_mfma_f32_16x16x32_bf16 v[216:219], a[56:59], v[144:147], v[216:219]
    ds_read_b64_tr_b16 a[34:35], v1 offset:14592
    s_bfe_u32 s94, s99, 0x40004
    v_mfma_f32_16x16x32_bf16 v[220:223], a[56:59], v[148:151], v[220:223]
    ds_read_b64_tr_b16 a[36:37], v1 offset:16640
    s_lshl_b32 s94, s94, 18
    v_mfma_f32_16x16x32_bf16 v[216:219], a[0:3], v[152:155], v[216:219]
    ds_read_b64_tr_b16 a[38:39], v1 offset:18688
    s_add_u32 s94, s94, s93
    v_mfma_f32_16x16x32_bf16 v[220:223], a[0:3], v[156:159], v[220:223]
    ds_read_b64_tr_b16 a[40:41], v1 offset:20736
    buffer_load_dwordx4 v6, s[20:23], s83 offen offset:3072 lds
    v_mfma_f32_16x16x32_bf16 v[216:219], a[4:7], v[160:163], v[216:219]
    ds_read_b64_tr_b16 a[42:43], v1 offset:22784
    v_mul_f32 v208, v10, v208
    v_mfma_f32_16x16x32_bf16 v[220:223], a[4:7], v[164:167], v[220:223]
    ds_read_b64_tr_b16 a[44:45], v1 offset:24832
    v_add_u32 v6, 114688, v6
    v_mfma_f32_16x16x32_bf16 v[216:219], a[8:11], v[168:171], v[216:219]
    ds_read_b64_tr_b16 a[46:47], v1 offset:26880
    v_mul_f32 v209, v10, v209
    v_mfma_f32_16x16x32_bf16 v[220:223], a[8:11], v[172:175], v[220:223]
    s_add_u32 m0, s47, 114688
    ds_read_b64_tr_b16 a[48:49], v1 offset:28928
    v_mfma_f32_16x16x32_bf16 v[216:219], a[12:15], v[176:179], v[216:219]
    ds_read_b64_tr_b16 a[50:51], v1 offset:30976
    v_cvt_pk_bf16_f32 v240, v208, v209
    v_mfma_f32_16x16x32_bf16 v[220:223], a[12:15], v[180:183], v[220:223]
    buffer_load_dwordx4 v6, s[20:23], 0 offen offset:0 lds
    ds_read_b64_tr_b16 a[52:53], v2 offset:256
    s_waitcnt lgkmcnt(6)
    v_mfma_f32_16x16x32_bf16 v[216:219], a[16:19], v[184:187], v[216:219]
    ds_read_b64_tr_b16 a[54:55], v2 offset:2304
    v_subrev_u32 v1, 131072, v1
    v_mfma_f32_16x16x32_bf16 v[220:223], a[16:19], v[188:191], v[220:223]
    ds_read_b64_tr_b16 a[56:57], v2 offset:4352
    v_mul_f32 v210, v10, v210
    v_mfma_f32_16x16x32_bf16 v[224:227], a[20:23], v[128:131], 0
    ds_read_b64_tr_b16 a[58:59], v2 offset:6400
    v_mul_f32 v211, v10, v211
    v_mfma_f32_16x16x32_bf16 v[228:231], a[20:23], v[132:135], 0
    ds_read_b64_tr_b16 a[0:1], v2 offset:8448
    v_cvt_pk_bf16_f32 v241, v210, v211
    v_mfma_f32_16x16x32_bf16 v[224:227], a[24:27], v[136:139], v[224:227]
    buffer_load_dwordx4 v6, s[20:23], s81 offen offset:1024 lds
    ds_read_b64_tr_b16 a[2:3], v2 offset:10496
    v_mfma_f32_16x16x32_bf16 v[228:231], a[24:27], v[140:143], v[228:231]
    ds_read_b64_tr_b16 a[4:5], v2 offset:12544
    v_mul_f32 v212, v0, v212
    v_mfma_f32_16x16x32_bf16 v[224:227], a[28:31], v[144:147], v[224:227]
    ds_read_b64_tr_b16 a[6:7], v2 offset:14592
    v_mul_f32 v213, v0, v213
    v_mfma_f32_16x16x32_bf16 v[228:231], a[28:31], v[148:151], v[228:231]
    ds_read_b64_tr_b16 a[8:9], v2 offset:16640
    v_cvt_pk_bf16_f32 v244, v212, v213
    v_mfma_f32_16x16x32_bf16 v[224:227], a[32:35], v[152:155], v[224:227]
    s_waitcnt vmcnt(26)
    s_barrier
    ds_read_b64_tr_b16 a[10:11], v2 offset:18688
    v_mfma_f32_16x16x32_bf16 v[228:231], a[32:35], v[156:159], v[228:231]
    buffer_load_dwordx4 v6, s[20:23], s82 offen offset:2048 lds
    ds_read_b64_tr_b16 a[12:13], v2 offset:20736
    v_mfma_f32_16x16x32_bf16 v[224:227], a[36:39], v[160:163], v[224:227]
    ds_read_b64_tr_b16 a[14:15], v2 offset:22784
    v_mul_f32 v214, v0, v214
    v_mfma_f32_16x16x32_bf16 v[228:231], a[36:39], v[164:167], v[228:231]
    ds_read_b64_tr_b16 a[16:17], v2 offset:24832
    s_waitcnt lgkmcnt(6)
    v_mfma_f32_16x16x32_bf16 v[224:227], a[40:43], v[168:171], v[224:227]
    ds_read_b64_tr_b16 a[18:19], v2 offset:26880
    v_mul_f32 v215, v0, v215
    v_mfma_f32_16x16x32_bf16 v[228:231], a[40:43], v[172:175], v[228:231]
    ds_read_b64_tr_b16 a[20:21], v2 offset:28928
    v_cvt_pk_bf16_f32 v245, v214, v215
    v_mfma_f32_16x16x32_bf16 v[224:227], a[44:47], v[176:179], v[224:227]
    buffer_load_dwordx4 v6, s[20:23], s83 offen offset:3072 lds
    ds_read_b64_tr_b16 a[22:23], v2 offset:30976
    v_mfma_f32_16x16x32_bf16 v[228:231], a[44:47], v[180:183], v[228:231]
    ds_read_b64_tr_b16 a[24:25], v1 offset:0
    v_mul_f32 v216, v10, v216
    v_mfma_f32_16x16x32_bf16 v[224:227], a[48:51], v[184:187], v[224:227]
    ds_read_b64_tr_b16 a[26:27], v1 offset:2048
    v_mul_f32 v217, v10, v217
    v_mfma_f32_16x16x32_bf16 v[228:231], a[48:51], v[188:191], v[228:231]
    ds_read_b64_tr_b16 a[28:29], v1 offset:4096
    v_subrev_u32 v2, 131072, v2
    v_mfma_f32_16x16x32_bf16 v[232:235], a[52:55], v[128:131], 0
    ds_read_b64_tr_b16 a[30:31], v1 offset:6144
    v_cvt_pk_bf16_f32 v242, v216, v217
    v_mfma_f32_16x16x32_bf16 v[236:239], a[52:55], v[132:135], 0
    ds_read_b64_tr_b16 a[32:33], v1 offset:8192
    v_mul_f32 v218, v10, v218
    v_mul_f32 v219, v10, v219
    v_cvt_pk_bf16_f32 v243, v218, v219
    v_mul_f32 v220, v0, v220
    v_mul_f32 v221, v0, v221
    v_cvt_pk_bf16_f32 v246, v220, v221
    v_mul_f32 v222, v0, v222
    v_mul_f32 v223, v0, v223
    v_cvt_pk_bf16_f32 v247, v222, v223
    v_mfma_f32_16x16x32_bf16 v[232:235], a[56:59], v[136:139], v[232:235]
    ds_read_b64_tr_b16 a[34:35], v1 offset:10240
    buffer_store_dwordx4 v[240:243], v7, s[40:43], s94 offen offset:0 sc1
    buffer_store_dwordx4 v[244:247], v7, s[40:43], s94 offen offset:1024 sc1
    v_mfma_f32_16x16x32_bf16 v[236:239], a[56:59], v[140:143], v[236:239]
    ds_read_b64_tr_b16 a[36:37], v1 offset:12288
    s_add_u32 s94, s94, 131072
    v_mfma_f32_16x16x32_bf16 v[232:235], a[0:3], v[144:147], v[232:235]
L_PAD11:
    s_cbranch_execz L_PADBACK
    ds_read_b64_tr_b16 a[38:39], v1 offset:14336
    v_mul_f32 v224, v10, v224
    v_mfma_f32_16x16x32_bf16 v[236:239], a[0:3], v[148:151], v[236:239]
    ds_read_b64_tr_b16 a[40:41], v1 offset:16384
    s_waitcnt lgkmcnt(6)
    v_mfma_f32_16x16x32_bf16 v[232:235], a[4:7], v[152:155], v[232:235]
    ds_read_b64_tr_b16 a[42:43], v1 offset:18432
    v_mul_f32 v225, v10, v225
    v_mfma_f32_16x16x32_bf16 v[236:239], a[4:7], v[156:159], v[236:239]
    ds_read_b64_tr_b16 a[44:45], v1 offset:20480
    v_cvt_pk_bf16_f32 v248, v224, v225
    v_mfma_f32_16x16x32_bf16 v[232:235], a[8:11], v[160:163], v[232:235]
    ds_read_b64_tr_b16 a[46:47], v1 offset:22528
    v_mul_f32 v226, v10, v226
    v_mfma_f32_16x16x32_bf16 v[236:239], a[8:11], v[164:167], v[236:239]
    ds_read_b64_tr_b16 a[48:49], v1 offset:24576
    v_mul_f32 v227, v10, v227
    v_mfma_f32_16x16x32_bf16 v[232:235], a[12:15], v[168:171], v[232:235]
    ds_read_b64_tr_b16 a[50:51], v1 offset:26624
    v_cvt_pk_bf16_f32 v249, v226, v227
    v_mfma_f32_16x16x32_bf16 v[236:239], a[12:15], v[172:175], v[236:239]
    ds_read_b64_tr_b16 a[52:53], v1 offset:28672
    v_mul_f32 v228, v0, v228
    v_mfma_f32_16x16x32_bf16 v[232:235], a[16:19], v[176:179], v[232:235]
    ds_read_b64_tr_b16 a[54:55], v1 offset:30720
    v_mul_f32 v229, v0, v229
    v_mfma_f32_16x16x32_bf16 v[236:239], a[16:19], v[180:183], v[236:239]
    ds_read_b64_tr_b16 a[56:57], v2 offset:0
    v_cvt_pk_bf16_f32 v252, v228, v229
    v_mfma_f32_16x16x32_bf16 v[232:235], a[20:23], v[184:187], v[232:235]
    ds_read_b64_tr_b16 a[58:59], v2 offset:2048
    v_mul_f32 v230, v0, v230
    v_mfma_f32_16x16x32_bf16 v[236:239], a[20:23], v[188:191], v[236:239]
    ds_read_b64_tr_b16 a[0:1], v2 offset:4096
    s_bfe_u32 s95, s99, 0x40018
    v_mfma_f32_16x16x32_bf16 v[208:211], a[24:27], v[128:131], 0
    ds_read_b64_tr_b16 a[2:3], v2 offset:6144
    v_mul_f32 v231, v0, v231
    v_mfma_f32_16x16x32_bf16 v[212:215], a[24:27], v[132:135], 0
    ds_read_b64_tr_b16 a[4:5], v2 offset:8192
    s_waitcnt lgkmcnt(6)
    v_mfma_f32_16x16x32_bf16 v[208:211], a[28:31], v[136:139], v[208:211]
    ds_read_b64_tr_b16 a[6:7], v2 offset:10240
    s_barrier
    v_mfma_f32_16x16x32_bf16 v[212:215], a[28:31], v[140:143], v[212:215]
    ds_read_b64_tr_b16 a[8:9], v2 offset:12288
    v_lshl_add_u32 v6, s95, 7, v5
    v_mfma_f32_16x16x32_bf16 v[208:211], a[32:35], v[144:147], v[208:211]
    ds_read_b64_tr_b16 a[10:11], v2 offset:14336
    v_cvt_pk_bf16_f32 v253, v230, v231
    v_mfma_f32_16x16x32_bf16 v[212:215], a[32:35], v[148:151], v[212:215]
    s_andn2_b32 s95, 1, s71
    ds_read_b64_tr_b16 a[12:13], v2 offset:16384
    v_mfma_f32_16x16x32_bf16 v[208:211], a[36:39], v[152:155], v[208:211]
    s_lshl_b32 s95, s95, 6
    ds_read_b64_tr_b16 a[14:15], v2 offset:18432
    v_mfma_f32_16x16x32_bf16 v[212:215], a[36:39], v[156:159], v[212:215]
    ds_read_b64_tr_b16 a[16:17], v2 offset:20480
    v_xor_b32 v6, s95, v6
    v_mfma_f32_16x16x32_bf16 v[208:211], a[40:43], v[160:163], v[208:211]
    s_add_u32 m0, s47, 131072
    ds_read_b64_tr_b16 a[18:19], v2 offset:22528
    v_mfma_f32_16x16x32_bf16 v[212:215], a[40:43], v[164:167], v[212:215]
    ds_read_b64_tr_b16 a[20:21], v2 offset:24576
    v_mul_f32 v232, v10, v232
    v_mfma_f32_16x16x32_bf16 v[208:211], a[44:47], v[168:171], v[208:211]
    buffer_load_dwordx4 v6, s[20:23], 0 offen offset:0 lds
    ds_read_b64_tr_b16 a[22:23], v2 offset:26624
    v_mfma_f32_16x16x32_bf16 v[212:215], a[44:47], v[172:175], v[212:215]
    ds_read_b64_tr_b16 a[24:25], v2 offset:28672
    v_mul_f32 v233, v10, v233
    v_mfma_f32_16x16x32_bf16 v[208:211], a[48:51], v[176:179], v[208:211]
    ds_read_b64_tr_b16 a[26:27], v2 offset:30720
    v_cvt_pk_bf16_f32 v250, v232, v233
    v_mfma_f32_16x16x32_bf16 v[212:215], a[48:51], v[180:183], v[212:215]
    ds_read_b64_tr_b16 a[28:29], v1 offset:256
    s_waitcnt lgkmcnt(6)
    v_mfma_f32_16x16x32_bf16 v[208:211], a[52:55], v[184:187], v[208:211]
    ds_read_b64_tr_b16 a[30:31], v1 offset:2304
    v_mul_f32 v234, v10, v234
    v_mfma_f32_16x16x32_bf16 v[212:215], a[52:55], v[188:191], v[212:215]
    buffer_load_dwordx4 v6, s[20:23], s81 offen offset:1024 lds
    ds_read_b64_tr_b16 a[32:33], v1 offset:4352
    v_mfma_f32_16x16x32_bf16 v[216:219], a[56:59], v[128:131], 0
    ds_read_b64_tr_b16 a[34:35], v1 offset:6400
    v_mul_f32 v235, v10, v235
    v_mfma_f32_16x16x32_bf16 v[220:223], a[56:59], v[132:135], 0
    ds_read_b64_tr_b16 a[36:37], v1 offset:8448
    v_cvt_pk_bf16_f32 v251, v234, v235
    v_mul_f32 v236, v0, v236
    v_mul_f32 v237, v0, v237
    v_cvt_pk_bf16_f32 v254, v236, v237
    v_mul_f32 v238, v0, v238
    v_mul_f32 v239, v0, v239
    v_cvt_pk_bf16_f32 v255, v238, v239
    v_mfma_f32_16x16x32_bf16 v[216:219], a[0:3], v[136:139], v[216:219]
    ds_read_b64_tr_b16 a[38:39], v1 offset:10496
    buffer_store_dwordx4 v[248:251], v7, s[40:43], s94 offen offset:0 sc1
    buffer_store_dwordx4 v[252:255], v7, s[40:43], s94 offen offset:1024 sc1
    v_mfma_f32_16x16x32_bf16 v[220:223], a[0:3], v[140:143], v[220:223]
    ds_read_b64_tr_b16 a[40:41], v1 offset:12544
    buffer_load_dwordx4 v6, s[20:23], s82 offen offset:2048 lds
    v_mfma_f32_16x16x32_bf16 v[216:219], a[4:7], v[144:147], v[216:219]
    ds_read_b64_tr_b16 a[42:43], v1 offset:14592
    s_bfe_u32 s94, s99, 0x40008
    v_mfma_f32_16x16x32_bf16 v[220:223], a[4:7], v[148:151], v[220:223]
    ds_read_b64_tr_b16 a[44:45], v1 offset:16640
    s_lshl_b32 s94, s94, 18
    v_mfma_f32_16x16x32_bf16 v[216:219], a[8:11], v[152:155], v[216:219]
    ds_read_b64_tr_b16 a[46:47], v1 offset:18688
    s_add_u32 s94, s94, s93
    v_mfma_f32_16x16x32_bf16 v[220:223], a[8:11], v[156:159], v[220:223]
    ds_read_b64_tr_b16 a[48:49], v1 offset:20736
    buffer_load_dwordx4 v6, s[20:23], s83 offen offset:3072 lds
    v_mfma_f32_16x16x32_bf16 v[216:219], a[12:15], v[160:163], v[216:219]
    ds_read_b64_tr_b16 a[50:51], v1 offset:22784
    v_mul_f32 v208, v10, v208
    v_mfma_f32_16x16x32_bf16 v[220:223], a[12:15], v[164:167], v[220:223]
    ds_read_b64_tr_b16 a[52:53], v1 offset:24832
    s_waitcnt lgkmcnt(6)
    v_mfma_f32_16x16x32_bf16 v[216:219], a[16:19], v[168:171], v[216:219]
    ds_read_b64_tr_b16 a[54:55], v1 offset:26880
    v_add_u32 v6, 114688, v6
    v_mfma_f32_16x16x32_bf16 v[220:223], a[16:19], v[172:175], v[220:223]
    s_add_u32 m0, s47, 147456
    ds_read_b64_tr_b16 a[56:57], v1 offset:28928
    v_mfma_f32_16x16x32_bf16 v[216:219], a[20:23], v[176:179], v[216:219]
    ds_read_b64_tr_b16 a[58:59], v1 offset:30976
    v_mul_f32 v209, v10, v209
    v_mfma_f32_16x16x32_bf16 v[220:223], a[20:23], v[180:183], v[220:223]
    buffer_load_dwordx4 v6, s[20:23], 0 offen offset:0 lds
    ds_read_b64_tr_b16 a[0:1], v2 offset:256
    v_mfma_f32_16x16x32_bf16 v[216:219], a[24:27], v[184:187], v[216:219]
    ds_read_b64_tr_b16 a[2:3], v2 offset:2304
    v_cvt_pk_bf16_f32 v240, v208, v209
    v_mfma_f32_16x16x32_bf16 v[220:223], a[24:27], v[188:191], v[220:223]
    ds_read_b64_tr_b16 a[4:5], v2 offset:4352
    v_mul_f32 v210, v10, v210
    v_mfma_f32_16x16x32_bf16 v[224:227], a[28:31], v[128:131], 0
    ds_read_b64_tr_b16 a[6:7], v2 offset:6400
    v_mul_f32 v211, v10, v211
    v_mfma_f32_16x16x32_bf16 v[228:231], a[28:31], v[132:135], 0
    ds_read_b64_tr_b16 a[8:9], v2 offset:8448
    v_cvt_pk_bf16_f32 v241, v210, v211
    v_mfma_f32_16x16x32_bf16 v[224:227], a[32:35], v[136:139], v[224:227]
    buffer_load_dwordx4 v6, s[20:23], s81 offen offset:1024 lds
    ds_read_b64_tr_b16 a[10:11], v2 offset:10496
    v_mfma_f32_16x16x32_bf16 v[228:231], a[32:35], v[140:143], v[228:231]
    ds_read_b64_tr_b16 a[12:13], v2 offset:12544
    v_mul_f32 v212, v0, v212
    v_mfma_f32_16x16x32_bf16 v[224:227], a[36:39], v[144:147], v[224:227]
    ds_read_b64_tr_b16 a[14:15], v2 offset:14592
    v_mul_f32 v213, v0, v213
    v_mfma_f32_16x16x32_bf16 v[228:231], a[36:39], v[148:151], v[228:231]
    ds_read_b64_tr_b16 a[16:17], v2 offset:16640
    s_waitcnt lgkmcnt(6)
    v_mfma_f32_16x16x32_bf16 v[224:227], a[40:43], v[152:155], v[224:227]
    s_waitcnt vmcnt(30)
    s_barrier
    ds_read_b64_tr_b16 a[18:19], v2 offset:18688
    v_mfma_f32_16x16x32_bf16 v[228:231], a[40:43], v[156:159], v[228:231]
    buffer_load_dwordx4 v6, s[20:23], s82 offen offset:2048 lds
    ds_read_b64_tr_b16 a[20:21], v2 offset:20736
    v_mfma_f32_16x16x32_bf16 v[224:227], a[44:47], v[160:163], v[224:227]
    ds_read_b64_tr_b16 a[22:23], v2 offset:22784
    v_cvt_pk_bf16_f32 v244, v212, v213
    v_mfma_f32_16x16x32_bf16 v[228:231], a[44:47], v[164:167], v[228:231]
    ds_read_b64_tr_b16 a[24:25], v2 offset:24832
    v_mul_f32 v214, v0, v214
    v_mfma_f32_16x16x32_bf16 v[224:227], a[48:51], v[168:171], v[224:227]
    ds_read_b64_tr_b16 a[26:27], v2 offset:26880
    v_mul_f32 v215, v0, v215
    v_mfma_f32_16x16x32_bf16 v[228:231], a[48:51], v[172:175], v[228:231]
    ds_read_b64_tr_b16 a[28:29], v2 offset:28928
    v_cvt_pk_bf16_f32 v245, v214, v215
    v_mfma_f32_16x16x32_bf16 v[224:227], a[52:55], v[176:179], v[224:227]
    buffer_load_dwordx4 v6, s[20:23], s83 offen offset:3072 lds
    ds_read_b64_tr_b16 a[30:31], v2 offset:30976
    v_mfma_f32_16x16x32_bf16 v[228:231], a[52:55], v[180:183], v[228:231]
    ds_read_b64_tr_b16 a[32:33], v1 offset:32768
    v_mul_f32 v216, v10, v216
    v_mfma_f32_16x16x32_bf16 v[224:227], a[56:59], v[184:187], v[224:227]
    ds_read_b64_tr_b16 a[34:35], v1 offset:34816
    v_mul_f32 v217, v10, v217
    v_mfma_f32_16x16x32_bf16 v[228:231], a[56:59], v[188:191], v[228:231]
    ds_read_b64_tr_b16 a[36:37], v1 offset:36864
    v_cvt_pk_bf16_f32 v242, v216, v217
    v_mfma_f32_16x16x32_bf16 v[232:235], a[0:3], v[128:131], 0
    ds_read_b64_tr_b16 a[38:39], v1 offset:38912
    v_mul_f32 v218, v10, v218
    v_mfma_f32_16x16x32_bf16 v[236:239], a[0:3], v[132:135], 0
    ds_read_b64_tr_b16 a[40:41], v1 offset:40960
    v_mul_f32 v219, v10, v219
    v_cvt_pk_bf16_f32 v243, v218, v219
    v_mul_f32 v220, v0, v220
    v_mul_f32 v221, v0, v221
    v_cvt_pk_bf16_f32 v246, v220, v221
    v_mul_f32 v222, v0, v222
    v_mul_f32 v223, v0, v223
    v_cvt_pk_bf16_f32 v247, v222, v223
    s_waitcnt lgkmcnt(6)
    v_mfma_f32_16x16x32_bf16 v[232:235], a[4:7], v[136:139], v[232:235]
    ds_read_b64_tr_b16 a[42:43], v1 offset:43008
    buffer_store_dwordx4 v[240:243], v7, s[40:43], s94 offen offset:0 sc1
    buffer_store_dwordx4 v[244:247], v7, s[40:43], s94 offen offset:1024 sc1
    v_mfma_f32_16x16x32_bf16 v[236:239], a[4:7], v[140:143], v[236:239]
    ds_read_b64_tr_b16 a[44:45], v1 offset:45056
    s_add_u32 s94, s94, 131072
    v_mfma_f32_16x16x32_bf16 v[232:235], a[8:11], v[144:147], v[232:235]
    ds_read_b64_tr_b16 a[46:47], v1 offset:47104
    v_mul_f32 v224, v10, v224
    v_mfma_f32_16x16x32_bf16 v[236:239], a[8:11], v[148:151], v[236:239]
    ds_read_b64_tr_b16 a[48:49], v1 offset:49152
    v_mul_f32 v225, v10, v225
    v_mfma_f32_16x16x32_bf16 v[232:235], a[12:15], v[152:155], v[232:235]
    ds_read_b64_tr_b16 a[50:51], v1 offset:51200
    v_cvt_pk_bf16_f32 v248, v224, v225
    v_mfma_f32_16x16x32_bf16 v[236:239], a[12:15], v[156:159], v[236:239]
    ds_read_b64_tr_b16 a[52:53], v1 offset:53248
    v_mul_f32 v226, v10, v226
    v_mfma_f32_16x16x32_bf16 v[232:235], a[16:19], v[160:163], v[232:235]
    ds_read_b64_tr_b16 a[54:55], v1 offset:55296
    v_mul_f32 v227, v10, v227
    v_mfma_f32_16x16x32_bf16 v[236:239], a[16:19], v[164:167], v[236:239]
    ds_read_b64_tr_b16 a[56:57], v1 offset:57344
    v_cvt_pk_bf16_f32 v249, v226, v227
    v_mfma_f32_16x16x32_bf16 v[232:235], a[20:23], v[168:171], v[232:235]
    ds_read_b64_tr_b16 a[58:59], v1 offset:59392
    v_mul_f32 v228, v0, v228
    v_mfma_f32_16x16x32_bf16 v[236:239], a[20:23], v[172:175], v[236:239]
    ds_read_b64_tr_b16 a[0:1], v1 offset:61440
    v_mul_f32 v229, v0, v229
    v_mfma_f32_16x16x32_bf16 v[232:235], a[24:27], v[176:179], v[232:235]
    ds_read_b64_tr_b16 a[2:3], v1 offset:63488
    v_cvt_pk_bf16_f32 v252, v228, v229
    v_mfma_f32_16x16x32_bf16 v[236:239], a[24:27], v[180:183], v[236:239]
    ds_read_b64_tr_b16 a[4:5], v2 offset:32768
    s_waitcnt lgkmcnt(6)
    v_mfma_f32_16x16x32_bf16 v[232:235], a[28:31], v[184:187], v[232:235]
    ds_read_b64_tr_b16 a[6:7], v2 offset:34816
    v_mul_f32 v230, v0, v230
    v_mfma_f32_16x16x32_bf16 v[236:239], a[28:31], v[188:191], v[236:239]
    ds_read_b64_tr_b16 a[8:9], v2 offset:36864
    v_mul_f32 v231, v0, v231
    v_mfma_f32_16x16x32_bf16 v[208:211], a[32:35], v[128:131], 0
    ds_read_b64_tr_b16 a[10:11], v2 offset:38912
    v_cvt_pk_bf16_f32 v253, v230, v231
    v_mfma_f32_16x16x32_bf16 v[212:215], a[32:35], v[132:135], 0
    ds_read_b64_tr_b16 a[12:13], v2 offset:40960
    v_mfma_f32_16x16x32_bf16 v[208:211], a[36:39], v[136:139], v[208:211]
    ds_read_b64_tr_b16 a[14:15], v2 offset:43008
    v_mfma_f32_16x16x32_bf16 v[212:215], a[36:39], v[140:143], v[212:215]
    ds_read_b64_tr_b16 a[16:17], v2 offset:45056
    v_mul_f32 v232, v10, v232
    v_mfma_f32_16x16x32_bf16 v[208:211], a[40:43], v[144:147], v[208:211]
    ds_read_b64_tr_b16 a[18:19], v2 offset:47104
    v_mul_f32 v233, v10, v233
    v_mfma_f32_16x16x32_bf16 v[212:215], a[40:43], v[148:151], v[212:215]
    ds_read_b64_tr_b16 a[20:21], v2 offset:49152
    v_cvt_pk_bf16_f32 v250, v232, v233
    v_mfma_f32_16x16x32_bf16 v[208:211], a[44:47], v[152:155], v[208:211]
    ds_read_b64_tr_b16 a[22:23], v2 offset:51200
    v_mul_f32 v234, v10, v234
    v_mfma_f32_16x16x32_bf16 v[212:215], a[44:47], v[156:159], v[212:215]
    ds_read_b64_tr_b16 a[24:25], v2 offset:53248
    v_mul_f32 v235, v10, v235
    v_mfma_f32_16x16x32_bf16 v[208:211], a[48:51], v[160:163], v[208:211]
    ds_read_b64_tr_b16 a[26:27], v2 offset:55296
    v_cvt_pk_bf16_f32 v251, v234, v235
    v_mfma_f32_16x16x32_bf16 v[212:215], a[48:51], v[164:167], v[212:215]
    buffer_store_dwordx4 v[248:251], v7, s[40:43], s94 offen offset:0 sc1
    ds_read_b64_tr_b16 a[28:29], v2 offset:57344
    s_waitcnt lgkmcnt(6)
    v_mfma_f32_16x16x32_bf16 v[208:211], a[52:55], v[168:171], v[208:211]
    ds_read_b64_tr_b16 a[30:31], v2 offset:59392
    v_mul_f32 v236, v0, v236
    v_mfma_f32_16x16x32_bf16 v[212:215], a[52:55], v[172:175], v[212:215]
    ds_read_b64_tr_b16 a[32:33], v2 offset:61440
    v_mul_f32 v237, v0, v237
    v_mfma_f32_16x16x32_bf16 v[208:211], a[56:59], v[176:179], v[208:211]
    ds_read_b64_tr_b16 a[34:35], v2 offset:63488
    v_cvt_pk_bf16_f32 v254, v236, v237
    v_mfma_f32_16x16x32_bf16 v[212:215], a[56:59], v[180:183], v[212:215]
    ds_read_b64_tr_b16 a[36:37], v1 offset:33024
    v_mul_f32 v238, v0, v238
    v_mfma_f32_16x16x32_bf16 v[208:211], a[0:3], v[184:187], v[208:211]
    ds_read_b64_tr_b16 a[38:39], v1 offset:35072
    v_mul_f32 v239, v0, v239
    v_mfma_f32_16x16x32_bf16 v[212:215], a[0:3], v[188:191], v[212:215]
    ds_read_b64_tr_b16 a[40:41], v1 offset:37120
    v_cvt_pk_bf16_f32 v255, v238, v239
    v_mfma_f32_16x16x32_bf16 v[216:219], a[4:7], v[128:131], 0
    ds_read_b64_tr_b16 a[42:43], v1 offset:39168
    buffer_store_dwordx4 v[252:255], v7, s[40:43], s94 offen offset:1024 sc1
    v_mfma_f32_16x16x32_bf16 v[220:223], a[4:7], v[132:135], 0
    ds_read_b64_tr_b16 a[44:45], v1 offset:41216
    s_bfe_u32 s94, s99, 0x4000c
    v_mfma_f32_16x16x32_bf16 v[216:219], a[8:11], v[136:139], v[216:219]
    ds_read_b64_tr_b16 a[46:47], v1 offset:43264
    s_lshl_b32 s94, s94, 18
    v_mfma_f32_16x16x32_bf16 v[220:223], a[8:11], v[140:143], v[220:223]
    ds_read_b64_tr_b16 a[48:49], v1 offset:45312
    s_add_u32 s94, s94, s93
    v_mfma_f32_16x16x32_bf16 v[216:219], a[12:15], v[144:147], v[216:219]
    ds_read_b64_tr_b16 a[50:51], v1 offset:47360
    v_mul_f32 v208, v10, v208
    v_mfma_f32_16x16x32_bf16 v[220:223], a[12:15], v[148:151], v[220:223]
    ds_read_b64_tr_b16 a[52:53], v1 offset:49408
    s_waitcnt lgkmcnt(6)
    v_mfma_f32_16x16x32_bf16 v[216:219], a[16:19], v[152:155], v[216:219]
    ds_read_b64_tr_b16 a[54:55], v1 offset:51456
    v_mul_f32 v209, v10, v209
    v_mfma_f32_16x16x32_bf16 v[220:223], a[16:19], v[156:159], v[220:223]
    ds_read_b64_tr_b16 a[56:57], v1 offset:53504
    v_cvt_pk_bf16_f32 v240, v208, v209
    v_mfma_f32_16x16x32_bf16 v[216:219], a[20:23], v[160:163], v[216:219]
    ds_read_b64_tr_b16 a[58:59], v1 offset:55552
    v_mul_f32 v210, v10, v210
    v_mfma_f32_16x16x32_bf16 v[220:223], a[20:23], v[164:167], v[220:223]
    ds_read_b64_tr_b16 a[0:1], v1 offset:57600
    v_mul_f32 v211, v10, v211
    v_mfma_f32_16x16x32_bf16 v[216:219], a[24:27], v[168:171], v[216:219]
    ds_read_b64_tr_b16 a[2:3], v1 offset:59648
    v_cvt_pk_bf16_f32 v241, v210, v211
    v_mfma_f32_16x16x32_bf16 v[220:223], a[24:27], v[172:175], v[220:223]
    ds_read_b64_tr_b16 a[4:5], v1 offset:61696
    v_mul_f32 v212, v0, v212
    v_mfma_f32_16x16x32_bf16 v[216:219], a[28:31], v[176:179], v[216:219]
    ds_read_b64_tr_b16 a[6:7], v1 offset:63744
    v_add_u32 v1, 65536, v1
    v_mfma_f32_16x16x32_bf16 v[220:223], a[28:31], v[180:183], v[220:223]
    ds_read_b64_tr_b16 a[8:9], v2 offset:33024
    v_mul_f32 v213, v0, v213
    v_mfma_f32_16x16x32_bf16 v[216:219], a[32:35], v[184:187], v[216:219]
    ds_read_b64_tr_b16 a[10:11], v2 offset:35072
    v_cvt_pk_bf16_f32 v244, v212, v213
    v_mfma_f32_16x16x32_bf16 v[220:223], a[32:35], v[188:191], v[220:223]
    ds_read_b64_tr_b16 a[12:13], v2 offset:37120
    v_mul_f32 v214, v0, v214
    v_mfma_f32_16x16x32_bf16 v[224:227], a[36:39], v[128:131], 0
    ds_read_b64_tr_b16 a[14:15], v2 offset:39168
    v_mul_f32 v215, v0, v215
    v_mfma_f32_16x16x32_bf16 v[228:231], a[36:39], v[132:135], 0
    ds_read_b64_tr_b16 a[16:17], v2 offset:41216
    s_waitcnt lgkmcnt(6)
    v_mfma_f32_16x16x32_bf16 v[224:227], a[40:43], v[136:139], v[224:227]
    ds_read_b64_tr_b16 a[18:19], v2 offset:43264
    s_waitcnt vmcnt(28)
    v_mfma_f32_16x16x32_bf16 v[228:231], a[40:43], v[140:143], v[228:231]
    ds_read_b64_tr_b16 a[20:21], v2 offset:45312
    v_cvt_pk_bf16_f32 v245, v214, v215
    v_mfma_f32_16x16x32_bf16 v[224:227], a[44:47], v[144:147], v[224:227]
    ds_read_b64_tr_b16 a[22:23], v2 offset:47360
    s_barrier
    v_mfma_f32_16x16x32_bf16 v[228:231], a[44:47], v[148:151], v[228:231]
    ds_read_b64_tr_b16 a[24:25], v2 offset:49408
    v_mul_f32 v216, v10, v216
    v_mfma_f32_16x16x32_bf16 v[224:227], a[48:51], v[152:155], v[224:227]
    ds_read_b64_tr_b16 a[26:27], v2 offset:51456
    v_mul_f32 v217, v10, v217
    v_mfma_f32_16x16x32_bf16 v[228:231], a[48:51], v[156:159], v[228:231]
    ds_read_b64_tr_b16 a[28:29], v2 offset:53504
    v_cvt_pk_bf16_f32 v242, v216, v217
    v_mfma_f32_16x16x32_bf16 v[224:227], a[52:55], v[160:163], v[224:227]
    ds_read_b64_tr_b16 a[30:31], v2 offset:55552
    v_mul_f32 v218, v10, v218
    v_mfma_f32_16x16x32_bf16 v[228:231], a[52:55], v[164:167], v[228:231]
    ds_read_b64_tr_b16 a[32:33], v2 offset:57600
    v_mul_f32 v219, v10, v219
    v_mfma_f32_16x16x32_bf16 v[224:227], a[56:59], v[168:171], v[224:227]
    ds_read_b64_tr_b16 a[34:35], v2 offset:59648
    v_cvt_pk_bf16_f32 v243, v218, v219
    v_mfma_f32_16x16x32_bf16 v[228:231], a[56:59], v[172:175], v[228:231]
    buffer_store_dwordx4 v[240:243], v7, s[40:43], s94 offen offset:0 sc1
    ds_read_b64_tr_b16 a[36:37], v2 offset:61696
    v_mfma_f32_16x16x32_bf16 v[224:227], a[0:3], v[176:179], v[224:227]
    ds_read_b64_tr_b16 a[38:39], v2 offset:63744
    v_mul_f32 v220, v0, v220
    v_mfma_f32_16x16x32_bf16 v[228:231], a[0:3], v[180:183], v[228:231]
    ds_read_b64_tr_b16 a[40:41], v1 offset:0
    s_waitcnt lgkmcnt(6)
    v_mfma_f32_16x16x32_bf16 v[224:227], a[4:7], v[184:187], v[224:227]
    ds_read_b64_tr_b16 a[42:43], v1 offset:2048
    v_add_u32 v2, 65536, v2
    v_mfma_f32_16x16x32_bf16 v[228:231], a[4:7], v[188:191], v[228:231]
    ds_read_b64_tr_b16 a[44:45], v1 offset:4096
    v_mul_f32 v221, v0, v221
    v_mfma_f32_16x16x32_bf16 v[232:235], a[8:11], v[128:131], 0
    ds_read_b64_tr_b16 a[46:47], v1 offset:6144
    v_cvt_pk_bf16_f32 v246, v220, v221
    v_mfma_f32_16x16x32_bf16 v[236:239], a[8:11], v[132:135], 0
    ds_read_b64_tr_b16 a[48:49], v1 offset:8192
    v_mul_f32 v222, v0, v222
    v_mul_f32 v223, v0, v223
    v_cvt_pk_bf16_f32 v247, v222, v223
    v_mfma_f32_16x16x32_bf16 v[232:235], a[12:15], v[136:139], v[232:235]
    ds_read_b64_tr_b16 a[50:51], v1 offset:10240
    buffer_store_dwordx4 v[244:247], v7, s[40:43], s94 offen offset:1024 sc1
    v_mfma_f32_16x16x32_bf16 v[236:239], a[12:15], v[140:143], v[236:239]
    ds_read_b64_tr_b16 a[52:53], v1 offset:12288
    s_add_u32 s94, s94, 131072
    v_mfma_f32_16x16x32_bf16 v[232:235], a[16:19], v[144:147], v[232:235]
    ds_read_b64_tr_b16 a[54:55], v1 offset:14336
    v_mul_f32 v224, v10, v224
    v_mfma_f32_16x16x32_bf16 v[236:239], a[16:19], v[148:151], v[236:239]
    ds_read_b64_tr_b16 a[56:57], v1 offset:16384
    v_mul_f32 v225, v10, v225
    v_mfma_f32_16x16x32_bf16 v[232:235], a[20:23], v[152:155], v[232:235]
    ds_read_b64_tr_b16 a[58:59], v1 offset:18432
    v_cvt_pk_bf16_f32 v248, v224, v225
    v_mfma_f32_16x16x32_bf16 v[236:239], a[20:23], v[156:159], v[236:239]
    ds_read_b64_tr_b16 a[0:1], v1 offset:20480
    v_mul_f32 v226, v10, v226
    v_mfma_f32_16x16x32_bf16 v[232:235], a[24:27], v[160:163], v[232:235]
    ds_read_b64_tr_b16 a[2:3], v1 offset:22528
    v_mul_f32 v227, v10, v227
    v_mfma_f32_16x16x32_bf16 v[236:239], a[24:27], v[164:167], v[236:239]
    ds_read_b64_tr_b16 a[4:5], v1 offset:24576
    s_waitcnt lgkmcnt(6)
    v_mfma_f32_16x16x32_bf16 v[232:235], a[28:31], v[168:171], v[232:235]
    ds_read_b64_tr_b16 a[6:7], v1 offset:26624
    v_cvt_pk_bf16_f32 v249, v226, v227
    v_mfma_f32_16x16x32_bf16 v[236:239], a[28:31], v[172:175], v[236:239]
    ds_read_b64_tr_b16 a[8:9], v1 offset:28672
    v_mul_f32 v228, v0, v228
    v_mfma_f32_16x16x32_bf16 v[232:235], a[32:35], v[176:179], v[232:235]
    ds_read_b64_tr_b16 a[10:11], v1 offset:30720
    v_mul_f32 v229, v0, v229
    v_mfma_f32_16x16x32_bf16 v[236:239], a[32:35], v[180:183], v[236:239]
    ds_read_b64_tr_b16 a[12:13], v2 offset:0
    v_cvt_pk_bf16_f32 v252, v228, v229
    v_mfma_f32_16x16x32_bf16 v[232:235], a[36:39], v[184:187], v[232:235]
    ds_read_b64_tr_b16 a[14:15], v2 offset:2048
    v_mul_f32 v230, v0, v230
    v_mfma_f32_16x16x32_bf16 v[236:239], a[36:39], v[188:191], v[236:239]
    ds_read_b64_tr_b16 a[16:17], v2 offset:4096
    v_mul_f32 v231, v0, v231
    v_mfma_f32_16x16x32_bf16 v[208:211], a[40:43], v[128:131], 0
    ds_read_b64_tr_b16 a[18:19], v2 offset:6144
    v_cvt_pk_bf16_f32 v253, v230, v231
    v_mfma_f32_16x16x32_bf16 v[212:215], a[40:43], v[132:135], 0
    ds_read_b64_tr_b16 a[20:21], v2 offset:8192
    v_lshrrev_b32 v4, 8, v13
    v_mfma_f32_16x16x32_bf16 v[208:211], a[44:47], v[136:139], v[208:211]
    ds_read_b64_tr_b16 a[22:23], v2 offset:10240
    v_cmp_eq_u32 s[74:75], 7, v4
    v_mfma_f32_16x16x32_bf16 v[212:215], a[44:47], v[140:143], v[212:215]
    ds_read_b64_tr_b16 a[24:25], v2 offset:12288
    v_mul_f32 v232, v10, v232
    v_mfma_f32_16x16x32_bf16 v[208:211], a[48:51], v[144:147], v[208:211]
    ds_read_b64_tr_b16 a[26:27], v2 offset:14336
    v_mul_f32 v233, v10, v233
    v_mfma_f32_16x16x32_bf16 v[212:215], a[48:51], v[148:151], v[212:215]
    ds_read_b64_tr_b16 a[28:29], v2 offset:16384
    s_waitcnt lgkmcnt(6)
    v_mfma_f32_16x16x32_bf16 v[208:211], a[52:55], v[152:155], v[208:211]
    ds_read_b64_tr_b16 a[30:31], v2 offset:18432
    v_cvt_pk_bf16_f32 v250, v232, v233
    v_mfma_f32_16x16x32_bf16 v[212:215], a[52:55], v[156:159], v[212:215]
    ds_read_b64_tr_b16 a[32:33], v2 offset:20480
    v_mul_f32 v234, v10, v234
    v_mfma_f32_16x16x32_bf16 v[208:211], a[56:59], v[160:163], v[208:211]
    ds_read_b64_tr_b16 a[34:35], v2 offset:22528
    v_mul_f32 v235, v10, v235
    v_mfma_f32_16x16x32_bf16 v[212:215], a[56:59], v[164:167], v[212:215]
    ds_read_b64_tr_b16 a[36:37], v2 offset:24576
    v_cvt_pk_bf16_f32 v251, v234, v235
    v_mfma_f32_16x16x32_bf16 v[208:211], a[0:3], v[168:171], v[208:211]
    ds_read_b64_tr_b16 a[38:39], v2 offset:26624
    buffer_store_dwordx4 v[248:251], v7, s[40:43], s94 offen offset:0 sc1
    v_mfma_f32_16x16x32_bf16 v[212:215], a[0:3], v[172:175], v[212:215]
    ds_read_b64_tr_b16 a[40:41], v2 offset:28672
    v_mul_f32 v236, v0, v236
    v_mfma_f32_16x16x32_bf16 v[208:211], a[4:7], v[176:179], v[208:211]
    ds_read_b64_tr_b16 a[42:43], v2 offset:30720
    v_mul_f32 v237, v0, v237
    v_mfma_f32_16x16x32_bf16 v[212:215], a[4:7], v[180:183], v[212:215]
    ds_read_b64_tr_b16 a[44:45], v1 offset:256
    v_cvt_pk_bf16_f32 v254, v236, v237
    v_mfma_f32_16x16x32_bf16 v[208:211], a[8:11], v[184:187], v[208:211]
    ds_read_b64_tr_b16 a[46:47], v1 offset:2304
    v_mul_f32 v238, v0, v238
    v_mfma_f32_16x16x32_bf16 v[212:215], a[8:11], v[188:191], v[212:215]
    ds_read_b64_tr_b16 a[48:49], v1 offset:4352
    v_mul_f32 v239, v0, v239
    v_mfma_f32_16x16x32_bf16 v[216:219], a[12:15], v[128:131], 0
    ds_read_b64_tr_b16 a[50:51], v1 offset:6400
    v_cvt_pk_bf16_f32 v255, v238, v239
    v_mfma_f32_16x16x32_bf16 v[220:223], a[12:15], v[132:135], 0
    buffer_store_dwordx4 v[252:255], v7, s[40:43], s94 offen offset:1024 sc1
    ds_read_b64_tr_b16 a[52:53], v1 offset:8448
    s_waitcnt lgkmcnt(6)
    v_mfma_f32_16x16x32_bf16 v[216:219], a[16:19], v[136:139], v[216:219]
    ds_read_b64_tr_b16 a[54:55], v1 offset:10496
    s_bfe_u32 s94, s99, 0x40010
    v_mfma_f32_16x16x32_bf16 v[220:223], a[16:19], v[140:143], v[220:223]
    ds_read_b64_tr_b16 a[56:57], v1 offset:12544
    s_lshl_b32 s94, s94, 18
    v_mfma_f32_16x16x32_bf16 v[216:219], a[20:23], v[144:147], v[216:219]
    ds_read_b64_tr_b16 a[58:59], v1 offset:14592
    s_add_u32 s94, s94, s93
    v_mfma_f32_16x16x32_bf16 v[220:223], a[20:23], v[148:151], v[220:223]
    ds_read_b64_tr_b16 a[0:1], v1 offset:16640
    v_mul_f32 v208, v10, v208
    v_mfma_f32_16x16x32_bf16 v[216:219], a[24:27], v[152:155], v[216:219]
    ds_read_b64_tr_b16 a[2:3], v1 offset:18688
    s_waitcnt vmcnt(4)
    v_mfma_f32_16x16x32_bf16 v[220:223], a[24:27], v[156:159], v[220:223]
    ds_read_b64_tr_b16 a[4:5], v1 offset:20736
    v_mov_b32 v9, 5
    v_mfma_f32_16x16x32_bf16 v[216:219], a[28:31], v[160:163], v[216:219]
    ds_read_b64_tr_b16 a[6:7], v1 offset:22784
    buffer_store_dword v9, v8, s[40:43], 0 offen sc1
    v_mfma_f32_16x16x32_bf16 v[220:223], a[28:31], v[164:167], v[220:223]
    ds_read_b64_tr_b16 a[8:9], v1 offset:24832
    v_mul_f32 v209, v10, v209
    v_mfma_f32_16x16x32_bf16 v[216:219], a[32:35], v[168:171], v[216:219]
    ds_read_b64_tr_b16 a[10:11], v1 offset:26880
    v_cvt_pk_bf16_f32 v240, v208, v209
    v_mfma_f32_16x16x32_bf16 v[220:223], a[32:35], v[172:175], v[220:223]
    ds_read_b64_tr_b16 a[12:13], v1 offset:28928
    v_mul_f32 v210, v10, v210
    v_mfma_f32_16x16x32_bf16 v[216:219], a[36:39], v[176:179], v[216:219]
    ds_read_b64_tr_b16 a[14:15], v1 offset:30976
    v_mul_f32 v211, v10, v211
    v_mfma_f32_16x16x32_bf16 v[220:223], a[36:39], v[180:183], v[220:223]
    ds_read_b64_tr_b16 a[16:17], v2 offset:256
    s_waitcnt lgkmcnt(6)
    v_mfma_f32_16x16x32_bf16 v[216:219], a[40:43], v[184:187], v[216:219]
    ds_read_b64_tr_b16 a[18:19], v2 offset:2304
    v_cvt_pk_bf16_f32 v241, v210, v211
    v_mfma_f32_16x16x32_bf16 v[220:223], a[40:43], v[188:191], v[220:223]
    ds_read_b64_tr_b16 a[20:21], v2 offset:4352
    v_mul_f32 v212, v0, v212
    v_mfma_f32_16x16x32_bf16 v[224:227], a[44:47], v[128:131], 0
    ds_read_b64_tr_b16 a[22:23], v2 offset:6400
    v_mul_f32 v213, v0, v213
    v_mfma_f32_16x16x32_bf16 v[228:231], a[44:47], v[132:135], 0
    ds_read_b64_tr_b16 a[24:25], v2 offset:8448
    v_cvt_pk_bf16_f32 v244, v212, v213
    v_mfma_f32_16x16x32_bf16 v[224:227], a[48:51], v[136:139], v[224:227]
    ds_read_b64_tr_b16 a[26:27], v2 offset:10496
    v_mul_f32 v214, v0, v214
    v_mfma_f32_16x16x32_bf16 v[228:231], a[48:51], v[140:143], v[228:231]
    ds_read_b64_tr_b16 a[28:29], v2 offset:12544
    v_mul_f32 v215, v0, v215
    v_mfma_f32_16x16x32_bf16 v[224:227], a[52:55], v[144:147], v[224:227]
    ds_read_b64_tr_b16 a[30:31], v2 offset:14592
    v_mfma_f32_16x16x32_bf16 v[228:231], a[52:55], v[148:151], v[228:231]
    ds_read_b64_tr_b16 a[32:33], v2 offset:16640
    v_cvt_pk_bf16_f32 v245, v214, v215
    v_mfma_f32_16x16x32_bf16 v[224:227], a[56:59], v[152:155], v[224:227]
    s_barrier
    ds_read_b64_tr_b16 a[34:35], v2 offset:18688
    v_mfma_f32_16x16x32_bf16 v[228:231], a[56:59], v[156:159], v[228:231]
    ds_read_b64_tr_b16 a[36:37], v2 offset:20736
    v_mul_f32 v216, v10, v216
    v_mfma_f32_16x16x32_bf16 v[224:227], a[0:3], v[160:163], v[224:227]
    ds_read_b64_tr_b16 a[38:39], v2 offset:22784
    v_mul_f32 v217, v10, v217
    v_mfma_f32_16x16x32_bf16 v[228:231], a[0:3], v[164:167], v[228:231]
    ds_read_b64_tr_b16 a[40:41], v2 offset:24832
    s_waitcnt lgkmcnt(6)
    v_mfma_f32_16x16x32_bf16 v[224:227], a[4:7], v[168:171], v[224:227]
    ds_read_b64_tr_b16 a[42:43], v2 offset:26880
    v_cvt_pk_bf16_f32 v242, v216, v217
    v_mfma_f32_16x16x32_bf16 v[228:231], a[4:7], v[172:175], v[228:231]
    ds_read_b64_tr_b16 a[44:45], v2 offset:28928
    v_mul_f32 v218, v10, v218
    v_mfma_f32_16x16x32_bf16 v[224:227], a[8:11], v[176:179], v[224:227]
    ds_read_b64_tr_b16 a[46:47], v2 offset:30976
    v_mul_f32 v219, v10, v219
    v_mfma_f32_16x16x32_bf16 v[228:231], a[8:11], v[180:183], v[228:231]
L_PAD12:
    s_cbranch_execz L_PADBACK
    ds_read_b64_tr_b16 a[48:49], v1 offset:32768
    v_cvt_pk_bf16_f32 v243, v218, v219
    v_mfma_f32_16x16x32_bf16 v[224:227], a[12:15], v[184:187], v[224:227]
    ds_read_b64_tr_b16 a[50:51], v1 offset:34816
    buffer_store_dwordx4 v[240:243], v7, s[40:43], s94 offen offset:0 sc1
    v_mfma_f32_16x16x32_bf16 v[228:231], a[12:15], v[188:191], v[228:231]
    ds_read_b64_tr_b16 a[52:53], v1 offset:36864
    v_mul_f32 v220, v0, v220
    v_mfma_f32_16x16x32_bf16 v[232:235], a[16:19], v[128:131], 0
    ds_read_b64_tr_b16 a[54:55], v1 offset:38912
    v_mul_f32 v221, v0, v221
    v_mfma_f32_16x16x32_bf16 v[236:239], a[16:19], v[132:135], 0
    ds_read_b64_tr_b16 a[56:57], v1 offset:40960
    v_cvt_pk_bf16_f32 v246, v220, v221
    v_mul_f32 v222, v0, v222
    v_mul_f32 v223, v0, v223
    v_cvt_pk_bf16_f32 v247, v222, v223
    v_mfma_f32_16x16x32_bf16 v[232:235], a[20:23], v[136:139], v[232:235]
    ds_read_b64_tr_b16 a[58:59], v1 offset:43008
    buffer_store_dwordx4 v[244:247], v7, s[40:43], s94 offen offset:1024 sc1
    v_mfma_f32_16x16x32_bf16 v[236:239], a[20:23], v[140:143], v[236:239]
    ds_read_b64_tr_b16 a[0:1], v1 offset:45056
    s_add_u32 s94, s94, 131072
    v_mfma_f32_16x16x32_bf16 v[232:235], a[24:27], v[144:147], v[232:235]
    ds_read_b64_tr_b16 a[2:3], v1 offset:47104
    v_mul_f32 v224, v10, v224
    v_mfma_f32_16x16x32_bf16 v[236:239], a[24:27], v[148:151], v[236:239]
    ds_read_b64_tr_b16 a[4:5], v1 offset:49152
    s_waitcnt lgkmcnt(6)
    v_mfma_f32_16x16x32_bf16 v[232:235], a[28:31], v[152:155], v[232:235]
    ds_read_b64_tr_b16 a[6:7], v1 offset:51200
    v_mul_f32 v225, v10, v225
    v_mfma_f32_16x16x32_bf16 v[236:239], a[28:31], v[156:159], v[236:239]
    ds_read_b64_tr_b16 a[8:9], v1 offset:53248
    v_cvt_pk_bf16_f32 v248, v224, v225
    v_mfma_f32_16x16x32_bf16 v[232:235], a[32:35], v[160:163], v[232:235]
    ds_read_b64_tr_b16 a[10:11], v1 offset:55296
    v_mul_f32 v226, v10, v226
    v_mfma_f32_16x16x32_bf16 v[236:239], a[32:35], v[164:167], v[236:239]
    ds_read_b64_tr_b16 a[12:13], v1 offset:57344
    v_mul_f32 v227, v10, v227
    v_mfma_f32_16x16x32_bf16 v[232:235], a[36:39], v[168:171], v[232:235]
    ds_read_b64_tr_b16 a[14:15], v1 offset:59392
    v_cvt_pk_bf16_f32 v249, v226, v227
    v_mfma_f32_16x16x32_bf16 v[236:239], a[36:39], v[172:175], v[236:239]
    ds_read_b64_tr_b16 a[16:17], v1 offset:61440
    v_mul_f32 v228, v0, v228
    v_mfma_f32_16x16x32_bf16 v[232:235], a[40:43], v[176:179], v[232:235]
    ds_read_b64_tr_b16 a[18:19], v1 offset:63488
    v_mul_f32 v229, v0, v229
    v_mfma_f32_16x16x32_bf16 v[236:239], a[40:43], v[180:183], v[236:239]
    ds_read_b64_tr_b16 a[20:21], v2 offset:32768
    v_cvt_pk_bf16_f32 v252, v228, v229
    v_mfma_f32_16x16x32_bf16 v[232:235], a[44:47], v[184:187], v[232:235]
    ds_read_b64_tr_b16 a[22:23], v2 offset:34816
    v_mul_f32 v230, v0, v230
    v_mfma_f32_16x16x32_bf16 v[236:239], a[44:47], v[188:191], v[236:239]
    ds_read_b64_tr_b16 a[24:25], v2 offset:36864
    v_mul_f32 v231, v0, v231
    v_mfma_f32_16x16x32_bf16 v[208:211], a[48:51], v[128:131], 0
    ds_read_b64_tr_b16 a[26:27], v2 offset:38912
    v_cvt_pk_bf16_f32 v253, v230, v231
    v_mfma_f32_16x16x32_bf16 v[212:215], a[48:51], v[132:135], 0
    ds_read_b64_tr_b16 a[28:29], v2 offset:40960
    s_waitcnt lgkmcnt(6)
    v_mfma_f32_16x16x32_bf16 v[208:211], a[52:55], v[136:139], v[208:211]
    ds_read_b64_tr_b16 a[30:31], v2 offset:43008
    v_cndmask_b32 v4, v4, 0, s[74:75]
    v_mfma_f32_16x16x32_bf16 v[212:215], a[52:55], v[140:143], v[212:215]
    ds_read_b64_tr_b16 a[32:33], v2 offset:45056
    v_mul_f32 v232, v10, v232
    v_mfma_f32_16x16x32_bf16 v[208:211], a[56:59], v[144:147], v[208:211]
    ds_read_b64_tr_b16 a[34:35], v2 offset:47104
    v_mul_f32 v233, v10, v233
    v_mfma_f32_16x16x32_bf16 v[212:215], a[56:59], v[148:151], v[212:215]
    ds_read_b64_tr_b16 a[36:37], v2 offset:49152
    v_cvt_pk_bf16_f32 v250, v232, v233
    v_mfma_f32_16x16x32_bf16 v[208:211], a[0:3], v[152:155], v[208:211]
    ds_read_b64_tr_b16 a[38:39], v2 offset:51200
    v_mul_f32 v234, v10, v234
    v_mfma_f32_16x16x32_bf16 v[212:215], a[0:3], v[156:159], v[212:215]
    ds_read_b64_tr_b16 a[40:41], v2 offset:53248
    v_mul_f32 v235, v10, v235
    v_mfma_f32_16x16x32_bf16 v[208:211], a[4:7], v[160:163], v[208:211]
    ds_read_b64_tr_b16 a[42:43], v2 offset:55296
    v_cvt_pk_bf16_f32 v251, v234, v235
    v_mfma_f32_16x16x32_bf16 v[212:215], a[4:7], v[164:167], v[212:215]
    buffer_store_dwordx4 v[248:251], v7, s[40:43], s94 offen offset:0 sc1
    ds_read_b64_tr_b16 a[44:45], v2 offset:57344
    v_mfma_f32_16x16x32_bf16 v[208:211], a[8:11], v[168:171], v[208:211]
    ds_read_b64_tr_b16 a[46:47], v2 offset:59392
    v_mul_f32 v236, v0, v236
    v_mfma_f32_16x16x32_bf16 v[212:215], a[8:11], v[172:175], v[212:215]
    ds_read_b64_tr_b16 a[48:49], v2 offset:61440
    v_mul_f32 v237, v0, v237
    v_mfma_f32_16x16x32_bf16 v[208:211], a[12:15], v[176:179], v[208:211]
    ds_read_b64_tr_b16 a[50:51], v2 offset:63488
    v_cvt_pk_bf16_f32 v254, v236, v237
    v_mfma_f32_16x16x32_bf16 v[212:215], a[12:15], v[180:183], v[212:215]
    ds_read_b64_tr_b16 a[52:53], v1 offset:33024
    s_waitcnt lgkmcnt(6)
    v_mfma_f32_16x16x32_bf16 v[208:211], a[16:19], v[184:187], v[208:211]
    ds_read_b64_tr_b16 a[54:55], v1 offset:35072
    v_mul_f32 v238, v0, v238
    v_mfma_f32_16x16x32_bf16 v[212:215], a[16:19], v[188:191], v[212:215]
    ds_read_b64_tr_b16 a[56:57], v1 offset:37120
    v_mul_f32 v239, v0, v239
    v_mfma_f32_16x16x32_bf16 v[216:219], a[20:23], v[128:131], 0
    ds_read_b64_tr_b16 a[58:59], v1 offset:39168
    v_cvt_pk_bf16_f32 v255, v238, v239
    v_mfma_f32_16x16x32_bf16 v[220:223], a[20:23], v[132:135], 0
    buffer_store_dwordx4 v[252:255], v7, s[40:43], s94 offen offset:1024 sc1
    ds_read_b64_tr_b16 a[0:1], v1 offset:41216
    v_mfma_f32_16x16x32_bf16 v[216:219], a[24:27], v[136:139], v[216:219]
    ds_read_b64_tr_b16 a[2:3], v1 offset:43264
    s_bfe_u32 s94, s99, 0x40014
    v_mfma_f32_16x16x32_bf16 v[220:223], a[24:27], v[140:143], v[220:223]
    ds_read_b64_tr_b16 a[4:5], v1 offset:45312
    s_lshl_b32 s94, s94, 18
    v_mfma_f32_16x16x32_bf16 v[216:219], a[28:31], v[144:147], v[216:219]
    ds_read_b64_tr_b16 a[6:7], v1 offset:47360
    s_add_u32 s94, s94, s93
    v_mfma_f32_16x16x32_bf16 v[220:223], a[28:31], v[148:151], v[220:223]
    ds_read_b64_tr_b16 a[8:9], v1 offset:49408
    v_mul_f32 v208, v10, v208
    v_mfma_f32_16x16x32_bf16 v[216:219], a[32:35], v[152:155], v[216:219]
    ds_read_b64_tr_b16 a[10:11], v1 offset:51456
    v_mul_f32 v209, v10, v209
    v_mfma_f32_16x16x32_bf16 v[220:223], a[32:35], v[156:159], v[220:223]
    ds_read_b64_tr_b16 a[12:13], v1 offset:53504
    v_cvt_pk_bf16_f32 v240, v208, v209
    v_mfma_f32_16x16x32_bf16 v[216:219], a[36:39], v[160:163], v[216:219]
    ds_read_b64_tr_b16 a[14:15], v1 offset:55552
    v_mul_f32 v210, v10, v210
    v_mfma_f32_16x16x32_bf16 v[220:223], a[36:39], v[164:167], v[220:223]
    ds_read_b64_tr_b16 a[16:17], v1 offset:57600
    s_waitcnt lgkmcnt(6)
    v_mfma_f32_16x16x32_bf16 v[216:219], a[40:43], v[168:171], v[216:219]
    ds_read_b64_tr_b16 a[18:19], v1 offset:59648
    v_mul_f32 v211, v10, v211
    v_mfma_f32_16x16x32_bf16 v[220:223], a[40:43], v[172:175], v[220:223]
    ds_read_b64_tr_b16 a[20:21], v1 offset:61696
    v_cvt_pk_bf16_f32 v241, v210, v211
    v_mfma_f32_16x16x32_bf16 v[216:219], a[44:47], v[176:179], v[216:219]
    ds_read_b64_tr_b16 a[22:23], v1 offset:63744
    v_add_u32 v1, 65536, v1
    v_mfma_f32_16x16x32_bf16 v[220:223], a[44:47], v[180:183], v[220:223]
    ds_read_b64_tr_b16 a[24:25], v2 offset:33024
    v_mul_f32 v212, v0, v212
    v_mfma_f32_16x16x32_bf16 v[216:219], a[48:51], v[184:187], v[216:219]
    ds_read_b64_tr_b16 a[26:27], v2 offset:35072
    v_mul_f32 v213, v0, v213
    v_mfma_f32_16x16x32_bf16 v[220:223], a[48:51], v[188:191], v[220:223]
    ds_read_b64_tr_b16 a[28:29], v2 offset:37120
    v_cvt_pk_bf16_f32 v244, v212, v213
    v_mfma_f32_16x16x32_bf16 v[224:227], a[52:55], v[128:131], 0
    ds_read_b64_tr_b16 a[30:31], v2 offset:39168
    v_mul_f32 v214, v0, v214
    v_mfma_f32_16x16x32_bf16 v[228:231], a[52:55], v[132:135], 0
    ds_read_b64_tr_b16 a[32:33], v2 offset:41216
    v_mul_f32 v215, v0, v215
    v_mfma_f32_16x16x32_bf16 v[224:227], a[56:59], v[136:139], v[224:227]
    ds_read_b64_tr_b16 a[34:35], v2 offset:43264
    v_mfma_f32_16x16x32_bf16 v[228:231], a[56:59], v[140:143], v[228:231]
    ds_read_b64_tr_b16 a[36:37], v2 offset:45312
    v_cvt_pk_bf16_f32 v245, v214, v215
    v_mfma_f32_16x16x32_bf16 v[224:227], a[0:3], v[144:147], v[224:227]
    ds_read_b64_tr_b16 a[38:39], v2 offset:47360
    s_barrier
    v_mfma_f32_16x16x32_bf16 v[228:231], a[0:3], v[148:151], v[228:231]
    ds_read_b64_tr_b16 a[40:41], v2 offset:49408
    s_waitcnt lgkmcnt(6)
    v_mfma_f32_16x16x32_bf16 v[224:227], a[4:7], v[152:155], v[224:227]
    ds_read_b64_tr_b16 a[42:43], v2 offset:51456
    v_mul_f32 v216, v10, v216
    v_mfma_f32_16x16x32_bf16 v[228:231], a[4:7], v[156:159], v[228:231]
    ds_read_b64_tr_b16 a[44:45], v2 offset:53504
    v_mul_f32 v217, v10, v217
    v_mfma_f32_16x16x32_bf16 v[224:227], a[8:11], v[160:163], v[224:227]
    ds_read_b64_tr_b16 a[46:47], v2 offset:55552
    v_cvt_pk_bf16_f32 v242, v216, v217
    v_mfma_f32_16x16x32_bf16 v[228:231], a[8:11], v[164:167], v[228:231]
    ds_read_b64_tr_b16 a[48:49], v2 offset:57600
    v_mul_f32 v218, v10, v218
    v_mfma_f32_16x16x32_bf16 v[224:227], a[12:15], v[168:171], v[224:227]
    ds_read_b64_tr_b16 a[50:51], v2 offset:59648
    v_mul_f32 v219, v10, v219
    v_mfma_f32_16x16x32_bf16 v[228:231], a[12:15], v[172:175], v[228:231]
    ds_read_b64_tr_b16 a[52:53], v2 offset:61696
    v_cvt_pk_bf16_f32 v243, v218, v219
    v_mfma_f32_16x16x32_bf16 v[224:227], a[16:19], v[176:179], v[224:227]
    ds_read_b64_tr_b16 a[54:55], v2 offset:63744
    buffer_store_dwordx4 v[240:243], v7, s[40:43], s94 offen offset:0 sc1
    v_mfma_f32_16x16x32_bf16 v[228:231], a[16:19], v[180:183], v[228:231]
    ds_read_b64_tr_b16 a[56:57], v1 offset:0
    v_mul_f32 v220, v0, v220
    v_mfma_f32_16x16x32_bf16 v[224:227], a[20:23], v[184:187], v[224:227]
    ds_read_b64_tr_b16 a[58:59], v1 offset:2048
    v_add_u32 v2, 65536, v2
    v_mfma_f32_16x16x32_bf16 v[228:231], a[20:23], v[188:191], v[228:231]
    ds_read_b64_tr_b16 a[0:1], v1 offset:4096
    v_mul_f32 v221, v0, v221
    v_mfma_f32_16x16x32_bf16 v[232:235], a[24:27], v[128:131], 0
    ds_read_b64_tr_b16 a[2:3], v1 offset:6144
    v_cvt_pk_bf16_f32 v246, v220, v221
    v_mfma_f32_16x16x32_bf16 v[236:239], a[24:27], v[132:135], 0
    ds_read_b64_tr_b16 a[4:5], v1 offset:8192
    v_mul_f32 v222, v0, v222
    v_mul_f32 v223, v0, v223
    v_cvt_pk_bf16_f32 v247, v222, v223
    s_waitcnt lgkmcnt(6)
    v_mfma_f32_16x16x32_bf16 v[232:235], a[28:31], v[136:139], v[232:235]
    ds_read_b64_tr_b16 a[6:7], v1 offset:10240
    buffer_store_dwordx4 v[244:247], v7, s[40:43], s94 offen offset:1024 sc1
    v_mfma_f32_16x16x32_bf16 v[236:239], a[28:31], v[140:143], v[236:239]
    ds_read_b64_tr_b16 a[8:9], v1 offset:12288
    s_add_u32 s94, s94, 131072
    v_mfma_f32_16x16x32_bf16 v[232:235], a[32:35], v[144:147], v[232:235]
    ds_read_b64_tr_b16 a[10:11], v1 offset:14336
    v_mul_f32 v224, v10, v224
    v_mfma_f32_16x16x32_bf16 v[236:239], a[32:35], v[148:151], v[236:239]
    ds_read_b64_tr_b16 a[12:13], v1 offset:16384
    v_mul_f32 v225, v10, v225
    v_mfma_f32_16x16x32_bf16 v[232:235], a[36:39], v[152:155], v[232:235]
    ds_read_b64_tr_b16 a[14:15], v1 offset:18432
    v_cvt_pk_bf16_f32 v248, v224, v225
    v_mfma_f32_16x16x32_bf16 v[236:239], a[36:39], v[156:159], v[236:239]
    ds_read_b64_tr_b16 a[16:17], v1 offset:20480
    v_mul_f32 v226, v10, v226
    v_mfma_f32_16x16x32_bf16 v[232:235], a[40:43], v[160:163], v[232:235]
    ds_read_b64_tr_b16 a[18:19], v1 offset:22528
    v_mul_f32 v227, v10, v227
    v_mfma_f32_16x16x32_bf16 v[236:239], a[40:43], v[164:167], v[236:239]
    ds_read_b64_tr_b16 a[20:21], v1 offset:24576
    v_cvt_pk_bf16_f32 v249, v226, v227
    v_mfma_f32_16x16x32_bf16 v[232:235], a[44:47], v[168:171], v[232:235]
    ds_read_b64_tr_b16 a[22:23], v1 offset:26624
    v_mul_f32 v228, v0, v228
    v_mfma_f32_16x16x32_bf16 v[236:239], a[44:47], v[172:175], v[236:239]
    ds_read_b64_tr_b16 a[24:25], v1 offset:28672
    v_mul_f32 v229, v0, v229
    v_mfma_f32_16x16x32_bf16 v[232:235], a[48:51], v[176:179], v[232:235]
    ds_read_b64_tr_b16 a[26:27], v1 offset:30720
    v_cvt_pk_bf16_f32 v252, v228, v229
    v_mfma_f32_16x16x32_bf16 v[236:239], a[48:51], v[180:183], v[236:239]
    ds_read_b64_tr_b16 a[28:29], v2 offset:0
    s_waitcnt lgkmcnt(6)
    v_mfma_f32_16x16x32_bf16 v[232:235], a[52:55], v[184:187], v[232:235]
    ds_read_b64_tr_b16 a[30:31], v2 offset:2048
    v_mul_f32 v230, v0, v230
    v_mfma_f32_16x16x32_bf16 v[236:239], a[52:55], v[188:191], v[236:239]
    ds_read_b64_tr_b16 a[32:33], v2 offset:4096
    v_mul_f32 v231, v0, v231
    v_mfma_f32_16x16x32_bf16 v[208:211], a[56:59], v[128:131], 0
    ds_read_b64_tr_b16 a[34:35], v2 offset:6144
    v_cvt_pk_bf16_f32 v253, v230, v231
    v_mfma_f32_16x16x32_bf16 v[212:215], a[56:59], v[132:135], 0
    ds_read_b64_tr_b16 a[36:37], v2 offset:8192
    s_bfe_u32 s101, s99, 0x40018
    v_mfma_f32_16x16x32_bf16 v[208:211], a[0:3], v[136:139], v[208:211]
    ds_read_b64_tr_b16 a[38:39], v2 offset:10240
    s_add_u32 s101, s101, 6
    v_mfma_f32_16x16x32_bf16 v[212:215], a[0:3], v[140:143], v[212:215]
    ds_read_b64_tr_b16 a[40:41], v2 offset:12288
    v_mul_f32 v232, v10, v232
    v_mfma_f32_16x16x32_bf16 v[208:211], a[4:7], v[144:147], v[208:211]
    ds_read_b64_tr_b16 a[42:43], v2 offset:14336
    v_mul_f32 v233, v10, v233
    v_mfma_f32_16x16x32_bf16 v[212:215], a[4:7], v[148:151], v[212:215]
    ds_read_b64_tr_b16 a[44:45], v2 offset:16384
    v_cvt_pk_bf16_f32 v250, v232, v233
    v_mfma_f32_16x16x32_bf16 v[208:211], a[8:11], v[152:155], v[208:211]
    ds_read_b64_tr_b16 a[46:47], v2 offset:18432
    v_mul_f32 v234, v10, v234
    v_mfma_f32_16x16x32_bf16 v[212:215], a[8:11], v[156:159], v[212:215]
    ds_read_b64_tr_b16 a[48:49], v2 offset:20480
    v_mul_f32 v235, v10, v235
    v_mfma_f32_16x16x32_bf16 v[208:211], a[12:15], v[160:163], v[208:211]
    ds_read_b64_tr_b16 a[50:51], v2 offset:22528
    v_cvt_pk_bf16_f32 v251, v234, v235
    v_mfma_f32_16x16x32_bf16 v[212:215], a[12:15], v[164:167], v[212:215]
    buffer_store_dwordx4 v[248:251], v7, s[40:43], s94 offen offset:0 sc1
    ds_read_b64_tr_b16 a[52:53], v2 offset:24576
    s_waitcnt lgkmcnt(6)
    v_mfma_f32_16x16x32_bf16 v[208:211], a[16:19], v[168:171], v[208:211]
    ds_read_b64_tr_b16 a[54:55], v2 offset:26624
    v_mul_f32 v236, v0, v236
    v_mfma_f32_16x16x32_bf16 v[212:215], a[16:19], v[172:175], v[212:215]
    ds_read_b64_tr_b16 a[56:57], v2 offset:28672
    v_mul_f32 v237, v0, v237
    v_mfma_f32_16x16x32_bf16 v[208:211], a[20:23], v[176:179], v[208:211]
    ds_read_b64_tr_b16 a[58:59], v2 offset:30720
    v_cvt_pk_bf16_f32 v254, v236, v237
    v_mfma_f32_16x16x32_bf16 v[212:215], a[20:23], v[180:183], v[212:215]
    ds_read_b64_tr_b16 a[0:1], v1 offset:256
    v_mul_f32 v238, v0, v238
    v_mfma_f32_16x16x32_bf16 v[208:211], a[24:27], v[184:187], v[208:211]
    ds_read_b64_tr_b16 a[2:3], v1 offset:2304
    v_mul_f32 v239, v0, v239
    v_mfma_f32_16x16x32_bf16 v[212:215], a[24:27], v[188:191], v[212:215]
    ds_read_b64_tr_b16 a[4:5], v1 offset:4352
    v_cvt_pk_bf16_f32 v255, v238, v239
    v_mfma_f32_16x16x32_bf16 v[216:219], a[28:31], v[128:131], 0
    buffer_store_dwordx4 v[252:255], v7, s[40:43], s94 offen offset:1024 sc1
    ds_read_b64_tr_b16 a[6:7], v1 offset:6400
    v_mfma_f32_16x16x32_bf16 v[220:223], a[28:31], v[132:135], 0
    ds_read_b64_tr_b16 a[8:9], v1 offset:8448
    s_bfe_u32 s94, s99, 0x40018
    v_mfma_f32_16x16x32_bf16 v[216:219], a[32:35], v[136:139], v[216:219]
    ds_read_b64_tr_b16 a[10:11], v1 offset:10496
    s_lshl_b32 s94, s94, 18
    v_mfma_f32_16x16x32_bf16 v[220:223], a[32:35], v[140:143], v[220:223]
    ds_read_b64_tr_b16 a[12:13], v1 offset:12544
    s_add_u32 s94, s94, s93
    v_mfma_f32_16x16x32_bf16 v[216:219], a[36:39], v[144:147], v[216:219]
    ds_read_b64_tr_b16 a[14:15], v1 offset:14592
    s_andn2_b32 s69, 1, s71
    v_mfma_f32_16x16x32_bf16 v[220:223], a[36:39], v[148:151], v[220:223]
    ds_read_b64_tr_b16 a[16:17], v1 offset:16640
    s_waitcnt lgkmcnt(6)
    v_mfma_f32_16x16x32_bf16 v[216:219], a[40:43], v[152:155], v[216:219]
    ds_read_b64_tr_b16 a[18:19], v1 offset:18688
    s_lshl_b32 s69, s69, 17
    v_mfma_f32_16x16x32_bf16 v[220:223], a[40:43], v[156:159], v[220:223]
    ds_read_b64_tr_b16 a[20:21], v1 offset:20736
    s_add_u32 s94, s94, s69
    v_mfma_f32_16x16x32_bf16 v[216:219], a[44:47], v[160:163], v[216:219]
    ds_read_b64_tr_b16 a[22:23], v1 offset:22784
    v_mul_f32 v208, v10, v208
    v_mfma_f32_16x16x32_bf16 v[220:223], a[44:47], v[164:167], v[220:223]
    ds_read_b64_tr_b16 a[24:25], v1 offset:24832
    v_mul_f32 v209, v10, v209
    v_mfma_f32_16x16x32_bf16 v[216:219], a[48:51], v[168:171], v[216:219]
    ds_read_b64_tr_b16 a[26:27], v1 offset:26880
    v_cvt_pk_bf16_f32 v240, v208, v209
    v_mfma_f32_16x16x32_bf16 v[220:223], a[48:51], v[172:175], v[220:223]
    ds_read_b64_tr_b16 a[28:29], v1 offset:28928
    v_mul_f32 v210, v10, v210
    v_mfma_f32_16x16x32_bf16 v[216:219], a[52:55], v[176:179], v[216:219]
    ds_read_b64_tr_b16 a[30:31], v1 offset:30976
    v_mul_f32 v211, v10, v211
    v_mfma_f32_16x16x32_bf16 v[220:223], a[52:55], v[180:183], v[220:223]
    ds_read_b64_tr_b16 a[32:33], v2 offset:256
    v_cvt_pk_bf16_f32 v241, v210, v211
    v_mfma_f32_16x16x32_bf16 v[216:219], a[56:59], v[184:187], v[216:219]
    ds_read_b64_tr_b16 a[34:35], v2 offset:2304
    v_mul_f32 v212, v0, v212
    v_mfma_f32_16x16x32_bf16 v[220:223], a[56:59], v[188:191], v[220:223]
    ds_read_b64_tr_b16 a[36:37], v2 offset:4352
    v_mul_f32 v213, v0, v213
    v_mfma_f32_16x16x32_bf16 v[224:227], a[0:3], v[128:131], 0
    ds_read_b64_tr_b16 a[38:39], v2 offset:6400
    v_cvt_pk_bf16_f32 v244, v212, v213
    v_mfma_f32_16x16x32_bf16 v[228:231], a[0:3], v[132:135], 0
    ds_read_b64_tr_b16 a[40:41], v2 offset:8448
    s_waitcnt lgkmcnt(6)
    v_mfma_f32_16x16x32_bf16 v[224:227], a[4:7], v[136:139], v[224:227]
    ds_read_b64_tr_b16 a[42:43], v2 offset:10496
    v_mul_f32 v214, v0, v214
    v_mfma_f32_16x16x32_bf16 v[228:231], a[4:7], v[140:143], v[228:231]
    ds_read_b64_tr_b16 a[44:45], v2 offset:12544
    v_mul_f32 v215, v0, v215
    v_mfma_f32_16x16x32_bf16 v[224:227], a[8:11], v[144:147], v[224:227]
    ds_read_b64_tr_b16 a[46:47], v2 offset:14592
    v_sub_u32 v3, s101, v4
    v_mfma_f32_16x16x32_bf16 v[228:231], a[8:11], v[148:151], v[228:231]
    ds_read_b64_tr_b16 a[48:49], v2 offset:16640
    v_cvt_pk_bf16_f32 v245, v214, v215
    v_mfma_f32_16x16x32_bf16 v[224:227], a[12:15], v[152:155], v[224:227]
    ds_read_b64_tr_b16 a[50:51], v2 offset:18688
    v_subrev_u32 v4, 7, v3
    v_min_u32 v3, v3, v4
    v_max_u32 v3, 2, v3
    v_add_u32 v3, 3, v3
    s_add_u32 s101, s71, 14
    s_lshl_b32 s101, s101, 7
    v_cmp_eq_u32 s[74:75], s101, v13
    s_nop 1
    v_cndmask_b32 v3, v3, 10, s[74:75]
    v_mfma_f32_16x16x32_bf16 v[228:231], a[12:15], v[156:159], v[228:231]
    ds_read_b64_tr_b16 a[52:53], v2 offset:20736
    v_mul_f32 v216, v10, v216
    v_mfma_f32_16x16x32_bf16 v[224:227], a[16:19], v[160:163], v[224:227]
    ds_read_b64_tr_b16 a[54:55], v2 offset:22784
    v_mul_f32 v217, v10, v217
    v_mfma_f32_16x16x32_bf16 v[228:231], a[16:19], v[164:167], v[228:231]
    ds_read_b64_tr_b16 a[56:57], v2 offset:24832
    v_cvt_pk_bf16_f32 v242, v216, v217
    v_mfma_f32_16x16x32_bf16 v[224:227], a[20:23], v[168:171], v[224:227]
    ds_read_b64_tr_b16 a[58:59], v2 offset:26880
    v_mul_f32 v218, v10, v218
    v_mfma_f32_16x16x32_bf16 v[228:231], a[20:23], v[172:175], v[228:231]
    ds_read_b64_tr_b16 a[0:1], v2 offset:28928
    v_mul_f32 v219, v10, v219
    v_cvt_pk_bf16_f32 v243, v218, v219
    v_mul_f32 v220, v0, v220
    v_mul_f32 v221, v0, v221
    v_cvt_pk_bf16_f32 v246, v220, v221
    v_mul_f32 v222, v0, v222
    v_mul_f32 v223, v0, v223
    v_cvt_pk_bf16_f32 v247, v222, v223
    v_mfma_f32_16x16x32_bf16 v[224:227], a[24:27], v[176:179], v[224:227]
    ds_read_b64_tr_b16 a[2:3], v2 offset:30976
    buffer_store_dwordx4 v[240:243], v7, s[40:43], s94 offen offset:0 sc1
    buffer_store_dwordx4 v[244:247], v7, s[40:43], s94 offen offset:1024 sc1
    v_mfma_f32_16x16x32_bf16 v[228:231], a[24:27], v[180:183], v[228:231]
    s_waitcnt lgkmcnt(5)
    v_mfma_f32_16x16x32_bf16 v[224:227], a[28:31], v[184:187], v[224:227]
    v_mfma_f32_16x16x32_bf16 v[228:231], a[28:31], v[188:191], v[228:231]
    v_mfma_f32_16x16x32_bf16 v[232:235], a[32:35], v[128:131], 0
    buffer_load_dword v14, v13, s[40:43], s76 offen sc1
    v_mfma_f32_16x16x32_bf16 v[236:239], a[32:35], v[132:135], 0
    v_mfma_f32_16x16x32_bf16 v[232:235], a[36:39], v[136:139], v[232:235]
    v_mfma_f32_16x16x32_bf16 v[236:239], a[36:39], v[140:143], v[236:239]
    v_mfma_f32_16x16x32_bf16 v[232:235], a[40:43], v[144:147], v[232:235]
    v_mfma_f32_16x16x32_bf16 v[236:239], a[40:43], v[148:151], v[236:239]
    v_mfma_f32_16x16x32_bf16 v[232:235], a[44:47], v[152:155], v[232:235]
    s_waitcnt vmcnt(1)
    v_mov_b32 v9, 9
    v_mfma_f32_16x16x32_bf16 v[236:239], a[44:47], v[156:159], v[236:239]
    buffer_store_dword v9, v8, s[40:43], 0 offen sc1
    v_mfma_f32_16x16x32_bf16 v[232:235], a[48:51], v[160:163], v[232:235]
    v_mfma_f32_16x16x32_bf16 v[236:239], a[48:51], v[164:167], v[236:239]
    s_waitcnt lgkmcnt(0)
    v_mfma_f32_16x16x32_bf16 v[232:235], a[52:55], v[168:171], v[232:235]
    v_mfma_f32_16x16x32_bf16 v[236:239], a[52:55], v[172:175], v[236:239]
    v_mfma_f32_16x16x32_bf16 v[232:235], a[56:59], v[176:179], v[232:235]
    v_mfma_f32_16x16x32_bf16 v[236:239], a[56:59], v[180:183], v[236:239]
    v_mfma_f32_16x16x32_bf16 v[232:235], a[0:3], v[184:187], v[232:235]
    v_mfma_f32_16x16x32_bf16 v[236:239], a[0:3], v[188:191], v[236:239]
    s_cmp_ge_u32 s71, 14
    s_cbranch_scc1 L_NOCONS
    s_waitcnt vmcnt(1)
    v_cmp_le_u32 s[26:27], v3, v14
    s_bfe_u32 s95, s80, 0x40000
    s_lshl_b32 s95, s95, 1
    s_lshl_b32 s95, 3, s95
    s_mov_b32 s96, 0
    s_andn2_b32 s101, s95, s26
    s_cbranch_scc0 L_FD0
L_FP0:
    s_mov_b64 exec, 0xffff
    s_and_b32 s97, s96, 7
    s_cmp_eq_u32 s97, 7
    s_cbranch_scc1 L_RAG0
    buffer_load_dword v14, v13, s[40:43], s76 offen sc1
    s_branch L_RBG0
L_RAG0:
    v_mov_b32 v14, 0
    buffer_atomic_or v14, v13, s[40:43], s76 offen sc0 sc1
L_RBG0:
    s_waitcnt vmcnt(0)
    v_cmp_le_u32 s[26:27], v3, v14
    s_mov_b64 exec, -1
    s_nop 3
    s_andn2_b32 s101, s95, s26
    s_cbranch_scc0 L_FD0
    s_add_u32 s96, s96, 1
    s_cmp_lt_u32 s96, 0x40000
    s_cbranch_scc1 L_FP0
L_FD0:
    s_bfe_u32 s84, s80, 0x40000
    s_lshl_b32 s84, s84, 12
    s_add_u32 s84, s84, s100
    buffer_load_dwordx4 v[16:19], v7, s[40:43], s84 offen offset:0 sc1
    v_mfma_f32_16x16x32_bf16 v[144:147], a[74:77], a[144:147], 0
    v_mfma_f32_16x16x32_bf16 v[152:155], a[72:75], a[144:147], 0
    v_mfma_f32_16x16x32_bf16 v[148:151], a[74:77], a[160:163], 0
    v_mfma_f32_16x16x32_bf16 v[156:159], a[72:75], a[160:163], 0
    buffer_load_dwordx4 v[20:23], v7, s[40:43], s84 offen offset:1024 sc1
    v_mfma_f32_16x16x32_bf16 v[144:147], a[74:77], a[148:151], v[144:147]
    v_mfma_f32_16x16x32_bf16 v[152:155], a[72:75], a[148:151], v[152:155]
    v_mfma_f32_16x16x32_bf16 v[148:151], a[74:77], a[164:167], v[148:151]
    v_mfma_f32_16x16x32_bf16 v[156:159], a[72:75], a[164:167], v[156:159]
    buffer_load_dwordx4 v[24:27], v7, s[40:43], s84 offen offset:2048 sc1
    v_mfma_f32_16x16x32_bf16 v[144:147], a[74:77], a[152:155], v[144:147]
    v_mfma_f32_16x16x32_bf16 v[152:155], a[72:75], a[152:155], v[152:155]
    v_mfma_f32_16x16x32_bf16 v[148:151], a[74:77], a[168:171], v[148:151]
    v_mfma_f32_16x16x32_bf16 v[156:159], a[72:75], a[168:171], v[156:159]
    buffer_load_dwordx4 v[28:31], v7, s[40:43], s84 offen offset:3072 sc1
    v_mfma_f32_16x16x32_bf16 v[144:147], a[74:77], a[156:159], v[144:147]
    v_mfma_f32_16x16x32_bf16 v[152:155], a[72:75], a[156:159], v[152:155]
    v_mfma_f32_16x16x32_bf16 v[148:151], a[74:77], a[172:175], v[148:151]
    v_mfma_f32_16x16x32_bf16 v[156:159], a[72:75], a[172:175], v[156:159]
    s_bfe_u32 s95, s80, 0x40004
    s_lshl_b32 s95, s95, 1
    s_lshl_b32 s95, 3, s95
    s_mov_b32 s96, 0
    s_andn2_b32 s101, s95, s26
    s_cbranch_scc0 L_FD1
L_FP1:
    s_mov_b64 exec, 0xffff
    s_and_b32 s97, s96, 7
    s_cmp_eq_u32 s97, 7
    s_cbranch_scc1 L_RAG1
    buffer_load_dword v14, v13, s[40:43], s76 offen sc1
    s_branch L_RBG1
L_RAG1:
    v_mov_b32 v14, 0
    buffer_atomic_or v14, v13, s[40:43], s76 offen sc0 sc1
L_RBG1:
    s_waitcnt vmcnt(0)
    v_cmp_le_u32 s[26:27], v3, v14
    s_mov_b64 exec, -1
    s_nop 3
    s_andn2_b32 s101, s95, s26
    s_cbranch_scc0 L_FD1
    s_add_u32 s96, s96, 1
    s_cmp_lt_u32 s96, 0x40000
    s_cbranch_scc1 L_FP1
L_FD1:
    s_bfe_u32 s84, s80, 0x40004
    s_lshl_b32 s84, s84, 12
    s_add_u32 s84, s84, s100
    buffer_load_dwordx4 v[32:35], v7, s[40:43], s84 offen offset:0 sc1
    v_accvgpr_read_b32 v5, a85
    v_accvgpr_read_b32 v11, a78
    v_accvgpr_read_b32 v12, a84
    v_mul_f32 v224, v10, v224
    v_mul_f32 v225, v10, v225
    v_mul_f32 v226, v10, v226
    v_mul_f32 v227, v10, v227
    v_mul_f32 v228, v0, v228
    v_mul_f32 v229, v0, v229
    v_mul_f32 v230, v0, v230
    v_mul_f32 v231, v0, v231
    v_mul_f32 v232, v10, v232
    v_mul_f32 v233, v10, v233
    v_mul_f32 v234, v10, v234
    v_mul_f32 v235, v10, v235
    v_mul_f32 v236, v0, v236
    buffer_load_dwordx4 v[36:39], v7, s[40:43], s84 offen offset:1024 sc1
    v_mul_f32 v237, v0, v237
    v_mul_f32 v238, v0, v238
    v_mul_f32 v239, v0, v239
    v_mul_f32 v144, v11, v144
    v_mul_f32 v145, v11, v145
    v_mul_f32 v146, v11, v146
    v_mul_f32 v147, v11, v147
    v_mul_f32 v148, v11, v148
    v_mul_f32 v149, v11, v149
    v_mul_f32 v150, v11, v150
    v_mul_f32 v151, v11, v151
    v_mul_f32 v152, v12, v152
    v_mul_f32 v153, v12, v153
    v_mul_f32 v154, v12, v154
    v_mul_f32 v155, v12, v155
    v_mul_f32 v156, v12, v156
    buffer_load_dwordx4 v[40:43], v7, s[40:43], s84 offen offset:2048 sc1
    v_mul_f32 v157, v12, v157
    v_mul_f32 v158, v12, v158
    v_mul_f32 v159, v12, v159
    v_mul_f32 v240, 0xc1800000, v144
    v_mul_f32 v241, 0xc1800000, v145
    v_mul_f32 v242, 0xc1800000, v146
    v_mul_f32 v243, 0xc1800000, v147
    v_mul_f32 v244, 0xc1800000, v148
    v_mul_f32 v245, 0xc1800000, v149
    v_mul_f32 v246, 0xc1800000, v150
    v_mul_f32 v247, 0xc1800000, v151
    v_mul_f32 v248, 0xc1800000, v152
    v_mul_f32 v249, 0xc1800000, v153
    v_mul_f32 v250, 0xc1800000, v154
    v_mul_f32 v251, 0xc1800000, v155
    v_mul_f32 v252, 0xc1800000, v156
    buffer_load_dwordx4 v[44:47], v7, s[40:43], s84 offen offset:3072 sc1
    v_mul_f32 v253, 0xc1800000, v157
    v_mul_f32 v254, 0xc1800000, v158
    v_mul_f32 v255, 0xc1800000, v159
    v_exp_f32 v240, v240
    v_exp_f32 v241, v241
    v_exp_f32 v242, v242
    v_exp_f32 v243, v243
    v_exp_f32 v244, v244
    v_exp_f32 v245, v245
    v_exp_f32 v246, v246
    buffer_load_dword v6, v13, s[40:43], s76 offen sc1
    s_bfe_u32 s95, s80, 0x40008
    s_lshl_b32 s95, s95, 1
    s_lshl_b32 s95, 3, s95
    s_mov_b32 s96, 0
    s_andn2_b32 s101, s95, s26
    s_cbranch_scc0 L_FD2
    s_waitcnt vmcnt(0)
    v_max_u32 v14, v14, v6
    v_cmp_le_u32 s[26:27], v3, v14
    s_nop 3
    s_andn2_b32 s101, s95, s26
    s_cbranch_scc0 L_FD2
L_FP2:
    s_mov_b64 exec, 0xffff
    s_and_b32 s97, s96, 7
    s_cmp_eq_u32 s97, 7
    s_cbranch_scc1 L_RAG2
    buffer_load_dword v14, v13, s[40:43], s76 offen sc1
    s_branch L_RBG2
L_RAG2:
    v_mov_b32 v14, 0
    buffer_atomic_or v14, v13, s[40:43], s76 offen sc0 sc1
L_RBG2:
    s_waitcnt vmcnt(0)
    v_cmp_le_u32 s[26:27], v3, v14
    s_mov_b64 exec, -1
    s_nop 3
    s_andn2_b32 s101, s95, s26
    s_cbranch_scc0 L_FD2
    s_add_u32 s96, s96, 1
    s_cmp_lt_u32 s96, 0x40000
    s_cbranch_scc1 L_FP2
L_FD2:
    s_bfe_u32 s84, s80, 0x40008
    s_lshl_b32 s84, s84, 12
    s_add_u32 s84, s84, s100
    buffer_load_dwordx4 v[48:51], v7, s[40:43], s84 offen offset:0 sc1
    v_exp_f32 v247, v247
    v_exp_f32 v248, v248
    v_exp_f32 v249, v249
    v_exp_f32 v250, v250
    v_exp_f32 v251, v251
    v_exp_f32 v252, v252
    v_exp_f32 v253, v253
    v_exp_f32 v254, v254
    buffer_load_dwordx4 v[52:55], v7, s[40:43], s84 offen offset:1024 sc1
    v_exp_f32 v255, v255
    v_add_f32 v240, 1.0, v240
    v_add_f32 v241, 1.0, v241
    v_add_f32 v242, 1.0, v242
    v_add_f32 v243, 1.0, v243
    v_add_f32 v244, 1.0, v244
    v_add_f32 v245, 1.0, v245
    v_add_f32 v246, 1.0, v246
    v_add_f32 v247, 1.0, v247
    v_add_f32 v248, 1.0, v248
    v_add_f32 v249, 1.0, v249
    v_add_f32 v250, 1.0, v250
    v_add_f32 v251, 1.0, v251
    v_add_f32 v252, 1.0, v252
    v_add_f32 v253, 1.0, v253
    buffer_load_dwordx4 v[56:59], v7, s[40:43], s84 offen offset:2048 sc1
    v_add_f32 v254, 1.0, v254
    v_add_f32 v255, 1.0, v255
    v_rcp_f32 v240, v240
L_PAD13:
    s_cbranch_execz L_PADBACK
    v_rcp_f32 v241, v241
    v_rcp_f32 v242, v242
    v_rcp_f32 v243, v243
    v_rcp_f32 v244, v244
    v_rcp_f32 v245, v245
    v_rcp_f32 v246, v246
    buffer_load_dwordx4 v[60:63], v7, s[40:43], s84 offen offset:3072 sc1
    v_rcp_f32 v247, v247
    v_rcp_f32 v248, v248
    v_rcp_f32 v249, v249
    v_rcp_f32 v250, v250
    v_rcp_f32 v251, v251
    v_rcp_f32 v252, v252
    v_rcp_f32 v253, v253
    v_rcp_f32 v254, v254
    s_bfe_u32 s95, s80, 0x4000c
    s_lshl_b32 s95, s95, 1
    s_lshl_b32 s95, 3, s95
    s_mov_b32 s96, 0
    s_andn2_b32 s101, s95, s26
    s_cbranch_scc0 L_FD3
    s_waitcnt vmcnt(4)
    v_max_u32 v14, v14, v6
    v_cmp_le_u32 s[26:27], v3, v14
    s_nop 3
    s_andn2_b32 s101, s95, s26
    s_cbranch_scc0 L_FD3
L_FP3:
    s_mov_b64 exec, 0xffff
    s_and_b32 s97, s96, 7
    s_cmp_eq_u32 s97, 7
    s_cbranch_scc1 L_RAG3
    buffer_load_dword v14, v13, s[40:43], s76 offen sc1
    s_branch L_RBG3
L_RAG3:
    v_mov_b32 v14, 0
    buffer_atomic_or v14, v13, s[40:43], s76 offen sc0 sc1
L_RBG3:
    s_waitcnt vmcnt(0)
    v_cmp_le_u32 s[26:27], v3, v14
    s_mov_b64 exec, -1
    s_nop 3
    s_andn2_b32 s101, s95, s26
    s_cbranch_scc0 L_FD3
    s_add_u32 s96, s96, 1
    s_cmp_lt_u32 s96, 0x40000
    s_cbranch_scc1 L_FP3
L_FD3:
    s_bfe_u32 s84, s80, 0x4000c
    s_lshl_b32 s84, s84, 12
    s_add_u32 s84, s84, s100
    buffer_load_dwordx4 v[64:67], v7, s[40:43], s84 offen offset:0 sc1
    v_rcp_f32 v255, v255
    v_mul_f32 v144, 0x41317218, v144
    v_mul_f32 v145, 0x41317218, v145
    v_mul_f32 v146, 0x41317218, v146
    v_mul_f32 v147, 0x41317218, v147
    v_mul_f32 v148, 0x41317218, v148
    v_mul_f32 v149, 0x41317218, v149
    v_mul_f32 v150, 0x41317218, v150
    v_mul_f32 v151, 0x41317218, v151
    v_mul_f32 v152, 0x41317218, v152
    v_mul_f32 v153, 0x41317218, v153
    v_mul_f32 v154, 0x41317218, v154
    v_mul_f32 v155, 0x41317218, v155
    v_mul_f32 v156, 0x41317218, v156
    v_mul_f32 v157, 0x41317218, v157
    buffer_load_dwordx4 v[68:71], v7, s[40:43], s84 offen offset:1024 sc1
    v_mul_f32 v158, 0x41317218, v158
    v_mul_f32 v159, 0x41317218, v159
    v_mul_f32 v144, v240, v144
    v_mul_f32 v145, v241, v145
    v_mul_f32 v146, v242, v146
    v_mul_f32 v147, v243, v147
    v_mul_f32 v148, v244, v148
    v_mul_f32 v149, v245, v149
    v_mul_f32 v150, v246, v150
    v_mul_f32 v151, v247, v151
    v_mul_f32 v152, v248, v152
    v_mul_f32 v153, v249, v153
    v_mul_f32 v154, v250, v154
    v_mul_f32 v155, v251, v155
    v_mul_f32 v156, v252, v156
    v_mul_f32 v157, v253, v157
    buffer_load_dwordx4 v[72:75], v7, s[40:43], s84 offen offset:2048 sc1
    v_mul_f32 v158, v254, v158
    v_mul_f32 v159, v255, v159
    v_accvgpr_read_b32 v176, a176
    v_accvgpr_read_b32 v177, a177
    v_accvgpr_read_b32 v178, a178
    v_accvgpr_read_b32 v179, a179
    v_accvgpr_read_b32 v180, a180
    v_accvgpr_read_b32 v181, a181
    v_accvgpr_read_b32 v182, a182
    v_accvgpr_read_b32 v183, a183
    v_permlane16_swap_b32 v176, v178
    v_permlane16_swap_b32 v177, v179
    v_permlane16_swap_b32 v180, v182
    buffer_load_dwordx4 v[76:79], v7, s[40:43], s84 offen offset:3072 sc1
    v_permlane16_swap_b32 v181, v183
    v_lshlrev_b32 v160, 16, v176
    v_and_b32 v161, s70, v176
    v_lshlrev_b32 v162, 16, v177
    v_and_b32 v163, s70, v177
    v_lshlrev_b32 v164, 16, v178
    v_and_b32 v165, s70, v178
    v_lshlrev_b32 v166, 16, v179
    v_and_b32 v167, s70, v179
    v_lshlrev_b32 v168, 16, v180
    v_and_b32 v169, s70, v180
    v_lshlrev_b32 v170, 16, v181
    v_and_b32 v171, s70, v181
    v_lshlrev_b32 v172, 16, v182
    v_and_b32 v173, s70, v182
    s_bfe_u32 s95, s80, 0x40010
    s_lshl_b32 s95, s95, 1
    s_lshl_b32 s95, 3, s95
    s_mov_b32 s96, 0
    s_andn2_b32 s101, s95, s26
    s_cbranch_scc0 L_FD4
    s_waitcnt vmcnt(8)
    v_max_u32 v14, v14, v6
    v_cmp_le_u32 s[26:27], v3, v14
    s_nop 3
    s_andn2_b32 s101, s95, s26
    s_cbranch_scc0 L_FD4
L_FP4:
    s_mov_b64 exec, 0xffff
    s_and_b32 s97, s96, 7
    s_cmp_eq_u32 s97, 7
    s_cbranch_scc1 L_RAG4
    buffer_load_dword v14, v13, s[40:43], s76 offen sc1
    s_branch L_RBG4
L_RAG4:
    v_mov_b32 v14, 0
    buffer_atomic_or v14, v13, s[40:43], s76 offen sc0 sc1
L_RBG4:
    s_waitcnt vmcnt(0)
    v_cmp_le_u32 s[26:27], v3, v14
    s_mov_b64 exec, -1
    s_nop 3
    s_andn2_b32 s101, s95, s26
    s_cbranch_scc0 L_FD4
    s_add_u32 s96, s96, 1
    s_cmp_lt_u32 s96, 0x40000
    s_cbranch_scc1 L_FP4
L_FD4:
    s_bfe_u32 s84, s80, 0x40010
    s_lshl_b32 s84, s84, 12
    s_add_u32 s84, s84, s100
    buffer_load_dwordx4 v[80:83], v7, s[40:43], s84 offen offset:0 sc1
    v_lshlrev_b32 v174, 16, v183
    v_and_b32 v175, s70, v183
    buffer_load_dwordx4 v[84:87], v7, s[40:43], s84 offen offset:1024 sc1
    buffer_load_dwordx4 v[88:91], v7, s[40:43], s84 offen offset:2048 sc1
    buffer_load_dwordx4 v[92:95], v7, s[40:43], s84 offen offset:3072 sc1
    s_waitcnt vmcnt(20)
    v_mfma_f32_16x16x32_bf16 v[128:131], a[74:77], v[16:19], v[224:227]
    v_mfma_f32_16x16x32_bf16 v[132:135], a[72:75], v[16:19], v[232:235]
    s_waitcnt vmcnt(19)
    v_mfma_f32_16x16x32_bf16 v[136:139], a[74:77], v[20:23], v[228:231]
    v_mfma_f32_16x16x32_bf16 v[140:143], a[72:75], v[20:23], v[236:239]
    s_waitcnt vmcnt(18)
    v_mfma_f32_16x16x32_bf16 v[128:131], a[74:77], v[24:27], v[128:131]
    v_mfma_f32_16x16x32_bf16 v[132:135], a[72:75], v[24:27], v[132:135]
    s_waitcnt vmcnt(17)
    v_mfma_f32_16x16x32_bf16 v[136:139], a[74:77], v[28:31], v[136:139]
    v_mfma_f32_16x16x32_bf16 v[140:143], a[72:75], v[28:31], v[140:143]
    s_waitcnt vmcnt(16)
    v_mfma_f32_16x16x32_bf16 v[128:131], a[74:77], v[32:35], v[128:131]
    v_mfma_f32_16x16x32_bf16 v[132:135], a[72:75], v[32:35], v[132:135]
    s_waitcnt vmcnt(15)
    v_mfma_f32_16x16x32_bf16 v[136:139], a[74:77], v[36:39], v[136:139]
    v_mfma_f32_16x16x32_bf16 v[140:143], a[72:75], v[36:39], v[140:143]
    s_waitcnt vmcnt(14)
    v_mfma_f32_16x16x32_bf16 v[128:131], a[74:77], v[40:43], v[128:131]
    v_mfma_f32_16x16x32_bf16 v[132:135], a[72:75], v[40:43], v[132:135]
    s_waitcnt vmcnt(13)
    v_mfma_f32_16x16x32_bf16 v[136:139], a[74:77], v[44:47], v[136:139]
    v_mfma_f32_16x16x32_bf16 v[140:143], a[72:75], v[44:47], v[140:143]
    s_bfe_u32 s95, s80, 0x40014
    s_lshl_b32 s95, s95, 1
    s_lshl_b32 s95, 3, s95
    s_mov_b32 s96, 0
    s_andn2_b32 s101, s95, s26
    s_cbranch_scc0 L_FD5
    s_waitcnt vmcnt(12)
    v_max_u32 v14, v14, v6
    v_cmp_le_u32 s[26:27], v3, v14
    s_nop 3
    s_andn2_b32 s101, s95, s26
    s_cbranch_scc0 L_FD5
L_FP5:
    s_mov_b64 exec, 0xffff
    s_and_b32 s97, s96, 7
    s_cmp_eq_u32 s97, 7
    s_cbranch_scc1 L_RAG5
    buffer_load_dword v14, v13, s[40:43], s76 offen sc1
    s_branch L_RBG5
L_RAG5:
    v_mov_b32 v14, 0
    buffer_atomic_or v14, v13, s[40:43], s76 offen sc0 sc1
L_RBG5:
    s_waitcnt vmcnt(0)
    v_cmp_le_u32 s[26:27], v3, v14
    s_mov_b64 exec, -1
    s_nop 3
    s_andn2_b32 s101, s95, s26
    s_cbranch_scc0 L_FD5
    s_add_u32 s96, s96, 1
    s_cmp_lt_u32 s96, 0x40000
    s_cbranch_scc1 L_FP5
L_FD5:
    s_bfe_u32 s84, s80, 0x40014
    s_lshl_b32 s84, s84, 12
    s_add_u32 s84, s84, s100
    buffer_load_dwordx4 v[96:99], v7, s[40:43], s84 offen offset:0 sc1
    buffer_load_dwordx4 v[100:103], v7, s[40:43], s84 offen offset:1024 sc1
    buffer_load_dwordx4 v[104:107], v7, s[40:43], s84 offen offset:2048 sc1
    buffer_load_dwordx4 v[108:111], v7, s[40:43], s84 offen offset:3072 sc1
    s_waitcnt vmcnt(15)
    v_mfma_f32_16x16x32_bf16 v[128:131], a[74:77], v[48:51], v[128:131]
    v_mfma_f32_16x16x32_bf16 v[132:135], a[72:75], v[48:51], v[132:135]
    s_waitcnt vmcnt(14)
    v_mfma_f32_16x16x32_bf16 v[136:139], a[74:77], v[52:55], v[136:139]
    v_mfma_f32_16x16x32_bf16 v[140:143], a[72:75], v[52:55], v[140:143]
    s_waitcnt vmcnt(13)
    v_mfma_f32_16x16x32_bf16 v[128:131], a[74:77], v[56:59], v[128:131]
    v_mfma_f32_16x16x32_bf16 v[132:135], a[72:75], v[56:59], v[132:135]
    s_waitcnt vmcnt(12)
    v_mfma_f32_16x16x32_bf16 v[136:139], a[74:77], v[60:63], v[136:139]
    v_mfma_f32_16x16x32_bf16 v[140:143], a[72:75], v[60:63], v[140:143]
    s_bfe_u32 s95, s80, 0x40018
    s_lshl_b32 s95, s95, 1
    s_lshl_b32 s95, 3, s95
    s_mov_b32 s96, 0
    s_andn2_b32 s101, s95, s26
    s_cbranch_scc0 L_FD6
    s_waitcnt vmcnt(16)
    v_max_u32 v14, v14, v6
    v_cmp_le_u32 s[26:27], v3, v14
    s_nop 3
    s_andn2_b32 s101, s95, s26
    s_cbranch_scc0 L_FD6
L_FP6:
    s_mov_b64 exec, 0xffff
    s_and_b32 s97, s96, 7
    s_cmp_eq_u32 s97, 7
    s_cbranch_scc1 L_RAG6
    buffer_load_dword v14, v13, s[40:43], s76 offen sc1
    s_branch L_RBG6
L_RAG6:
    v_mov_b32 v14, 0
    buffer_atomic_or v14, v13, s[40:43], s76 offen sc0 sc1
L_RBG6:
    s_waitcnt vmcnt(0)
    v_cmp_le_u32 s[26:27], v3, v14
    s_mov_b64 exec, -1
    s_nop 3
    s_andn2_b32 s101, s95, s26
    s_cbranch_scc0 L_FD6
    s_add_u32 s96, s96, 1
    s_cmp_lt_u32 s96, 0x40000
    s_cbranch_scc1 L_FP6
L_FD6:
    s_bfe_u32 s84, s80, 0x40018
    s_lshl_b32 s84, s84, 12
    s_add_u32 s84, s84, s100
    s_lshr_b32 s69, s69, 6
    s_add_u32 s84, s84, s69
    buffer_load_dwordx4 v[112:115], v7, s[40:43], s84 offen offset:0 sc1
    buffer_load_dwordx4 v[116:119], v7, s[40:43], s84 offen offset:1024 sc1
    s_waitcnt vmcnt(13)
    v_mfma_f32_16x16x32_bf16 v[128:131], a[74:77], v[64:67], v[128:131]
    v_mfma_f32_16x16x32_bf16 v[132:135], a[72:75], v[64:67], v[132:135]
    s_waitcnt vmcnt(12)
    v_mfma_f32_16x16x32_bf16 v[136:139], a[74:77], v[68:71], v[136:139]
    v_mfma_f32_16x16x32_bf16 v[140:143], a[72:75], v[68:71], v[140:143]
    s_waitcnt vmcnt(11)
    v_mfma_f32_16x16x32_bf16 v[128:131], a[74:77], v[72:75], v[128:131]
    v_mfma_f32_16x16x32_bf16 v[132:135], a[72:75], v[72:75], v[132:135]
    s_waitcnt vmcnt(10)
    v_mfma_f32_16x16x32_bf16 v[136:139], a[74:77], v[76:79], v[136:139]
    v_mfma_f32_16x16x32_bf16 v[140:143], a[72:75], v[76:79], v[140:143]
    s_mov_b32 s95, 0xc000
    s_mov_b32 s96, 0
    s_andn2_b32 s101, s95, s26
    s_cbranch_scc0 L_FD7
    s_waitcnt vmcnt(18)
    v_max_u32 v14, v14, v6
    v_cmp_le_u32 s[26:27], v3, v14
    s_nop 3
    s_andn2_b32 s101, s95, s26
    s_cbranch_scc0 L_FD7
L_FP7:
    s_mov_b64 exec, 0xffff
    s_and_b32 s97, s96, 7
    s_cmp_eq_u32 s97, 7
    s_cbranch_scc1 L_RAG7
    buffer_load_dword v14, v13, s[40:43], s76 offen sc1
    s_branch L_RBG7
L_RAG7:
    v_mov_b32 v14, 0
    buffer_atomic_or v14, v13, s[40:43], s76 offen sc0 sc1
L_RBG7:
    s_waitcnt vmcnt(0)
    v_cmp_le_u32 s[26:27], v3, v14
    s_mov_b64 exec, -1
    s_nop 3
    s_andn2_b32 s101, s95, s26
    s_cbranch_scc0 L_FD7
    s_add_u32 s96, s96, 1
    s_cmp_lt_u32 s96, 0x40000
    s_cbranch_scc1 L_FP7
L_FD7:
    s_add_u32 s84, s100, 28672
    buffer_load_dwordx4 v[192:195], v7, s[40:43], s84 offen offset:0 sc1
    buffer_load_dwordx4 v[196:199], v7, s[40:43], s84 offen offset:1024 sc1
    buffer_load_dwordx4 v[200:203], v7, s[40:43], s84 offen offset:2048 sc1
    buffer_load_dwordx4 v[204:207], v7, s[40:43], s84 offen offset:3072 sc1
    s_waitcnt vmcnt(13)
    v_mfma_f32_16x16x32_bf16 v[128:131], a[74:77], v[80:83], v[128:131]
    v_mfma_f32_16x16x32_bf16 v[132:135], a[72:75], v[80:83], v[132:135]
    s_waitcnt vmcnt(12)
    v_mfma_f32_16x16x32_bf16 v[136:139], a[74:77], v[84:87], v[136:139]
    v_mfma_f32_16x16x32_bf16 v[140:143], a[72:75], v[84:87], v[140:143]
    s_waitcnt vmcnt(11)
    v_mfma_f32_16x16x32_bf16 v[128:131], a[74:77], v[88:91], v[128:131]
    v_mfma_f32_16x16x32_bf16 v[132:135], a[72:75], v[88:91], v[132:135]
    s_waitcnt vmcnt(10)
    v_mfma_f32_16x16x32_bf16 v[136:139], a[74:77], v[92:95], v[136:139]
    v_mfma_f32_16x16x32_bf16 v[140:143], a[72:75], v[92:95], v[140:143]
    s_waitcnt vmcnt(9)
    v_mfma_f32_16x16x32_bf16 v[128:131], a[74:77], v[96:99], v[128:131]
    v_mfma_f32_16x16x32_bf16 v[132:135], a[72:75], v[96:99], v[132:135]
    s_waitcnt vmcnt(8)
    v_mfma_f32_16x16x32_bf16 v[136:139], a[74:77], v[100:103], v[136:139]
    v_mfma_f32_16x16x32_bf16 v[140:143], a[72:75], v[100:103], v[140:143]
    s_waitcnt vmcnt(7)
    v_mfma_f32_16x16x32_bf16 v[128:131], a[74:77], v[104:107], v[128:131]
    v_mfma_f32_16x16x32_bf16 v[132:135], a[72:75], v[104:107], v[132:135]
    s_waitcnt vmcnt(6)
    v_mfma_f32_16x16x32_bf16 v[136:139], a[74:77], v[108:111], v[136:139]
    v_mfma_f32_16x16x32_bf16 v[140:143], a[72:75], v[108:111], v[140:143]
    s_waitcnt vmcnt(5)
    v_mfma_f32_16x16x32_bf16 v[128:131], a[74:77], v[112:115], v[128:131]
    v_mfma_f32_16x16x32_bf16 v[132:135], a[72:75], v[112:115], v[132:135]
    s_waitcnt vmcnt(4)
    v_mfma_f32_16x16x32_bf16 v[136:139], a[74:77], v[116:119], v[136:139]
    v_mfma_f32_16x16x32_bf16 v[140:143], a[72:75], v[116:119], v[140:143]
    s_waitcnt vmcnt(3)
    v_mfma_f32_16x16x32_bf16 v[128:131], a[74:77], v[192:195], v[128:131]
    v_mfma_f32_16x16x32_bf16 v[132:135], a[72:75], v[192:195], v[132:135]
    s_waitcnt vmcnt(2)
    v_mfma_f32_16x16x32_bf16 v[136:139], a[74:77], v[196:199], v[136:139]
    v_mfma_f32_16x16x32_bf16 v[140:143], a[72:75], v[196:199], v[140:143]
    s_waitcnt vmcnt(1)
    v_mfma_f32_16x16x32_bf16 v[128:131], a[74:77], v[200:203], v[128:131]
    v_mfma_f32_16x16x32_bf16 v[132:135], a[72:75], v[200:203], v[132:135]
    s_waitcnt vmcnt(0)
    v_mfma_f32_16x16x32_bf16 v[136:139], a[74:77], v[204:207], v[136:139]
    v_mfma_f32_16x16x32_bf16 v[140:143], a[72:75], v[204:207], v[140:143]
    s_nop 3
    v_fma_f32 v160, v128, v144, v160
    v_fma_f32 v161, v129, v145, v161
    v_fma_f32 v162, v130, v146, v162
    v_fma_f32 v163, v131, v147, v163
    v_fma_f32 v164, v132, v148, v164
    v_fma_f32 v165, v133, v149, v165
    v_fma_f32 v166, v134, v150, v166
    v_fma_f32 v167, v135, v151, v167
    v_fma_f32 v168, v136, v152, v168
    v_fma_f32 v169, v137, v153, v169
    v_fma_f32 v170, v138, v154, v170
    v_fma_f32 v171, v139, v155, v171
    v_fma_f32 v172, v140, v156, v172
    v_fma_f32 v173, v141, v157, v173
    v_fma_f32 v174, v142, v158, v174
    v_fma_f32 v175, v143, v159, v175
    v_cvt_pk_bf16_f32 v176, v160, v161
    v_cvt_pk_bf16_f32 v177, v162, v163
    v_cvt_pk_bf16_f32 v178, v164, v165
    v_cvt_pk_bf16_f32 v179, v166, v167
    v_cvt_pk_bf16_f32 v180, v168, v169
    v_cvt_pk_bf16_f32 v181, v170, v171
    v_cvt_pk_bf16_f32 v182, v172, v173
    v_cvt_pk_bf16_f32 v183, v174, v175
    v_permlane16_swap_b32 v176, v178
    v_permlane16_swap_b32 v177, v179
    v_permlane16_swap_b32 v180, v182
    v_permlane16_swap_b32 v181, v183
    buffer_store_dwordx4 v[176:179], v5, s[32:35], s92 offen
    buffer_store_dwordx4 v[180:183], v5, s[32:35], s25 offen
L_FIN:
L_END:
    s_endpgm
L_NOCONS:
    s_nop 7
    v_mul_f32 v224, v10, v224
    v_mul_f32 v225, v10, v225
    v_mul_f32 v226, v10, v226
    v_mul_f32 v227, v10, v227
    v_mul_f32 v228, v0, v228
    v_mul_f32 v229, v0, v229
    v_mul_f32 v230, v0, v230
    v_mul_f32 v231, v0, v231
    v_mul_f32 v232, v10, v232
    v_mul_f32 v233, v10, v233
    v_mul_f32 v234, v10, v234
    v_mul_f32 v235, v10, v235
    v_mul_f32 v236, v0, v236
    v_mul_f32 v237, v0, v237
    v_mul_f32 v238, v0, v238
    v_mul_f32 v239, v0, v239
    v_cvt_pk_bf16_f32 v248, v224, v225
    v_cvt_pk_bf16_f32 v249, v226, v227
    v_cvt_pk_bf16_f32 v250, v232, v233
    v_cvt_pk_bf16_f32 v251, v234, v235
    v_cvt_pk_bf16_f32 v252, v228, v229
    v_cvt_pk_bf16_f32 v253, v230, v231
    v_cvt_pk_bf16_f32 v254, v236, v237
    v_cvt_pk_bf16_f32 v255, v238, v239
    s_xor_b32 s94, s94, 131072
    buffer_store_dwordx4 v[248:251], v7, s[40:43], s94 offen offset:0 sc1
    buffer_store_dwordx4 v[252:255], v7, s[40:43], s94 offen offset:1024 sc1
    s_waitcnt vmcnt(0)
    v_mov_b32 v14, 10
    buffer_store_dword v14, v8, s[40:43], 0 offen sc1
    s_branch L_FIN
L_CODE_END:
L_REVAR:
    s_nop 7
    v_mfma_f32_16x16x32_bf16 v[144:147], v[16:19], v[16:19], 0
    v_mfma_f32_16x16x32_bf16 v[148:151], v[20:23], v[20:23], 0
    v_mfma_f32_16x16x32_bf16 v[144:147], v[24:27], v[24:27], v[144:147]
    v_mfma_f32_16x16x32_bf16 v[148:151], v[28:31], v[28:31], v[148:151]
    v_mfma_f32_16x16x32_bf16 v[144:147], v[32:35], v[32:35], v[144:147]
    v_mfma_f32_16x16x32_bf16 v[148:151], v[36:39], v[36:39], v[148:151]
    v_mfma_f32_16x16x32_bf16 v[144:147], v[40:43], v[40:43], v[144:147]
    v_mfma_f32_16x16x32_bf16 v[148:151], v[44:47], v[44:47], v[148:151]
    v_mfma_f32_16x16x32_bf16 v[144:147], v[48:51], v[48:51], v[144:147]
    v_mfma_f32_16x16x32_bf16 v[148:151], v[52:55], v[52:55], v[148:151]
    v_mfma_f32_16x16x32_bf16 v[144:147], v[56:59], v[56:59], v[144:147]
    v_mfma_f32_16x16x32_bf16 v[148:151], v[60:63], v[60:63], v[148:151]
    v_mfma_f32_16x16x32_bf16 v[144:147], v[64:67], v[64:67], v[144:147]
    v_mfma_f32_16x16x32_bf16 v[148:151], v[68:71], v[68:71], v[148:151]
    v_mfma_f32_16x16x32_bf16 v[144:147], v[72:75], v[72:75], v[144:147]
    v_mfma_f32_16x16x32_bf16 v[148:151], v[76:79], v[76:79], v[148:151]
    v_mfma_f32_16x16x32_bf16 v[144:147], v[80:83], v[80:83], v[144:147]
    v_mfma_f32_16x16x32_bf16 v[148:151], v[84:87], v[84:87], v[148:151]
    v_mfma_f32_16x16x32_bf16 v[144:147], v[88:91], v[88:91], v[144:147]
    v_mfma_f32_16x16x32_bf16 v[148:151], v[92:95], v[92:95], v[148:151]
    v_mfma_f32_16x16x32_bf16 v[144:147], v[96:99], v[96:99], v[144:147]
    v_mfma_f32_16x16x32_bf16 v[148:151], v[100:103], v[100:103], v[148:151]
    v_mfma_f32_16x16x32_bf16 v[144:147], v[104:107], v[104:107], v[144:147]
    v_mfma_f32_16x16x32_bf16 v[148:151], v[108:111], v[108:111], v[148:151]
    v_mfma_f32_16x16x32_bf16 v[144:147], v[112:115], v[112:115], v[144:147]
    v_mfma_f32_16x16x32_bf16 v[148:151], v[116:119], v[116:119], v[148:151]
    v_mfma_f32_16x16x32_bf16 v[144:147], v[120:123], v[120:123], v[144:147]
    v_mfma_f32_16x16x32_bf16 v[148:151], v[124:127], v[124:127], v[148:151]
    v_sub_f32 v142, v142, v160
    v_sub_f32 v143, v143, v164
    v_accvgpr_read_b32 v140, a74
    v_accvgpr_read_b32 v141, a75
    v_lshlrev_b32 v136, 16, v140
    v_and_b32 v137, s70, v140
    v_lshlrev_b32 v138, 16, v141
    v_and_b32 v139, s70, v141
    v_mul_f32 v144, v136, v144
    v_mul_f32 v148, v136, v148
    v_fmac_f32 v144, v137, v145
    v_fmac_f32 v148, v137, v149
    v_fmac_f32 v144, v138, v146
    v_fmac_f32 v148, v138, v150
    v_fmac_f32 v144, v139, v147
    v_fmac_f32 v148, v139, v151
    v_mov_b32 v145, v144
    v_mov_b32 v149, v148
    s_nop 0
    v_permlane16_swap_b32 v144, v145
    v_permlane16_swap_b32 v148, v149
    v_add_f32 v144, v144, v145
    v_add_f32 v148, v148, v149
    v_mov_b32 v145, v144
    v_mov_b32 v149, v148
    s_nop 0
    v_permlane32_swap_b32 v144, v145
    v_permlane32_swap_b32 v148, v149
    v_add_f32 v144, v144, v145
    v_add_f32 v148, v148, v149
    v_mul_f32 v144, 0x3b124925, v144
    v_mul_f32 v148, 0x3b124925, v148
    v_fma_f32 v144, -v142, v142, v144
    v_fma_f32 v148, -v143, v143, v148
    v_max_f32 v144, 0, v144
    v_max_f32 v148, 0, v148
    v_cvt_pk_bf16_f32 v144, v144, v144
    v_cvt_pk_bf16_f32 v148, v148, v148
    v_and_b32 v144, s70, v144
    v_and_b32 v148, s70, v148
    v_add_f32 v144, 0x3727c5ac, v144
    v_add_f32 v148, 0x3727c5ac, v148
    v_cvt_pk_bf16_f32 v144, v144, v144
    v_cvt_pk_bf16_f32 v148, v148, v148
    v_and_b32 v144, s70, v144
    v_and_b32 v148, s70, v148
    v_sqrt_f32 v144, v144
    v_sqrt_f32 v148, v148
    v_cvt_pk_bf16_f32 v144, v144, v144
    v_cvt_pk_bf16_f32 v148, v148, v148
    v_and_b32 v144, s70, v144
    v_and_b32 v148, s70, v148
    v_rcp_f32 v144, v144
    v_rcp_f32 v148, v148
    v_mul_f32 v144, 0x3db8aa3b, v144
    v_mul_f32 v148, 0x3db8aa3b, v148
    v_accvgpr_write_b32 a78, v144
    v_accvgpr_write_b32 a84, v148
    s_nop 1
    s_branch L_VAROK
L_SPIN0:
    s_mov_b32 s96, 0
L_SPINL0:
    s_sleep 1
    s_mov_b64 exec, 1
    s_and_b32 s97, s96, 7
    s_cmp_eq_u32 s97, 7
    s_cbranch_scc1 L_RAC0
    buffer_load_dword v10, v14, s[36:39], 0 offen sc1
    s_branch L_RBC0
L_RAC0:
    v_mov_b32 v10, 0
    buffer_atomic_or v10, v14, s[36:39], 0 offen sc0 sc1
L_RBC0:
    s_waitcnt vmcnt(0)
    v_cmp_ne_u32 s[26:27], 1, v10
    s_mov_b64 exec, -1
    s_nop 3
    s_cmp_eq_u64 s[26:27], 0
    s_cbranch_scc1 L_OK0
    s_add_u32 s96, s96, 1
    s_cmp_lt_u32 s96, 0x40000
    s_cbranch_scc1 L_SPINL0
    s_branch L_OK0
L_SPIN1:
    s_mov_b32 s96, 0
L_SPINL1:
    s_sleep 1
    s_mov_b64 exec, 0xffff
    s_and_b32 s97, s96, 7
    s_cmp_eq_u32 s97, 7
    s_cbranch_scc1 L_RAC1
    buffer_load_dword v14, v13, s[40:43], s76 offen sc1
    s_branch L_RBC1
L_RAC1:
    v_mov_b32 v14, 0
    buffer_atomic_or v14, v13, s[40:43], s76 offen sc0 sc1
L_RBC1:
    s_waitcnt vmcnt(0)
    v_cmp_gt_u32 s[26:27], 1, v14
    s_mov_b64 exec, -1
    s_nop 3
    s_cmp_eq_u64 s[26:27], 0
    s_cbranch_scc1 L_OK1
    s_add_u32 s96, s96, 1
    s_cmp_lt_u32 s96, 0x40000
    s_cbranch_scc1 L_SPINL1
    s_branch L_OK1
L_SPIN2:
    s_mov_b32 s96, 0
L_SPINL2:
    s_sleep 1
    s_mov_b64 exec, 0xffff
    s_and_b32 s97, s96, 7
    s_cmp_eq_u32 s97, 7
    s_cbranch_scc1 L_RAC2
    buffer_load_dword v14, v13, s[40:43], s76 offen sc1
    s_branch L_RBC2
L_RAC2:
    v_mov_b32 v14, 0
    buffer_atomic_or v14, v13, s[40:43], s76 offen sc0 sc1
L_RBC2:
    s_waitcnt vmcnt(0)
    v_cmp_gt_u32 s[26:27], 2, v14
    s_mov_b64 exec, -1
    s_nop 3
    s_cmp_eq_u64 s[26:27], 0
    s_cbranch_scc1 L_OK2
    s_add_u32 s96, s96, 1
    s_cmp_lt_u32 s96, 0x40000
    s_cbranch_scc1 L_SPINL2
    s_branch L_OK2
L_RARE0:
    s_call_b64 s[96:97], L_RESCALE1
    s_branch L_BACK0
L_RARE1:
    s_call_b64 s[96:97], L_RESCALE0
    s_branch L_BACK1
L_RARE2:
    s_call_b64 s[96:97], L_RESCALE1
    s_branch L_BACK2
L_RARE3:
    s_call_b64 s[96:97], L_RESCALE0
    s_branch L_BACK3
L_RARE4:
    s_call_b64 s[96:97], L_RESCALE1
    s_branch L_BACK4
L_RARE5:
    s_call_b64 s[96:97], L_RESCALE0
    s_branch L_BACK5
L_RARE6:
    s_call_b64 s[96:97], L_RESCALE1
    s_branch L_BACK6
L_RARE7:
    s_call_b64 s[96:97], L_RESCALE0
    s_branch L_BACK7
L_RARE8:
    s_call_b64 s[96:97], L_RESCALE1
    s_branch L_BACK8
L_RARE9:
    s_call_b64 s[96:97], L_RESCALE0
    s_branch L_BACK9
L_RARE10:
    s_call_b64 s[96:97], L_RESCALE1
    s_branch L_BACK10
L_RARE11:
    s_call_b64 s[96:97], L_RESCALE0
    s_branch L_BACK11
L_RARE12:
    s_call_b64 s[96:97], L_RESCALE1
    s_branch L_BACK12
L_RARE13:
    s_call_b64 s[96:97], L_RESCALE0
    s_branch L_BACK13
L_RARE14:
    s_call_b64 s[96:97], L_RESCALE1
    s_branch L_BACK14
L_RARE15:
    s_call_b64 s[96:97], L_RESCALE0
    s_branch L_BACK15
L_RARE16:
    s_call_b64 s[96:97], L_RESCALE1
    s_branch L_BACK16
L_RARE17:
    s_call_b64 s[96:97], L_RESCALE0
    s_branch L_BACK17
L_RARE18:
    s_call_b64 s[96:97], L_RESCALE1
    s_branch L_BACK18
L_RARE19:
    s_call_b64 s[96:97], L_RESCALE0
    s_branch L_BACK19
L_RARE20:
    s_call_b64 s[96:97], L_RESCALE1
    s_branch L_BACK20
L_RARE21:
    s_call_b64 s[96:97], L_RESCALE0
    s_branch L_BACK21
L_RARE22:
    s_call_b64 s[96:97], L_RESCALE1
    s_branch L_BACK22
L_RARE23:
    s_call_b64 s[96:97], L_RESCALE0
    s_branch L_BACK23
L_RARE24:
    s_call_b64 s[96:97], L_RESCALE1
    s_branch L_BACK24
L_RARE25:
    s_call_b64 s[96:97], L_RESCALE0
    s_branch L_BACK25
L_RARE26:
    s_call_b64 s[96:97], L_RESCALE1
    s_branch L_BACK26
L_RARE27:
    s_call_b64 s[96:97], L_RESCALE0
    s_branch L_BACK27
L_RARE28:
    s_call_b64 s[96:97], L_RESCALE1
    s_branch L_BACK28
L_RARE29:
    s_call_b64 s[96:97], L_RESCALE0
    s_branch L_BACK29
L_RARE30:
    s_call_b64 s[96:97], L_RESCALE1
    s_branch L_BACK30
L_RESCALE0:
    s_nop 15
    v_max3_f32 v0, v208, v209, v210
    v_max_f32 v0, v0, v211
    v_mov_b32 v254, v0
    s_nop 1
    v_permlane16_swap_b32 v0, v254
    v_max_f32 v0, v0, v254
    v_mov_b32 v254, v0
    s_nop 1
    v_permlane32_swap_b32 v0, v254
    v_max_f32 v0, v0, v254
    v_ceil_f32 v0, v0
    v_max_f32 v0, 0, v0
    v_sub_f32 v254, 0, v0
    v_exp_f32 v254, v254
    v_sub_f32 v208, v208, v0
    v_sub_f32 v209, v209, v0
    v_sub_f32 v210, v210, v0
    v_sub_f32 v211, v211, v0
    v_sub_f32 v216, v216, v0
    v_sub_f32 v217, v217, v0
    v_sub_f32 v218, v218, v0
    v_sub_f32 v219, v219, v0
    v_sub_f32 v240, v240, v0
    v_sub_f32 v241, v241, v0
    v_sub_f32 v242, v242, v0
    v_sub_f32 v243, v243, v0
    v_mul_f32 v16, v254, v16
    v_mul_f32 v17, v254, v17
    v_mul_f32 v18, v254, v18
    v_mul_f32 v19, v254, v19
    v_mul_f32 v24, v254, v24
    v_mul_f32 v25, v254, v25
    v_mul_f32 v26, v254, v26
    v_mul_f32 v27, v254, v27
    v_mul_f32 v32, v254, v32
    v_mul_f32 v33, v254, v33
    v_mul_f32 v34, v254, v34
    v_mul_f32 v35, v254, v35
    v_mul_f32 v40, v254, v40
    v_mul_f32 v41, v254, v41
    v_mul_f32 v42, v254, v42
    v_mul_f32 v43, v254, v43
    v_mul_f32 v48, v254, v48
    v_mul_f32 v49, v254, v49
    v_mul_f32 v50, v254, v50
    v_mul_f32 v51, v254, v51
    v_mul_f32 v56, v254, v56
    v_mul_f32 v57, v254, v57
    v_mul_f32 v58, v254, v58
    v_mul_f32 v59, v254, v59
    v_mul_f32 v64, v254, v64
    v_mul_f32 v65, v254, v65
    v_mul_f32 v66, v254, v66
    v_mul_f32 v67, v254, v67
    v_mul_f32 v72, v254, v72
    v_mul_f32 v73, v254, v73
    v_mul_f32 v74, v254, v74
    v_mul_f32 v75, v254, v75
    v_mul_f32 v80, v254, v80
    v_mul_f32 v81, v254, v81
    v_mul_f32 v82, v254, v82
    v_mul_f32 v83, v254, v83
    v_mul_f32 v88, v254, v88
    v_mul_f32 v89, v254, v89
    v_mul_f32 v90, v254, v90
    v_mul_f32 v91, v254, v91
    v_mul_f32 v96, v254, v96
    v_mul_f32 v97, v254, v97
    v_mul_f32 v98, v254, v98
    v_mul_f32 v99, v254, v99
    v_mul_f32 v104, v254, v104
    v_mul_f32 v105, v254, v105
    v_mul_f32 v106, v254, v106
    v_mul_f32 v107, v254, v107
    v_mul_f32 v112, v254, v112
    v_mul_f32 v113, v254, v113
    v_mul_f32 v114, v254, v114
    v_mul_f32 v115, v254, v115
    v_mul_f32 v120, v254, v120
    v_mul_f32 v121, v254, v121
    v_mul_f32 v122, v254, v122
    v_mul_f32 v123, v254, v123
    v_mul_f32 v192, v254, v192
    v_mul_f32 v193, v254, v193
    v_mul_f32 v194, v254, v194
    v_mul_f32 v195, v254, v195
    v_mul_f32 v200, v254, v200
    v_mul_f32 v201, v254, v201
    v_mul_f32 v202, v254, v202
    v_mul_f32 v203, v254, v203
    v_accvgpr_read_b32 v10, a64
    v_mul_f32 v10, v254, v10
    v_accvgpr_write_b32 a64, v10
    v_accvgpr_read_b32 v10, a65
    v_mul_f32 v10, v254, v10
    v_accvgpr_write_b32 a65, v10
    v_accvgpr_read_b32 v10, a66
    v_mul_f32 v10, v254, v10
    v_accvgpr_write_b32 a66, v10
    v_accvgpr_read_b32 v10, a67
    v_mul_f32 v10, v254, v10
    v_accvgpr_write_b32 a67, v10
    v_lshlrev_b32 v10, 16, v224
    v_and_b32 v255, s70, v224
    v_mul_f32 v10, v254, v10
    v_mul_f32 v255, v254, v255
    v_cvt_pk_bf16_f32 v224, v10, v255
    v_lshlrev_b32 v10, 16, v225
    v_and_b32 v255, s70, v225
    v_mul_f32 v10, v254, v10
    v_mul_f32 v255, v254, v255
    v_cvt_pk_bf16_f32 v225, v10, v255
    v_lshlrev_b32 v10, 16, v226
    v_and_b32 v255, s70, v226
    v_mul_f32 v10, v254, v10
    v_mul_f32 v255, v254, v255
    v_cvt_pk_bf16_f32 v226, v10, v255
    v_lshlrev_b32 v10, 16, v227
    v_and_b32 v255, s70, v227
    v_mul_f32 v10, v254, v10
    v_mul_f32 v255, v254, v255
    v_cvt_pk_bf16_f32 v227, v10, v255
    v_lshlrev_b32 v10, 16, v232
    v_and_b32 v255, s70, v232
    v_mul_f32 v10, v254, v10
    v_mul_f32 v255, v254, v255
    v_cvt_pk_bf16_f32 v232, v10, v255
    v_lshlrev_b32 v10, 16, v233
    v_and_b32 v255, s70, v233
    v_mul_f32 v10, v254, v10
    v_mul_f32 v255, v254, v255
    v_cvt_pk_bf16_f32 v233, v10, v255
    v_lshlrev_b32 v10, 16, v234
    v_and_b32 v255, s70, v234
    v_mul_f32 v10, v254, v10
    v_mul_f32 v255, v254, v255
    v_cvt_pk_bf16_f32 v234, v10, v255
    v_lshlrev_b32 v10, 16, v235
    v_and_b32 v255, s70, v235
    v_mul_f32 v10, v254, v10
    v_mul_f32 v255, v254, v255
    v_cvt_pk_bf16_f32 v235, v10, v255
    v_max3_f32 v0, v212, v213, v214
    v_max_f32 v0, v0, v215
    v_mov_b32 v254, v0
    s_nop 1
    v_permlane16_swap_b32 v0, v254
    v_max_f32 v0, v0, v254
    v_mov_b32 v254, v0
    s_nop 1
    v_permlane32_swap_b32 v0, v254
    v_max_f32 v0, v0, v254
    v_ceil_f32 v0, v0
    v_max_f32 v0, 0, v0
    v_sub_f32 v254, 0, v0
    v_exp_f32 v254, v254
    v_sub_f32 v212, v212, v0
    v_sub_f32 v213, v213, v0
    v_sub_f32 v214, v214, v0
    v_sub_f32 v215, v215, v0
    v_sub_f32 v220, v220, v0
    v_sub_f32 v221, v221, v0
    v_sub_f32 v222, v222, v0
    v_sub_f32 v223, v223, v0
    v_sub_f32 v244, v244, v0
    v_sub_f32 v245, v245, v0
    v_sub_f32 v246, v246, v0
    v_sub_f32 v247, v247, v0
    v_mul_f32 v20, v254, v20
    v_mul_f32 v21, v254, v21
    v_mul_f32 v22, v254, v22
    v_mul_f32 v23, v254, v23
    v_mul_f32 v28, v254, v28
    v_mul_f32 v29, v254, v29
    v_mul_f32 v30, v254, v30
    v_mul_f32 v31, v254, v31
    v_mul_f32 v36, v254, v36
    v_mul_f32 v37, v254, v37
    v_mul_f32 v38, v254, v38
    v_mul_f32 v39, v254, v39
    v_mul_f32 v44, v254, v44
    v_mul_f32 v45, v254, v45
    v_mul_f32 v46, v254, v46
    v_mul_f32 v47, v254, v47
    v_mul_f32 v52, v254, v52
    v_mul_f32 v53, v254, v53
    v_mul_f32 v54, v254, v54
    v_mul_f32 v55, v254, v55
    v_mul_f32 v60, v254, v60
    v_mul_f32 v61, v254, v61
    v_mul_f32 v62, v254, v62
    v_mul_f32 v63, v254, v63
    v_mul_f32 v68, v254, v68
    v_mul_f32 v69, v254, v69
    v_mul_f32 v70, v254, v70
    v_mul_f32 v71, v254, v71
    v_mul_f32 v76, v254, v76
    v_mul_f32 v77, v254, v77
    v_mul_f32 v78, v254, v78
    v_mul_f32 v79, v254, v79
    v_mul_f32 v84, v254, v84
    v_mul_f32 v85, v254, v85
    v_mul_f32 v86, v254, v86
    v_mul_f32 v87, v254, v87
    v_mul_f32 v92, v254, v92
    v_mul_f32 v93, v254, v93
    v_mul_f32 v94, v254, v94
    v_mul_f32 v95, v254, v95
    v_mul_f32 v100, v254, v100
    v_mul_f32 v101, v254, v101
    v_mul_f32 v102, v254, v102
    v_mul_f32 v103, v254, v103
    v_mul_f32 v108, v254, v108
    v_mul_f32 v109, v254, v109
    v_mul_f32 v110, v254, v110
    v_mul_f32 v111, v254, v111
    v_mul_f32 v116, v254, v116
    v_mul_f32 v117, v254, v117
    v_mul_f32 v118, v254, v118
    v_mul_f32 v119, v254, v119
    v_mul_f32 v124, v254, v124
    v_mul_f32 v125, v254, v125
    v_mul_f32 v126, v254, v126
    v_mul_f32 v127, v254, v127
    v_mul_f32 v196, v254, v196
    v_mul_f32 v197, v254, v197
    v_mul_f32 v198, v254, v198
    v_mul_f32 v199, v254, v199
    v_mul_f32 v204, v254, v204
    v_mul_f32 v205, v254, v205
    v_mul_f32 v206, v254, v206
    v_mul_f32 v207, v254, v207
    v_accvgpr_read_b32 v10, a68
    v_mul_f32 v10, v254, v10
    v_accvgpr_write_b32 a68, v10
    v_accvgpr_read_b32 v10, a69
    v_mul_f32 v10, v254, v10
    v_accvgpr_write_b32 a69, v10
    v_accvgpr_read_b32 v10, a70
    v_mul_f32 v10, v254, v10
    v_accvgpr_write_b32 a70, v10
    v_accvgpr_read_b32 v10, a71
    v_mul_f32 v10, v254, v10
    v_accvgpr_write_b32 a71, v10
    v_lshlrev_b32 v10, 16, v228
    v_and_b32 v255, s70, v228
    v_mul_f32 v10, v254, v10
    v_mul_f32 v255, v254, v255
    v_cvt_pk_bf16_f32 v228, v10, v255
    v_lshlrev_b32 v10, 16, v229
    v_and_b32 v255, s70, v229
    v_mul_f32 v10, v254, v10
    v_mul_f32 v255, v254, v255
    v_cvt_pk_bf16_f32 v229, v10, v255
    v_lshlrev_b32 v10, 16, v230
    v_and_b32 v255, s70, v230
    v_mul_f32 v10, v254, v10
    v_mul_f32 v255, v254, v255
    v_cvt_pk_bf16_f32 v230, v10, v255
    v_lshlrev_b32 v10, 16, v231
    v_and_b32 v255, s70, v231
    v_mul_f32 v10, v254, v10
    v_mul_f32 v255, v254, v255
    v_cvt_pk_bf16_f32 v231, v10, v255
    v_lshlrev_b32 v10, 16, v236
    v_and_b32 v255, s70, v236
    v_mul_f32 v10, v254, v10
    v_mul_f32 v255, v254, v255
    v_cvt_pk_bf16_f32 v236, v10, v255
    v_lshlrev_b32 v10, 16, v237
    v_and_b32 v255, s70, v237
    v_mul_f32 v10, v254, v10
    v_mul_f32 v255, v254, v255
    v_cvt_pk_bf16_f32 v237, v10, v255
    v_lshlrev_b32 v10, 16, v238
    v_and_b32 v255, s70, v238
    v_mul_f32 v10, v254, v10
    v_mul_f32 v255, v254, v255
    v_cvt_pk_bf16_f32 v238, v10, v255
    v_lshlrev_b32 v10, 16, v239
    v_and_b32 v255, s70, v239
    v_mul_f32 v10, v254, v10
    v_mul_f32 v255, v254, v255
    v_cvt_pk_bf16_f32 v239, v10, v255
    s_nop 3
    s_setpc_b64 s[96:97]
L_RESCALE1:
    s_nop 15
    v_max3_f32 v0, v216, v217, v218
    v_max_f32 v0, v0, v219
    v_mov_b32 v254, v0
    s_nop 1
    v_permlane16_swap_b32 v0, v254
    v_max_f32 v0, v0, v254
    v_mov_b32 v254, v0
    s_nop 1
    v_permlane32_swap_b32 v0, v254
    v_max_f32 v0, v0, v254
    v_ceil_f32 v0, v0
    v_max_f32 v0, 0, v0
    v_sub_f32 v254, 0, v0
    v_exp_f32 v254, v254
    v_sub_f32 v208, v208, v0
    v_sub_f32 v209, v209, v0
    v_sub_f32 v210, v210, v0
    v_sub_f32 v211, v211, v0
    v_sub_f32 v216, v216, v0
    v_sub_f32 v217, v217, v0
    v_sub_f32 v218, v218, v0
    v_sub_f32 v219, v219, v0
    v_sub_f32 v240, v240, v0
    v_sub_f32 v241, v241, v0
    v_sub_f32 v242, v242, v0
    v_sub_f32 v243, v243, v0
    v_mul_f32 v16, v254, v16
    v_mul_f32 v17, v254, v17
    v_mul_f32 v18, v254, v18
    v_mul_f32 v19, v254, v19
    v_mul_f32 v24, v254, v24
    v_mul_f32 v25, v254, v25
    v_mul_f32 v26, v254, v26
    v_mul_f32 v27, v254, v27
    v_mul_f32 v32, v254, v32
    v_mul_f32 v33, v254, v33
    v_mul_f32 v34, v254, v34
    v_mul_f32 v35, v254, v35
    v_mul_f32 v40, v254, v40
    v_mul_f32 v41, v254, v41
    v_mul_f32 v42, v254, v42
    v_mul_f32 v43, v254, v43
    v_mul_f32 v48, v254, v48
    v_mul_f32 v49, v254, v49
    v_mul_f32 v50, v254, v50
    v_mul_f32 v51, v254, v51
    v_mul_f32 v56, v254, v56
    v_mul_f32 v57, v254, v57
    v_mul_f32 v58, v254, v58
    v_mul_f32 v59, v254, v59
    v_mul_f32 v64, v254, v64
    v_mul_f32 v65, v254, v65
    v_mul_f32 v66, v254, v66
    v_mul_f32 v67, v254, v67
    v_mul_f32 v72, v254, v72
    v_mul_f32 v73, v254, v73
    v_mul_f32 v74, v254, v74
    v_mul_f32 v75, v254, v75
    v_mul_f32 v80, v254, v80
    v_mul_f32 v81, v254, v81
    v_mul_f32 v82, v254, v82
    v_mul_f32 v83, v254, v83
    v_mul_f32 v88, v254, v88
    v_mul_f32 v89, v254, v89
    v_mul_f32 v90, v254, v90
    v_mul_f32 v91, v254, v91
    v_mul_f32 v96, v254, v96
    v_mul_f32 v97, v254, v97
    v_mul_f32 v98, v254, v98
    v_mul_f32 v99, v254, v99
    v_mul_f32 v104, v254, v104
    v_mul_f32 v105, v254, v105
    v_mul_f32 v106, v254, v106
    v_mul_f32 v107, v254, v107
    v_mul_f32 v112, v254, v112
    v_mul_f32 v113, v254, v113
    v_mul_f32 v114, v254, v114
    v_mul_f32 v115, v254, v115
    v_mul_f32 v120, v254, v120
    v_mul_f32 v121, v254, v121
    v_mul_f32 v122, v254, v122
    v_mul_f32 v123, v254, v123
    v_mul_f32 v192, v254, v192
    v_mul_f32 v193, v254, v193
    v_mul_f32 v194, v254, v194
    v_mul_f32 v195, v254, v195
    v_mul_f32 v200, v254, v200
    v_mul_f32 v201, v254, v201
    v_mul_f32 v202, v254, v202
    v_mul_f32 v203, v254, v203
    v_accvgpr_read_b32 v10, a64
    v_mul_f32 v10, v254, v10
    v_accvgpr_write_b32 a64, v10
    v_accvgpr_read_b32 v10, a65
    v_mul_f32 v10, v254, v10
    v_accvgpr_write_b32 a65, v10
    v_accvgpr_read_b32 v10, a66
    v_mul_f32 v10, v254, v10
    v_accvgpr_write_b32 a66, v10
    v_accvgpr_read_b32 v10, a67
    v_mul_f32 v10, v254, v10
    v_accvgpr_write_b32 a67, v10
    v_lshlrev_b32 v10, 16, v224
    v_and_b32 v255, s70, v224
    v_mul_f32 v10, v254, v10
    v_mul_f32 v255, v254, v255
    v_cvt_pk_bf16_f32 v224, v10, v255
    v_lshlrev_b32 v10, 16, v225
    v_and_b32 v255, s70, v225
    v_mul_f32 v10, v254, v10
    v_mul_f32 v255, v254, v255
    v_cvt_pk_bf16_f32 v225, v10, v255
    v_lshlrev_b32 v10, 16, v226
    v_and_b32 v255, s70, v226
    v_mul_f32 v10, v254, v10
    v_mul_f32 v255, v254, v255
    v_cvt_pk_bf16_f32 v226, v10, v255
    v_lshlrev_b32 v10, 16, v227
    v_and_b32 v255, s70, v227
    v_mul_f32 v10, v254, v10
    v_mul_f32 v255, v254, v255
    v_cvt_pk_bf16_f32 v227, v10, v255
    v_lshlrev_b32 v10, 16, v232
    v_and_b32 v255, s70, v232
    v_mul_f32 v10, v254, v10
    v_mul_f32 v255, v254, v255
    v_cvt_pk_bf16_f32 v232, v10, v255
    v_lshlrev_b32 v10, 16, v233
    v_and_b32 v255, s70, v233
    v_mul_f32 v10, v254, v10
    v_mul_f32 v255, v254, v255
    v_cvt_pk_bf16_f32 v233, v10, v255
    v_lshlrev_b32 v10, 16, v234
    v_and_b32 v255, s70, v234
    v_mul_f32 v10, v254, v10
    v_mul_f32 v255, v254, v255
    v_cvt_pk_bf16_f32 v234, v10, v255
    v_lshlrev_b32 v10, 16, v235
    v_and_b32 v255, s70, v235
    v_mul_f32 v10, v254, v10
    v_mul_f32 v255, v254, v255
    v_cvt_pk_bf16_f32 v235, v10, v255
    v_max3_f32 v0, v220, v221, v222
    v_max_f32 v0, v0, v223
    v_mov_b32 v254, v0
    s_nop 1
    v_permlane16_swap_b32 v0, v254
    v_max_f32 v0, v0, v254
    v_mov_b32 v254, v0
    s_nop 1
    v_permlane32_swap_b32 v0, v254
    v_max_f32 v0, v0, v254
    v_ceil_f32 v0, v0
    v_max_f32 v0, 0, v0
    v_sub_f32 v254, 0, v0
    v_exp_f32 v254, v254
    v_sub_f32 v212, v212, v0
    v_sub_f32 v213, v213, v0
    v_sub_f32 v214, v214, v0
    v_sub_f32 v215, v215, v0
    v_sub_f32 v220, v220, v0
    v_sub_f32 v221, v221, v0
    v_sub_f32 v222, v222, v0
    v_sub_f32 v223, v223, v0
    v_sub_f32 v244, v244, v0
    v_sub_f32 v245, v245, v0
    v_sub_f32 v246, v246, v0
    v_sub_f32 v247, v247, v0
    v_mul_f32 v20, v254, v20
    v_mul_f32 v21, v254, v21
    v_mul_f32 v22, v254, v22
    v_mul_f32 v23, v254, v23
    v_mul_f32 v28, v254, v28
    v_mul_f32 v29, v254, v29
    v_mul_f32 v30, v254, v30
    v_mul_f32 v31, v254, v31
    v_mul_f32 v36, v254, v36
    v_mul_f32 v37, v254, v37
    v_mul_f32 v38, v254, v38
    v_mul_f32 v39, v254, v39
    v_mul_f32 v44, v254, v44
    v_mul_f32 v45, v254, v45
    v_mul_f32 v46, v254, v46
    v_mul_f32 v47, v254, v47
    v_mul_f32 v52, v254, v52
    v_mul_f32 v53, v254, v53
    v_mul_f32 v54, v254, v54
    v_mul_f32 v55, v254, v55
    v_mul_f32 v60, v254, v60
    v_mul_f32 v61, v254, v61
    v_mul_f32 v62, v254, v62
    v_mul_f32 v63, v254, v63
    v_mul_f32 v68, v254, v68
    v_mul_f32 v69, v254, v69
    v_mul_f32 v70, v254, v70
    v_mul_f32 v71, v254, v71
    v_mul_f32 v76, v254, v76
    v_mul_f32 v77, v254, v77
    v_mul_f32 v78, v254, v78
    v_mul_f32 v79, v254, v79
    v_mul_f32 v84, v254, v84
    v_mul_f32 v85, v254, v85
    v_mul_f32 v86, v254, v86
    v_mul_f32 v87, v254, v87
    v_mul_f32 v92, v254, v92
    v_mul_f32 v93, v254, v93
    v_mul_f32 v94, v254, v94
    v_mul_f32 v95, v254, v95
    v_mul_f32 v100, v254, v100
    v_mul_f32 v101, v254, v101
    v_mul_f32 v102, v254, v102
    v_mul_f32 v103, v254, v103
    v_mul_f32 v108, v254, v108
    v_mul_f32 v109, v254, v109
    v_mul_f32 v110, v254, v110
    v_mul_f32 v111, v254, v111
    v_mul_f32 v116, v254, v116
    v_mul_f32 v117, v254, v117
    v_mul_f32 v118, v254, v118
    v_mul_f32 v119, v254, v119
    v_mul_f32 v124, v254, v124
    v_mul_f32 v125, v254, v125
    v_mul_f32 v126, v254, v126
    v_mul_f32 v127, v254, v127
    v_mul_f32 v196, v254, v196
    v_mul_f32 v197, v254, v197
    v_mul_f32 v198, v254, v198
    v_mul_f32 v199, v254, v199
    v_mul_f32 v204, v254, v204
    v_mul_f32 v205, v254, v205
    v_mul_f32 v206, v254, v206
    v_mul_f32 v207, v254, v207
    v_accvgpr_read_b32 v10, a68
    v_mul_f32 v10, v254, v10
    v_accvgpr_write_b32 a68, v10
    v_accvgpr_read_b32 v10, a69
    v_mul_f32 v10, v254, v10
    v_accvgpr_write_b32 a69, v10
    v_accvgpr_read_b32 v10, a70
    v_mul_f32 v10, v254, v10
    v_accvgpr_write_b32 a70, v10
    v_accvgpr_read_b32 v10, a71
    v_mul_f32 v10, v254, v10
    v_accvgpr_write_b32 a71, v10
    v_lshlrev_b32 v10, 16, v228
    v_and_b32 v255, s70, v228
    v_mul_f32 v10, v254, v10
    v_mul_f32 v255, v254, v255
    v_cvt_pk_bf16_f32 v228, v10, v255
    v_lshlrev_b32 v10, 16, v229
    v_and_b32 v255, s70, v229
    v_mul_f32 v10, v254, v10
    v_mul_f32 v255, v254, v255
    v_cvt_pk_bf16_f32 v229, v10, v255
    v_lshlrev_b32 v10, 16, v230
    v_and_b32 v255, s70, v230
    v_mul_f32 v10, v254, v10
    v_mul_f32 v255, v254, v255
    v_cvt_pk_bf16_f32 v230, v10, v255
    v_lshlrev_b32 v10, 16, v231
    v_and_b32 v255, s70, v231
    v_mul_f32 v10, v254, v10
    v_mul_f32 v255, v254, v255
    v_cvt_pk_bf16_f32 v231, v10, v255
    v_lshlrev_b32 v10, 16, v236
    v_and_b32 v255, s70, v236
    v_mul_f32 v10, v254, v10
    v_mul_f32 v255, v254, v255
    v_cvt_pk_bf16_f32 v236, v10, v255
    v_lshlrev_b32 v10, 16, v237
    v_and_b32 v255, s70, v237
    v_mul_f32 v10, v254, v10
    v_mul_f32 v255, v254, v255
    v_cvt_pk_bf16_f32 v237, v10, v255
    v_lshlrev_b32 v10, 16, v238
    v_and_b32 v255, s70, v238
    v_mul_f32 v10, v254, v10
    v_mul_f32 v255, v254, v255
    v_cvt_pk_bf16_f32 v238, v10, v255
    v_lshlrev_b32 v10, 16, v239
    v_and_b32 v255, s70, v239
    v_mul_f32 v10, v254, v10
    v_mul_f32 v255, v254, v255
    v_cvt_pk_bf16_f32 v239, v10, v255
    s_nop 3
    s_setpc_b64 s[96:97]
.section .rodata,"a"
.p2align 6
.amdhsa_kernel recurrent_scan__sliding_block_cached__dense_activation_relu__prompt_kernel
  .amdhsa_next_free_vgpr 512
  .amdhsa_next_free_sgpr 102
  .amdhsa_accum_offset 256
  .amdhsa_group_segment_fixed_size 0
  .amdhsa_kernarg_size 88
  .amdhsa_user_sgpr_count 2
  .amdhsa_user_sgpr_kernarg_segment_ptr 1
  .amdhsa_system_sgpr_workgroup_id_x 1
.end_amdhsa_kernel
```
